```python
import torch

def _softmax(x, axis=-1):
    return torch.softmax(x, dim=axis)
def _gelu(x):
    return torch.nn.functional.gelu(x, approximate="tanh")
def _silu(x):
    return torch.nn.functional.silu(x)
def _sigmoid(x):
    return torch.sigmoid(x)
def _layernorm(x, axis=-1, eps=1e-5):
    m = x.mean(dim=axis, keepdim=True)
    v = x.var(dim=axis, keepdim=True, unbiased=False)
    return (x - m) / torch.sqrt(v + eps)
def _scatter_add(tgt, idx, src, axis=0):
    return tgt.clone().index_add_(axis, idx, src)
def _segment_sum(src, seg, n):
    out = torch.zeros((n,) + src.shape[1:], dtype=src.dtype)
    return out.index_add_(0, seg, src)
def _pad(x, pw):
    flat = tuple(v for pair in reversed(pw) for v in pair)
    return torch.nn.functional.pad(x, flat)

kernel_name = 'parallel_sum__sliding_local_dilated__glu_gated_geglu__prompt'

def setup_inputs():

    _w = (lambda a: (lambda t: t.to(torch.bfloat16) if t.is_floating_point() else t)(torch.as_tensor(a)))
    def _A_setup():
        B, S, D = 1, 2048, 640
        return {
            "x": _w((lambda *s: torch.randn(*s, dtype=torch.bfloat16) * 0.05)(B, S, D)),
            "wqkv": _w((lambda *s: torch.randn(*s, dtype=torch.bfloat16) * 0.05)(D, 3 * D)),
            "wo": _w((lambda *s: torch.randn(*s, dtype=torch.bfloat16) * 0.05)(D, D)),
        }
    _A_in = _A_setup()

    def _B_setup():
        B, S, Dm, Df = 1, 2048, 640, 1536
        return {
            "x": _w((lambda *s: torch.randn(*s, dtype=torch.bfloat16) * 0.05)(B, S, Dm)),
            "w_gate": _w((lambda *s: torch.randn(*s, dtype=torch.bfloat16) * 0.8)(Dm, Df) * (Dm ** -0.5)),
            "w_up": _w((lambda *s: torch.randn(*s, dtype=torch.bfloat16) * 0.8)(Dm, Df) * (Dm ** -0.5)),
            "w_down": _w((lambda *s: torch.randn(*s, dtype=torch.bfloat16) * 0.8)(Df, Dm) * (Df ** -0.5)),
        }
    _B_in = _B_setup()

    return {
        "A_x": _A_in["x"],
        "A_wqkv": _A_in["wqkv"],
        "A_wo": _A_in["wo"],
        "B_x": _B_in["x"],
        "B_w_gate": _B_in["w_gate"],
        "B_w_up": _B_in["w_up"],
        "B_w_down": _B_in["w_down"],
    }

def reference(A_x, A_wqkv, A_wo, B_x, B_w_gate, B_w_up, B_w_down):
    def _A_ref(x, wqkv, wo):
        B, S, D = x.shape
        H = 32; Dh = D // H
        W, dil = 8, 2
        qkv = (lambda x, *d: x.permute(*d))((x @ wqkv).reshape(B, S, 3, H, Dh), 2, 0, 3, 1, 4)
        q, k, v = qkv[0], qkv[1], qkv[2]
        scale = Dh ** -0.5
        pos = torch.arange(S)
        off = torch.arange(W) * dil
        idx = pos[:, None] - off[None, :]
        mask = idx >= 0
        idx_c = torch.where(mask, idx, 0).reshape(-1)
        kg = k[:, :, idx_c, :].reshape(B, H, S, W, Dh)
        vg = v[:, :, idx_c, :].reshape(B, H, S, W, Dh)
        logits = torch.einsum("bhsd,bhswd->bhsw", q, kg) * scale
        logits = torch.where(mask[None, None, :, :], logits, -1e9)
        attn = _softmax(logits, axis=-1)
        o = torch.einsum("bhsw,bhswd->bhsd", attn, vg)
        return (lambda x, *d: x.permute(*d))(o, 0, 2, 1, 3).reshape(B, S, D) @ wo

    def _B_ref(x, w_gate, w_up, w_down):
        g = torch.einsum("bsd,df->bsf", x, w_gate)
        u = torch.einsum("bsd,df->bsf", x, w_up)
        h = _gelu(g) * u
        return torch.einsum("bsf,fd->bsd", h, w_down)

    x = A_x
    xn = _layernorm(x, axis=-1)
    return x + _A_ref(xn, A_wqkv, A_wo) + _B_ref(xn, B_w_gate, B_w_up, B_w_down)
```

```asm
; @launch grid=(256,1,1) block=(256,1,1) lds=162816
.amdgcn_target "amdgcn-amd-amdhsa--gfx950"
.text
.globl parallel_sum__sliding_local_dilated__glu_gated_geglu__prompt_kernel
.p2align 8
.type parallel_sum__sliding_local_dilated__glu_gated_geglu__prompt_kernel,@function
parallel_sum__sliding_local_dilated__glu_gated_geglu__prompt_kernel:
    s_cmp_ge_u32 s2, 256
    s_cbranch_scc1 K_end
    s_memrealtime s[94:95]
    s_load_dwordx4 s[4:7], s[0:1], 0
    s_load_dwordx4 s[8:11], s[0:1], 32
    s_load_dwordx2 s[12:13], s[0:1], 72
    s_load_dwordx2 s[24:25], s[0:1], 64
    s_load_dwordx2 s[14:15], s[0:1], 16
    s_load_dwordx4 s[96:99], s[0:1], 48
    v_lshrrev_b32 v1, 6, v0
    v_and_b32 v2, 63, v0
    v_readfirstlane_b32 s32, v1
    s_getpc_b64 s[68:69]
K_pf:
    s_cmp_ge_u32 s2, 128
    s_cselect_b32 s70, K_att-K_pf, 0
    s_bfe_u32 s71, s2, 0x20003
    s_lshl_b32 s71, s71, 4
    v_lshrrev_b32 v16, 2, v2
    v_add_u32 v16, s71, v16
    v_lshl_add_u32 v16, v1, 6, v16
    v_lshl_add_u32 v16, v16, 7, s70
    v_min_u32 v16, K_last-K_pf, v16
    v_mov_b32 v17, s69
    v_add_co_u32 v16, vcc, s68, v16
    s_nop 1
    v_addc_co_u32 v17, vcc, 0, v17, vcc
    global_load_dword a199, v[16:17], off
    s_and_b32 s33, s2, 7
    s_lshr_b32 s34, s2, 3
    s_and_b32 s35, s34, 7
    s_lshr_b32 s34, s34, 3
    s_and_b32 s36, s33, 1
    s_lshl_b32 s36, s36, 3
    s_add_u32 s36, s36, s35
    s_lshr_b32 s76, s33, 1
    s_lshl_b32 s76, s76, 2
    s_add_u32 s76, s76, s34
    s_and_b32 s37, s33, 6
    s_and_b32 s68, s34, 1
    s_add_u32 s37, s37, s68
    s_lshl_b32 s38, s34, 2
    s_lshr_b32 s38, 17408, s38
    s_and_b32 s38, s38, 15
    s_lshl_b32 s68, s35, 2
    s_cmp_ge_u32 s34, 2
    s_mov_b32 s69, 2271556112
    s_cselect_b32 s69, 2271556112, s69
    s_lshr_b32 s69, s69, s68
    s_and_b32 s69, s69, 15
    s_add_u32 s38, s38, s69
    s_and_b32 s69, s33, 1
    s_mul_i32 s69, s69, 2
    s_add_u32 s38, s38, s69
    s_sub_u32 s68, s38, 10
    s_cmp_ge_u32 s38, 10
    s_cselect_b32 s38, s68, s38
    s_cmp_ge_u32 s34, 2
    s_movk_i32 s68, 0x780
    s_cselect_b32 s69, s68, 0x600
    s_lshl_b32 s50, s38, 7
    s_mul_i32 s40, s50, s69
    s_add_u32 s38, s38, 1
    s_cmp_eq_u32 s38, 10
    s_cselect_b32 s38, 0, s38
    s_lshl_b32 s51, s38, 7
    s_mul_i32 s41, s51, s69
    s_add_u32 s38, s38, 1
    s_cmp_eq_u32 s38, 10
    s_cselect_b32 s38, 0, s38
    s_lshl_b32 s52, s38, 7
    s_mul_i32 s42, s52, s69
    s_add_u32 s38, s38, 1
    s_cmp_eq_u32 s38, 10
    s_cselect_b32 s38, 0, s38
    s_lshl_b32 s53, s38, 7
    s_mul_i32 s43, s53, s69
    s_add_u32 s38, s38, 1
    s_cmp_eq_u32 s38, 10
    s_cselect_b32 s38, 0, s38
    s_lshl_b32 s54, s38, 7
    s_mul_i32 s44, s54, s69
    s_add_u32 s38, s38, 1
    s_cmp_eq_u32 s38, 10
    s_cselect_b32 s38, 0, s38
    s_lshl_b32 s55, s38, 7
    s_mul_i32 s45, s55, s69
    s_add_u32 s38, s38, 1
    s_cmp_eq_u32 s38, 10
    s_cselect_b32 s38, 0, s38
    s_lshl_b32 s56, s38, 7
    s_mul_i32 s46, s56, s69
    s_add_u32 s38, s38, 1
    s_cmp_eq_u32 s38, 10
    s_cselect_b32 s38, 0, s38
    s_lshl_b32 s57, s38, 7
    s_mul_i32 s47, s57, s69
    s_add_u32 s38, s38, 1
    s_cmp_eq_u32 s38, 10
    s_cselect_b32 s38, 0, s38
    s_lshl_b32 s58, s38, 7
    s_mul_i32 s48, s58, s69
    s_add_u32 s38, s38, 1
    s_cmp_eq_u32 s38, 10
    s_cselect_b32 s38, 0, s38
    s_lshl_b32 s59, s38, 7
    s_mul_i32 s49, s59, s69
    s_lshl_b32 s68, s36, 4
    s_add_u32 s68, s68, s76
    s_mul_i32 s39, s68, 10240
    v_lshrrev_b32 v3, 5, v0
    v_mul_u32_u24 v4, 1280, v3
    v_and_b32 v5, 31, v2
    v_lshl_add_u32 v4, v5, 4, v4
    v_lshlrev_b32 v5, 26, v5
    v_and_b32 v5, 0x40000000, v5
    v_or_b32 v5, v5, v4
    s_mov_b32 s18, 0x280000
    s_mov_b32 s19, 0x00020000
    s_mov_b32 s30, 0x10000000
    s_mov_b32 s31, 0x00020000
    s_movk_i32 s26, 256
    s_mov_b32 s27, 0x00020000
    s_or_b32 s70, s2, s32
    v_lshlrev_b32 v14, 4, v2
    s_waitcnt lgkmcnt(0)
    s_mov_b32 s16, s4
    s_and_b32 s17, s5, 0xffff
    s_mov_b32 s28, s12
    s_and_b32 s29, s13, 0xffff
    s_and_b32 s25, s25, 0xffff
    s_cmp_lg_u32 s70, 0
    s_cbranch_scc1 K_noinit
    s_lshl_b32 s68, s94, 3
    s_or_b32 s68, s68, 4
    v_mov_b32 v8, s68
    s_mov_b64 exec, 1
    buffer_store_dword v8, off, s[24:27], 0 sc1
    s_mov_b64 exec, -1
K_noinit:
    buffer_load_dwordx4 v[112:115], v4, s[16:19], s39 offen offset:0
    buffer_load_dwordx4 v[116:119], v4, s[16:19], s39 offen offset:512
    buffer_load_dwordx4 v[120:123], v5, s[16:19], s39 offen offset:1024
    s_cmp_ge_u32 s34, 2
    s_cbranch_scc1 K_att
    s_and_b32 s60, s32, 1
    s_lshr_b32 s61, s32, 1
    v_mov_b32 v11, v14
    v_lshrrev_b32 v13, 3, v2
    v_lshl_add_u32 v13, v1, 5, v13
    s_lshl_b32 s71, s36, 7
    v_add_u32 v13, s71, v13
    v_mul_u32_u24 v13, 1280, v13
    v_and_b32 v14, 7, v2
    v_lshrrev_b32 v15, 4, v2
    v_xor_b32 v15, v14, v15
    v_lshl_add_u32 v104, v15, 4, v13
    v_xor_b32 v15, 64, v104
    v_add_u32 v105, 9216, v15
    v_add_u32 v106, 18432, v104
    v_add_u32 v107, 18432, v105
    s_mul_i32 s66, s32, 4224
    s_lshl_b32 s67, s32, 12
    s_add_u32 m0, s67, 101376
    s_nop 0
    buffer_load_dwordx4 v104, s[16:19], s50 offen offset:0 lds
    buffer_load_dwordx4 v105, s[16:19], s50 offen offset:1024 lds
    buffer_load_dwordx4 v106, s[16:19], s50 offen offset:2048 lds
    buffer_load_dwordx4 v107, s[16:19], s50 offen offset:3072 lds
    s_cmp_eq_u32 s60, 0
    s_cselect_b32 s8, s8, s10
    s_cselect_b32 s9, s9, s11
    s_mov_b32 s20, s8
    s_and_b32 s21, s9, 0xffff
    s_mov_b32 s22, 0x1e0000
    s_mov_b32 s23, 0x00020000
    v_lshrrev_b32 v13, 5, v2
    v_lshlrev_b32 v13, 4, v13
    v_bfe_u32 v15, v2, 4, 1
    v_lshl_add_u32 v13, v15, 2, v13
    v_bfe_u32 v15, v2, 3, 1
    s_lshl_b32 s71, s61, 5
    v_add3_u32 v13, v13, v15, s71
    v_mul_u32_u24 v13, 3072, v13
    v_lshlrev_b32 v14, 4, v14
    s_mul_i32 s71, s37, 384
    v_add3_u32 v3, v13, v14, s71
    v_add_u32 v4, 5088, v3
    v_add_u32 v5, 22464, v3
    v_add_u32 v6, 27552, v3
    s_add_u32 m0, s66, 0
    s_add_u32 s68, s40, 0
    buffer_load_dwordx4 v3, s[20:23], s68 offen offset:0 lds
    buffer_load_dwordx4 v4, s[20:23], s68 offen offset:1056 lds
    buffer_load_dwordx4 v5, s[20:23], s68 offen offset:2112 lds
    buffer_load_dwordx4 v6, s[20:23], s68 offen offset:3168 lds
    s_add_u32 m0, s67, 118272
    s_nop 0
    buffer_load_dwordx4 v104, s[16:19], s51 offen offset:0 lds
    buffer_load_dwordx4 v105, s[16:19], s51 offen offset:1024 lds
    buffer_load_dwordx4 v106, s[16:19], s51 offen offset:2048 lds
    buffer_load_dwordx4 v107, s[16:19], s51 offen offset:3072 lds
    s_add_u32 m0, s66, 16896
    s_add_u32 s68, s41, 0
    buffer_load_dwordx4 v3, s[20:23], s68 offen offset:0 lds
    buffer_load_dwordx4 v4, s[20:23], s68 offen offset:1056 lds
    buffer_load_dwordx4 v5, s[20:23], s68 offen offset:2112 lds
    buffer_load_dwordx4 v6, s[20:23], s68 offen offset:3168 lds
    s_lshl_b32 s63, s36, 1
    s_add_u32 s63, s63, s60
    s_mul_i32 s63, s63, 68
    s_mul_i32 s71, s37, 6
    s_add_u32 s63, s63, s71
    s_add_u32 s63, s63, s61
    s_add_u32 s63, s63, 20
    s_lshl_b32 s63, s63, 12
    s_add_u32 s64, s63, 8192
    s_add_u32 s65, s63, 16384
    v_bfe_u32 v13, v2, 3, 2
    v_mul_u32_u24 v13, 1056, v13
    v_lshrrev_b32 v14, 5, v2
    v_lshlrev_b32 v14, 2, v14
    v_bfe_u32 v15, v2, 2, 1
    v_add_u32 v14, v14, v15
    v_lshl_add_u32 v13, v14, 7, v13
    v_and_b32 v14, 3, v2
    v_lshlrev_b32 v14, 3, v14
    s_lshl_b32 s71, s61, 6
    v_add3_u32 v7, v13, v14, s71
    v_add_u32 v8, 67584, v7
    v_bfe_u32 v13, v2, 1, 3
    v_lshrrev_b32 v14, 4, v2
    v_xor_b32 v13, v13, v14
    v_lshlrev_b32 v13, 4, v13
    v_and_b32 v14, 15, v2
    v_lshl_add_u32 v13, v14, 7, v13
    s_lshl_b32 s71, s60, 13
    s_add_u32 s71, s71, 84480
    v_add_u32 v108, s71, v13
    v_xor_b32 v109, 64, v108
    v_lshlrev_b32 v110, 3, v14
    s_mul_i32 s12, s32, 7168
    s_add_u32 s12, s12, 135168
    s_lshl_b32 s72, s33, 1
    s_add_u32 s72, s72, s34
    s_lshl_b32 s72, s72, 15
    s_lshl_b32 s71, s61, 12
    s_add_u32 s72, s72, s71
    s_add_u32 s72, s72, 30408704
    s_lshl_b32 s73, s60, 11
    s_add_u32 s73, s73, s72
    s_lshr_b32 s71, s35, 1
    s_lshl_b32 s71, s71, 8
    s_add_u32 s73, s73, s71
    s_and_b32 s71, s35, 1
    s_lshl_b32 s71, s71, 10
    s_add_u32 s73, s73, s71
    s_bitcmp1_b32 136, s35
    s_cselect_b32 s74, 0x3f803f80, 0
    s_cmp_eq_u32 s60, 0
    s_cselect_b32 s6, 0x3f803f80, 0
    s_cselect_b32 s7, 0, 0x3f803f80
    s_and_b32 s10, s6, s74
    s_and_b32 s11, s7, s74
    s_lshr_b32 s0, s76, 3
    s_mul_i32 s0, s0, 20
    s_lshl_b32 s68, s34, 3
    s_lshr_b32 s68, 0x0e080400, s68
    s_and_b32 s68, s68, 255
    s_add_u32 s0, s0, s68
    s_lshl_b32 s70, s36, 1
    s_bfe_u32 s71, s76, 0x10002
    s_add_u32 s70, s70, s71
    s_lshl_b32 s69, s0, 10
    s_add_u32 s69, s69, 16777216
    s_mul_i32 s68, s32, 204800
    s_add_u32 s93, s69, s68
    s_mul_i32 s68, s32, 491520
    s_add_u32 s92, s69, s68
    s_mul_i32 s69, s70, 278528
    s_mul_i32 s68, s32, 20480
    s_add_u32 s78, s69, s68
    s_mul_i32 s68, s32, 49152
    s_add_u32 s77, s69, s68
    s_mul_i32 s3, s70, 81920
    s_lshl_b32 s69, s0, 5
    s_add_u32 s3, s3, s69
    s_mul_i32 s69, s32, 20480
    s_add_u32 s3, s3, s69
    s_lshr_b32 s35, s70, 1
    s_lshl_b32 s35, s35, 14
    s_and_b32 s71, s70, 1
    s_lshl_b32 s71, s71, 5
    s_add_u32 s35, s35, s71
    s_lshl_b32 s71, s32, 7
    s_add_u32 s71, s71, 29361152
    s_add_u32 s35, s35, s71
    s_lshl_b32 s79, s36, 14
    s_add_u32 s79, s79, 29360128
    s_lshr_b32 s69, s76, 2
    s_lshl_b32 s69, s69, 7
    s_add_u32 s68, s79, s69
    s_lshl_b32 s34, s34, 3
    s_add_u32 s34, s34, s68
    s_add_u32 s34, s34, 1024
    s_and_b32 s68, s32, 1
    s_lshr_b32 s69, s32, 1
    s_lshl_b32 s68, s68, 5
    s_lshl_b32 s69, s69, 2
    s_add_u32 s34, s34, s68
    s_add_u32 s34, s34, s69
    s_lshl_b32 s75, s60, 9
    s_add_u32 s75, s75, s79
    s_mov_b32 s4, 0x01000100
    s_mov_b32 s5, 0x03020302
    s_mov_b32 s33, 0x3f803f80
    v_mov_b32 v124, 0
    v_lshrrev_b32 v126, 5, v0
    s_lshl_b32 s68, s76, 3
    v_add_lshl_u32 v126, v126, s68, 3
    v_and_b32 v125, 31, v2
    v_cmp_eq_u32 vcc, 31, v125
    v_mov_b32 v125, 0x7ff00000
    s_nop 0
    v_cndmask_b32 v126, v125, v126, vcc
    v_mov_b32 v125, 0
    s_waitcnt vmcnt(16)
    s_buffer_load_dword s1, s[24:27], 0
    v_dot2c_f32_bf16 v124, s33, v112
    v_dot2c_f32_bf16 v125, v112, v112
    v_dot2c_f32_bf16 v124, s33, v113
    v_dot2c_f32_bf16 v125, v113, v113
    v_dot2c_f32_bf16 v124, s33, v114
    v_dot2c_f32_bf16 v125, v114, v114
    v_dot2c_f32_bf16 v124, s33, v115
    v_dot2c_f32_bf16 v125, v115, v115
    v_dot2c_f32_bf16 v124, s33, v116
    v_dot2c_f32_bf16 v125, v116, v116
    v_dot2c_f32_bf16 v124, s33, v117
    v_dot2c_f32_bf16 v125, v117, v117
    v_dot2c_f32_bf16 v124, s33, v118
    v_dot2c_f32_bf16 v125, v118, v118
    v_dot2c_f32_bf16 v124, s33, v119
    v_dot2c_f32_bf16 v125, v119, v119
    v_dot2c_f32_bf16 v124, s33, v120
    v_dot2c_f32_bf16 v125, v120, v120
    v_dot2c_f32_bf16 v124, s33, v121
    v_dot2c_f32_bf16 v125, v121, v121
    v_dot2c_f32_bf16 v124, s33, v122
    v_dot2c_f32_bf16 v125, v122, v122
    v_dot2c_f32_bf16 v124, s33, v123
    v_dot2c_f32_bf16 v125, v123, v123
    s_nop 0
    s_nop 1
    v_add_f32_dpp v124, v124, v124 quad_perm:[1,0,3,2] row_mask:0xf bank_mask:0xf
    v_add_f32_dpp v125, v125, v125 quad_perm:[1,0,3,2] row_mask:0xf bank_mask:0xf
    s_nop 1
    v_add_f32_dpp v124, v124, v124 quad_perm:[2,3,0,1] row_mask:0xf bank_mask:0xf
    v_add_f32_dpp v125, v125, v125 quad_perm:[2,3,0,1] row_mask:0xf bank_mask:0xf
    s_nop 1
    v_add_f32_dpp v124, v124, v124 row_half_mirror row_mask:0xf bank_mask:0xf
    v_add_f32_dpp v125, v125, v125 row_half_mirror row_mask:0xf bank_mask:0xf
    s_nop 1
    v_add_f32_dpp v124, v124, v124 row_mirror row_mask:0xf bank_mask:0xf
    v_add_f32_dpp v125, v125, v125 row_mirror row_mask:0xf bank_mask:0xf
    s_nop 1
    v_add_f32_dpp v124, v124, v124 row_bcast:15 row_mask:0xa bank_mask:0xf
    v_add_f32_dpp v125, v125, v125 row_bcast:15 row_mask:0xa bank_mask:0xf
    v_mul_f32 v124, 0xbacccccd, v124
    v_mul_f32 v125, 0x3acccccd, v125
    v_fma_f32 v125, -v124, v124, v125
    v_max_f32 v125, 0, v125
    v_cvt_pk_bf16_f32 v125, v125, v125
    v_lshlrev_b32 v125, 16, v125
    v_add_f32 v125, 0x3727c5ac, v125
    v_cvt_pk_bf16_f32 v125, v125, v125
    v_lshlrev_b32 v125, 16, v125
    v_sqrt_f32 v125, v125
    s_waitcnt lgkmcnt(0)
    v_cvt_pk_bf16_f32 v124, v124, v125
    s_cmp_eq_u32 s1, 0
    s_cbranch_scc1 NON_ffn_spin
NON_ffn_ok:
    v_mov_b32 v125, s1
    v_add_u32 v2, s1, v2
    buffer_store_dwordx2 v[124:125], v126, s[28:31], s79 offen sc1
    v_mov_b32 v240, 0x3f803f80
    v_mov_b32 v241, 0x3f803f80
    v_mov_b32 v242, 0x3f803f80
    v_mov_b32 v243, 0x3f803f80
    v_mov_b32 v240, s6
    v_mov_b32 v241, s6
    v_mov_b32 v242, s6
    v_mov_b32 v243, s6
    v_mov_b32 v244, s7
    v_mov_b32 v245, s7
    v_mov_b32 v246, s7
    v_mov_b32 v247, s7
    s_add_u32 m0, s67, 135168
    s_nop 0
    buffer_load_dwordx4 v104, s[16:19], s52 offen offset:0 lds
    buffer_load_dwordx4 v105, s[16:19], s52 offen offset:1024 lds
    buffer_load_dwordx4 v106, s[16:19], s52 offen offset:2048 lds
    buffer_load_dwordx4 v107, s[16:19], s52 offen offset:3072 lds
    s_add_u32 m0, s66, 33792
    s_add_u32 s68, s42, 0
    buffer_load_dwordx4 v3, s[20:23], s68 offen offset:0 lds
    buffer_load_dwordx4 v4, s[20:23], s68 offen offset:1056 lds
    buffer_load_dwordx4 v5, s[20:23], s68 offen offset:2112 lds
    buffer_load_dwordx4 v6, s[20:23], s68 offen offset:3168 lds
    s_waitcnt vmcnt(17)
    s_barrier
    ds_read_b64_tr_b16 v[16:17], v7 offset:0
    ds_read_b64_tr_b16 v[18:19], v7 offset:256
    ds_read_b128 a[0:3], v108 offset:16896
    ds_read_b128 a[4:7], v108 offset:18944
    ds_read_b128 a[8:11], v108 offset:20992
    ds_read_b128 a[12:15], v108 offset:23040
    ds_read_b64_tr_b16 v[20:21], v7 offset:32
    ds_read_b64_tr_b16 v[22:23], v7 offset:288
    ds_read_b64_tr_b16 v[24:25], v7 offset:4224
    ds_read_b64_tr_b16 v[26:27], v7 offset:4480
    ds_read_b64_tr_b16 v[28:29], v7 offset:4256
    ds_read_b64_tr_b16 v[30:31], v7 offset:4512
    ds_read_b128 a[16:19], v109 offset:16896
    ds_read_b128 a[20:23], v109 offset:18944
    ds_read_b128 a[24:27], v109 offset:20992
    ds_read_b128 a[28:31], v109 offset:23040
    s_waitcnt lgkmcnt(8)
    v_mfma_f32_16x16x32_bf16 v[40:43], v[16:19], a[0:3], 0
    s_add_u32 m0, s66, 50688
    s_add_u32 s68, s43, 0
    v_mfma_f32_16x16x32_bf16 v[44:47], v[16:19], a[4:7], 0
    ds_read_b64_tr_b16 v[32:33], v7 offset:8448
    v_mfma_f32_16x16x32_bf16 v[48:51], v[16:19], a[8:11], 0
    buffer_load_dwordx4 v3, s[20:23], s68 offen offset:0 lds
    v_mfma_f32_16x16x32_bf16 v[52:55], v[16:19], a[12:15], 0
    ds_read_b64_tr_b16 v[34:35], v7 offset:8704
    v_mfma_f32_16x16x32_bf16 v[68:71], v[20:23], a[12:15], 0
    buffer_load_dwordx4 v4, s[20:23], s68 offen offset:1056 lds
    v_mfma_f32_16x16x32_bf16 v[64:67], v[20:23], a[8:11], 0
    ds_read_b64_tr_b16 v[36:37], v7 offset:8480
    v_mfma_f32_16x16x32_bf16 v[60:63], v[20:23], a[4:7], 0
    buffer_load_dwordx4 v5, s[20:23], s68 offen offset:2112 lds
    v_mfma_f32_16x16x32_bf16 v[56:59], v[20:23], a[0:3], 0
    ds_read_b64_tr_b16 v[38:39], v7 offset:8736
    v_mfma_f32_16x16x32_bf16 v[248:251], v[240:243], v[16:19], 0
    buffer_load_dwordx4 v6, s[20:23], s68 offen offset:3168 lds
    v_mfma_f32_16x16x32_bf16 v[252:255], v[240:243], v[20:23], 0
    s_add_u32 m0, s66, 67584
    s_waitcnt lgkmcnt(8)
    v_mfma_f32_16x16x32_bf16 v[72:75], v[24:27], a[0:3], 0
    s_add_u32 s68, s44, 0
    v_mfma_f32_16x16x32_bf16 v[76:79], v[24:27], a[4:7], 0
    ds_read_b64_tr_b16 v[16:17], v7 offset:12672
    v_mfma_f32_16x16x32_bf16 v[80:83], v[24:27], a[8:11], 0
    buffer_load_dwordx4 v3, s[20:23], s68 offen offset:0 lds
    v_mfma_f32_16x16x32_bf16 v[84:87], v[24:27], a[12:15], 0
    ds_read_b64_tr_b16 v[18:19], v7 offset:12928
    v_mfma_f32_16x16x32_bf16 v[100:103], v[28:31], a[12:15], 0
    buffer_load_dwordx4 v4, s[20:23], s68 offen offset:1056 lds
    v_mfma_f32_16x16x32_bf16 v[96:99], v[28:31], a[8:11], 0
    ds_read_b64_tr_b16 v[20:21], v7 offset:12704
    v_mfma_f32_16x16x32_bf16 v[92:95], v[28:31], a[4:7], 0
    buffer_load_dwordx4 v5, s[20:23], s68 offen offset:2112 lds
    v_mfma_f32_16x16x32_bf16 v[88:91], v[28:31], a[0:3], 0
    ds_read_b64_tr_b16 v[22:23], v7 offset:12960
    v_mfma_f32_16x16x32_bf16 v[248:251], v[244:247], v[24:27], v[248:251]
    buffer_load_dwordx4 v6, s[20:23], s68 offen offset:3168 lds
    v_mfma_f32_16x16x32_bf16 v[252:255], v[244:247], v[28:31], v[252:255]
    s_waitcnt lgkmcnt(4)
    v_mfma_f32_16x16x32_bf16 v[40:43], v[32:35], a[16:19], v[40:43]
    s_waitcnt vmcnt(17)
    s_barrier
    v_mfma_f32_16x16x32_bf16 v[44:47], v[32:35], a[20:23], v[44:47]
    ds_read_b64_tr_b16 v[24:25], v7 offset:16896
    s_add_u32 m0, s67, 101376
    v_mfma_f32_16x16x32_bf16 v[48:51], v[32:35], a[24:27], v[48:51]
    ds_read_b128 a[32:35], v108 offset:33792
    s_nop 0
    v_mfma_f32_16x16x32_bf16 v[52:55], v[32:35], a[28:31], v[52:55]
    ds_read_b64_tr_b16 v[26:27], v7 offset:17152
    ds_read_b128 a[36:39], v108 offset:35840
    v_mfma_f32_16x16x32_bf16 v[68:71], v[36:39], a[28:31], v[68:71]
    buffer_load_dwordx4 v104, s[16:19], s53 offen offset:0 lds
    v_mfma_f32_16x16x32_bf16 v[64:67], v[36:39], a[24:27], v[64:67]
    ds_read_b64_tr_b16 v[28:29], v7 offset:16928
    v_mfma_f32_16x16x32_bf16 v[60:63], v[36:39], a[20:23], v[60:63]
    ds_read_b128 a[40:43], v108 offset:37888
    v_mfma_f32_16x16x32_bf16 v[56:59], v[36:39], a[16:19], v[56:59]
    ds_read_b64_tr_b16 v[30:31], v7 offset:17184
    v_mfma_f32_16x16x32_bf16 v[248:251], v[240:243], v[32:35], v[248:251]
    buffer_load_dwordx4 v105, s[16:19], s53 offen offset:1024 lds
    v_mfma_f32_16x16x32_bf16 v[252:255], v[240:243], v[36:39], v[252:255]
    s_waitcnt lgkmcnt(7)
    v_mfma_f32_16x16x32_bf16 v[72:75], v[16:19], a[16:19], v[72:75]
    v_mfma_f32_16x16x32_bf16 v[76:79], v[16:19], a[20:23], v[76:79]
    ds_read_b64_tr_b16 v[32:33], v7 offset:21120
    v_mfma_f32_16x16x32_bf16 v[80:83], v[16:19], a[24:27], v[80:83]
    ds_read_b128 a[44:47], v108 offset:39936
    v_mfma_f32_16x16x32_bf16 v[84:87], v[16:19], a[28:31], v[84:87]
    ds_read_b64_tr_b16 v[34:35], v7 offset:21376
    v_mfma_f32_16x16x32_bf16 v[100:103], v[20:23], a[28:31], v[100:103]
    buffer_load_dwordx4 v106, s[16:19], s53 offen offset:2048 lds
    v_mfma_f32_16x16x32_bf16 v[96:99], v[20:23], a[24:27], v[96:99]
    ds_read_b64_tr_b16 v[36:37], v7 offset:21152
    v_mfma_f32_16x16x32_bf16 v[92:95], v[20:23], a[20:23], v[92:95]
    ds_read_b128 a[48:51], v109 offset:33792
    v_mfma_f32_16x16x32_bf16 v[88:91], v[20:23], a[16:19], v[88:91]
    ds_read_b64_tr_b16 v[38:39], v7 offset:21408
    v_mfma_f32_16x16x32_bf16 v[248:251], v[244:247], v[16:19], v[248:251]
    buffer_load_dwordx4 v107, s[16:19], s53 offen offset:3072 lds
    v_mfma_f32_16x16x32_bf16 v[252:255], v[244:247], v[20:23], v[252:255]
    s_add_u32 m0, s66, 84480
    s_waitcnt lgkmcnt(4)
    v_mfma_f32_16x16x32_bf16 v[40:43], v[24:27], a[32:35], v[40:43]
    v_mov_b32 v240, s10
    v_mov_b32 v241, s10
    v_mfma_f32_16x16x32_bf16 v[44:47], v[24:27], a[36:39], v[44:47]
    ds_read_b64_tr_b16 v[16:17], v7 offset:25344
    s_add_u32 s68, s45, 0
    v_mfma_f32_16x16x32_bf16 v[48:51], v[24:27], a[40:43], v[48:51]
    ds_read_b128 a[52:55], v109 offset:35840
    v_mov_b32 v242, s10
    v_mov_b32 v243, s10
    v_mfma_f32_16x16x32_bf16 v[52:55], v[24:27], a[44:47], v[52:55]
    ds_read_b64_tr_b16 v[18:19], v7 offset:25600
    ds_read_b128 a[56:59], v109 offset:37888
    v_mfma_f32_16x16x32_bf16 v[68:71], v[28:31], a[44:47], v[68:71]
    buffer_load_dwordx4 v3, s[20:23], s68 offen offset:0 lds
    v_mfma_f32_16x16x32_bf16 v[64:67], v[28:31], a[40:43], v[64:67]
    ds_read_b64_tr_b16 v[20:21], v7 offset:25376
    v_mfma_f32_16x16x32_bf16 v[60:63], v[28:31], a[36:39], v[60:63]
    ds_read_b128 a[60:63], v109 offset:39936
    v_mfma_f32_16x16x32_bf16 v[56:59], v[28:31], a[32:35], v[56:59]
    ds_read_b64_tr_b16 v[22:23], v7 offset:25632
    v_mfma_f32_16x16x32_bf16 v[248:251], v[240:243], v[24:27], v[248:251]
    buffer_load_dwordx4 v4, s[20:23], s68 offen offset:1056 lds
    v_mfma_f32_16x16x32_bf16 v[252:255], v[240:243], v[28:31], v[252:255]
    s_waitcnt lgkmcnt(7)
    v_mfma_f32_16x16x32_bf16 v[72:75], v[32:35], a[32:35], v[72:75]
    v_mov_b32 v244, s11
    v_mov_b32 v245, s11
    v_mfma_f32_16x16x32_bf16 v[76:79], v[32:35], a[36:39], v[76:79]
    ds_read_b64_tr_b16 v[24:25], v7 offset:29568
    v_mfma_f32_16x16x32_bf16 v[80:83], v[32:35], a[40:43], v[80:83]
    v_mov_b32 v246, s11
    v_mov_b32 v247, s11
    v_mfma_f32_16x16x32_bf16 v[84:87], v[32:35], a[44:47], v[84:87]
    ds_read_b64_tr_b16 v[26:27], v7 offset:29824
    v_mfma_f32_16x16x32_bf16 v[100:103], v[36:39], a[44:47], v[100:103]
    buffer_load_dwordx4 v5, s[20:23], s68 offen offset:2112 lds
    v_mfma_f32_16x16x32_bf16 v[96:99], v[36:39], a[40:43], v[96:99]
    ds_read_b64_tr_b16 v[28:29], v7 offset:29600
    v_mfma_f32_16x16x32_bf16 v[92:95], v[36:39], a[36:39], v[92:95]
    v_mfma_f32_16x16x32_bf16 v[88:91], v[36:39], a[32:35], v[88:91]
    ds_read_b64_tr_b16 v[30:31], v7 offset:29856
    v_mfma_f32_16x16x32_bf16 v[248:251], v[244:247], v[32:35], v[248:251]
    buffer_load_dwordx4 v6, s[20:23], s68 offen offset:3168 lds
    v_mfma_f32_16x16x32_bf16 v[252:255], v[244:247], v[36:39], v[252:255]
    s_waitcnt lgkmcnt(4)
    v_mfma_f32_16x16x32_bf16 v[40:43], v[16:19], a[48:51], v[40:43]
    s_waitcnt vmcnt(16)
    s_barrier
    v_mfma_f32_16x16x32_bf16 v[44:47], v[16:19], a[52:55], v[44:47]
    ds_read_b64_tr_b16 v[32:33], v7 offset:33792
    s_add_u32 m0, s67, 118272
    v_mfma_f32_16x16x32_bf16 v[48:51], v[16:19], a[56:59], v[48:51]
    ds_read_b128 a[64:67], v108 offset:50688
    s_nop 0
    v_mfma_f32_16x16x32_bf16 v[52:55], v[16:19], a[60:63], v[52:55]
    ds_read_b64_tr_b16 v[34:35], v7 offset:34048
    ds_read_b128 a[68:71], v108 offset:52736
    v_mfma_f32_16x16x32_bf16 v[68:71], v[20:23], a[60:63], v[68:71]
    buffer_load_dwordx4 v104, s[16:19], s54 offen offset:0 lds
    v_mfma_f32_16x16x32_bf16 v[64:67], v[20:23], a[56:59], v[64:67]
    ds_read_b64_tr_b16 v[36:37], v7 offset:33824
    v_mfma_f32_16x16x32_bf16 v[60:63], v[20:23], a[52:55], v[60:63]
    ds_read_b128 a[72:75], v108 offset:54784
    v_mfma_f32_16x16x32_bf16 v[56:59], v[20:23], a[48:51], v[56:59]
    ds_read_b64_tr_b16 v[38:39], v7 offset:34080
    v_mfma_f32_16x16x32_bf16 v[248:251], v[240:243], v[16:19], v[248:251]
    buffer_load_dwordx4 v105, s[16:19], s54 offen offset:1024 lds
    v_mfma_f32_16x16x32_bf16 v[252:255], v[240:243], v[20:23], v[252:255]
    s_waitcnt lgkmcnt(7)
    v_mfma_f32_16x16x32_bf16 v[72:75], v[24:27], a[48:51], v[72:75]
    v_mfma_f32_16x16x32_bf16 v[76:79], v[24:27], a[52:55], v[76:79]
    ds_read_b64_tr_b16 v[16:17], v7 offset:38016
    v_mfma_f32_16x16x32_bf16 v[80:83], v[24:27], a[56:59], v[80:83]
    ds_read_b128 a[76:79], v108 offset:56832
    v_mfma_f32_16x16x32_bf16 v[84:87], v[24:27], a[60:63], v[84:87]
    ds_read_b64_tr_b16 v[18:19], v7 offset:38272
    v_mfma_f32_16x16x32_bf16 v[100:103], v[28:31], a[60:63], v[100:103]
    buffer_load_dwordx4 v106, s[16:19], s54 offen offset:2048 lds
    v_mfma_f32_16x16x32_bf16 v[96:99], v[28:31], a[56:59], v[96:99]
    ds_read_b64_tr_b16 v[20:21], v7 offset:38048
    v_mfma_f32_16x16x32_bf16 v[92:95], v[28:31], a[52:55], v[92:95]
    ds_read_b128 a[80:83], v109 offset:50688
    v_mfma_f32_16x16x32_bf16 v[88:91], v[28:31], a[48:51], v[88:91]
    ds_read_b64_tr_b16 v[22:23], v7 offset:38304
    v_mfma_f32_16x16x32_bf16 v[248:251], v[244:247], v[24:27], v[248:251]
    buffer_load_dwordx4 v107, s[16:19], s54 offen offset:3072 lds
    v_mfma_f32_16x16x32_bf16 v[252:255], v[244:247], v[28:31], v[252:255]
    s_add_u32 m0, s66, 0
    s_waitcnt lgkmcnt(4)
    v_mfma_f32_16x16x32_bf16 v[40:43], v[32:35], a[64:67], v[40:43]
    s_add_u32 s68, s46, 0
    v_mfma_f32_16x16x32_bf16 v[44:47], v[32:35], a[68:71], v[44:47]
    ds_read_b64_tr_b16 v[24:25], v7 offset:42240
    v_mfma_f32_16x16x32_bf16 v[48:51], v[32:35], a[72:75], v[48:51]
    ds_read_b128 a[84:87], v109 offset:52736
    v_mfma_f32_16x16x32_bf16 v[52:55], v[32:35], a[76:79], v[52:55]
    ds_read_b64_tr_b16 v[26:27], v7 offset:42496
    ds_read_b128 a[88:91], v109 offset:54784
    v_mfma_f32_16x16x32_bf16 v[68:71], v[36:39], a[76:79], v[68:71]
    v_cvt_pk_bf16_f32 v249, v248, v248
    v_lshlrev_b32 v249, 16, v249
    v_mfma_f32_16x16x32_bf16 v[64:67], v[36:39], a[72:75], v[64:67]
    ds_read_b64_tr_b16 v[28:29], v7 offset:42272
    v_sub_f32 v248, v248, v249
    v_mfma_f32_16x16x32_bf16 v[60:63], v[36:39], a[68:71], v[60:63]
    ds_read_b128 a[92:95], v109 offset:56832
    v_cvt_pk_bf16_f32 v240, v249, v248
    v_mfma_f32_16x16x32_bf16 v[56:59], v[36:39], a[64:67], v[56:59]
    ds_read_b64_tr_b16 v[30:31], v7 offset:42528
    s_waitcnt lgkmcnt(7)
    v_mfma_f32_16x16x32_bf16 v[72:75], v[16:19], a[64:67], v[72:75]
    v_cvt_pk_bf16_f32 v253, v252, v252
    v_lshlrev_b32 v253, 16, v253
    v_mfma_f32_16x16x32_bf16 v[76:79], v[16:19], a[68:71], v[76:79]
    ds_read_b64_tr_b16 v[32:33], v7 offset:46464
    v_sub_f32 v252, v252, v253
    v_mfma_f32_16x16x32_bf16 v[80:83], v[16:19], a[72:75], v[80:83]
    v_cvt_pk_bf16_f32 v241, v253, v252
    v_mov_b32 v242, s1
    v_mfma_f32_16x16x32_bf16 v[84:87], v[16:19], a[76:79], v[84:87]
    ds_read_b64_tr_b16 v[34:35], v7 offset:46720
    s_add_u32 s14, s73, 0
    v_mfma_f32_16x16x32_bf16 v[100:103], v[20:23], a[76:79], v[100:103]
    s_mov_b64 exec, 0xffff
    buffer_store_dwordx4 v[240:243], v11, s[28:31], s14 offen sc1
    s_mov_b64 exec, -1
    v_mfma_f32_16x16x32_bf16 v[96:99], v[20:23], a[72:75], v[96:99]
    ds_read_b64_tr_b16 v[36:37], v7 offset:46496
    v_mfma_f32_16x16x32_bf16 v[92:95], v[20:23], a[68:71], v[92:95]
    v_mfma_f32_16x16x32_bf16 v[88:91], v[20:23], a[64:67], v[88:91]
    ds_read_b64_tr_b16 v[38:39], v7 offset:46752
    s_waitcnt lgkmcnt(4)
    buffer_load_dwordx4 v3, s[20:23], s68 offen offset:0 lds
    buffer_load_dwordx4 v4, s[20:23], s68 offen offset:1056 lds
    buffer_load_dwordx4 v5, s[20:23], s68 offen offset:2112 lds
    buffer_load_dwordx4 v6, s[20:23], s68 offen offset:3168 lds
    v_mfma_f32_16x16x32_bf16 v[40:43], v[24:27], a[80:83], v[40:43]
    s_waitcnt vmcnt(13)
    s_barrier
    v_mfma_f32_16x16x32_bf16 v[44:47], v[24:27], a[84:87], v[44:47]
    ds_read_b64_tr_b16 v[16:17], v7 offset:50688
    s_add_u32 m0, s67, 135168
    v_mfma_f32_16x16x32_bf16 v[48:51], v[24:27], a[88:91], v[48:51]
    ds_read_b128 a[96:99], v108 offset:16896
    s_nop 0
    v_mfma_f32_16x16x32_bf16 v[52:55], v[24:27], a[92:95], v[52:55]
    ds_read_b64_tr_b16 v[18:19], v7 offset:50944
    ds_read_b128 a[100:103], v108 offset:18944
    v_mfma_f32_16x16x32_bf16 v[68:71], v[28:31], a[92:95], v[68:71]
    buffer_load_dwordx4 v104, s[16:19], s55 offen offset:0 lds
    v_mfma_f32_16x16x32_bf16 v[64:67], v[28:31], a[88:91], v[64:67]
    ds_read_b64_tr_b16 v[20:21], v7 offset:50720
    v_mfma_f32_16x16x32_bf16 v[60:63], v[28:31], a[84:87], v[60:63]
    ds_read_b128 a[104:107], v108 offset:20992
    v_mfma_f32_16x16x32_bf16 v[56:59], v[28:31], a[80:83], v[56:59]
    ds_read_b64_tr_b16 v[22:23], v7 offset:50976
    s_waitcnt lgkmcnt(7)
    v_mfma_f32_16x16x32_bf16 v[72:75], v[32:35], a[80:83], v[72:75]
    buffer_load_dwordx4 v105, s[16:19], s55 offen offset:1024 lds
    v_mfma_f32_16x16x32_bf16 v[76:79], v[32:35], a[84:87], v[76:79]
    ds_read_b64_tr_b16 v[24:25], v7 offset:54912
    v_mfma_f32_16x16x32_bf16 v[80:83], v[32:35], a[88:91], v[80:83]
    ds_read_b128 a[108:111], v108 offset:23040
    v_mfma_f32_16x16x32_bf16 v[84:87], v[32:35], a[92:95], v[84:87]
    ds_read_b64_tr_b16 v[26:27], v7 offset:55168
    v_mfma_f32_16x16x32_bf16 v[100:103], v[36:39], a[92:95], v[100:103]
    buffer_load_dwordx4 v106, s[16:19], s55 offen offset:2048 lds
    v_mfma_f32_16x16x32_bf16 v[96:99], v[36:39], a[88:91], v[96:99]
    ds_read_b64_tr_b16 v[28:29], v7 offset:54944
    v_mfma_f32_16x16x32_bf16 v[92:95], v[36:39], a[84:87], v[92:95]
    ds_read_b128 a[112:115], v109 offset:16896
    v_mfma_f32_16x16x32_bf16 v[88:91], v[36:39], a[80:83], v[88:91]
    ds_read_b64_tr_b16 v[30:31], v7 offset:55200
    s_waitcnt lgkmcnt(4)
    v_mfma_f32_16x16x32_bf16 v[40:43], v[16:19], a[96:99], v[40:43]
    buffer_load_dwordx4 v107, s[16:19], s55 offen offset:3072 lds
    v_mfma_f32_16x16x32_bf16 v[44:47], v[16:19], a[100:103], v[44:47]
    ds_read_b64_tr_b16 v[32:33], v7 offset:59136
    s_add_u32 m0, s66, 16896
    v_mfma_f32_16x16x32_bf16 v[48:51], v[16:19], a[104:107], v[48:51]
    ds_read_b128 a[116:119], v109 offset:18944
    s_add_u32 s68, s47, 0
    v_mfma_f32_16x16x32_bf16 v[52:55], v[16:19], a[108:111], v[52:55]
    ds_read_b64_tr_b16 v[34:35], v7 offset:59392
    ds_read_b128 a[120:123], v109 offset:20992
    v_mfma_f32_16x16x32_bf16 v[68:71], v[20:23], a[108:111], v[68:71]
    buffer_load_dwordx4 v3, s[20:23], s68 offen offset:0 lds
    v_mfma_f32_16x16x32_bf16 v[64:67], v[20:23], a[104:107], v[64:67]
    ds_read_b64_tr_b16 v[36:37], v7 offset:59168
    v_mfma_f32_16x16x32_bf16 v[60:63], v[20:23], a[100:103], v[60:63]
    ds_read_b128 a[124:127], v109 offset:23040
    v_mfma_f32_16x16x32_bf16 v[56:59], v[20:23], a[96:99], v[56:59]
    ds_read_b64_tr_b16 v[38:39], v7 offset:59424
    s_waitcnt lgkmcnt(7)
    v_mfma_f32_16x16x32_bf16 v[72:75], v[24:27], a[96:99], v[72:75]
    buffer_load_dwordx4 v4, s[20:23], s68 offen offset:1056 lds
    v_mfma_f32_16x16x32_bf16 v[76:79], v[24:27], a[100:103], v[76:79]
    ds_read_b64_tr_b16 v[16:17], v7 offset:63360
    v_mfma_f32_16x16x32_bf16 v[80:83], v[24:27], a[104:107], v[80:83]
    v_mfma_f32_16x16x32_bf16 v[84:87], v[24:27], a[108:111], v[84:87]
    ds_read_b64_tr_b16 v[18:19], v7 offset:63616
    v_mfma_f32_16x16x32_bf16 v[100:103], v[28:31], a[108:111], v[100:103]
    buffer_load_dwordx4 v5, s[20:23], s68 offen offset:2112 lds
    v_mfma_f32_16x16x32_bf16 v[96:99], v[28:31], a[104:107], v[96:99]
    ds_read_b64_tr_b16 v[20:21], v7 offset:63392
    v_mfma_f32_16x16x32_bf16 v[92:95], v[28:31], a[100:103], v[92:95]
    v_mfma_f32_16x16x32_bf16 v[88:91], v[28:31], a[96:99], v[88:91]
    ds_read_b64_tr_b16 v[22:23], v7 offset:63648
    s_waitcnt lgkmcnt(4)
    buffer_load_dwordx4 v6, s[20:23], s68 offen offset:3168 lds
    buffer_load_dwordx2 v[128:129], v110, s[28:31], s75 offen offset:0 sc1
    v_mfma_f32_16x16x32_bf16 v[40:43], v[32:35], a[112:115], v[40:43]
    s_waitcnt vmcnt(14)
    s_barrier
    v_mfma_f32_16x16x32_bf16 v[44:47], v[32:35], a[116:119], v[44:47]
    ds_read_b64_tr_b16 v[24:25], v8 offset:0
    s_add_u32 m0, s67, 101376
    v_mfma_f32_16x16x32_bf16 v[48:51], v[32:35], a[120:123], v[48:51]
    ds_read_b128 a[128:131], v108 offset:33792
    s_nop 0
    v_mfma_f32_16x16x32_bf16 v[52:55], v[32:35], a[124:127], v[52:55]
    ds_read_b64_tr_b16 v[26:27], v8 offset:256
    ds_read_b128 a[132:135], v108 offset:35840
    v_mfma_f32_16x16x32_bf16 v[68:71], v[36:39], a[124:127], v[68:71]
    buffer_load_dwordx4 v104, s[16:19], s56 offen offset:0 lds
    v_mfma_f32_16x16x32_bf16 v[64:67], v[36:39], a[120:123], v[64:67]
    ds_read_b64_tr_b16 v[28:29], v8 offset:32
    v_mfma_f32_16x16x32_bf16 v[60:63], v[36:39], a[116:119], v[60:63]
    ds_read_b128 a[136:139], v108 offset:37888
    v_mfma_f32_16x16x32_bf16 v[56:59], v[36:39], a[112:115], v[56:59]
    ds_read_b64_tr_b16 v[30:31], v8 offset:288
    s_waitcnt lgkmcnt(7)
    v_mfma_f32_16x16x32_bf16 v[72:75], v[16:19], a[112:115], v[72:75]
    buffer_load_dwordx4 v105, s[16:19], s56 offen offset:1024 lds
    v_mfma_f32_16x16x32_bf16 v[76:79], v[16:19], a[116:119], v[76:79]
    ds_read_b64_tr_b16 v[32:33], v8 offset:4224
    v_mfma_f32_16x16x32_bf16 v[80:83], v[16:19], a[120:123], v[80:83]
    ds_read_b128 a[140:143], v108 offset:39936
    v_mfma_f32_16x16x32_bf16 v[84:87], v[16:19], a[124:127], v[84:87]
    ds_read_b64_tr_b16 v[34:35], v8 offset:4480
    v_mfma_f32_16x16x32_bf16 v[100:103], v[20:23], a[124:127], v[100:103]
    buffer_load_dwordx4 v106, s[16:19], s56 offen offset:2048 lds
    v_mfma_f32_16x16x32_bf16 v[96:99], v[20:23], a[120:123], v[96:99]
    ds_read_b64_tr_b16 v[36:37], v8 offset:4256
    v_mfma_f32_16x16x32_bf16 v[92:95], v[20:23], a[116:119], v[92:95]
    ds_read_b128 a[144:147], v109 offset:33792
    v_mfma_f32_16x16x32_bf16 v[88:91], v[20:23], a[112:115], v[88:91]
    ds_read_b64_tr_b16 v[38:39], v8 offset:4512
    s_waitcnt lgkmcnt(4)
    v_mfma_f32_16x16x32_bf16 v[40:43], v[24:27], a[128:131], v[40:43]
    buffer_load_dwordx4 v107, s[16:19], s56 offen offset:3072 lds
    v_mfma_f32_16x16x32_bf16 v[44:47], v[24:27], a[132:135], v[44:47]
    ds_read_b64_tr_b16 v[16:17], v8 offset:8448
    s_add_u32 m0, s66, 33792
    v_mfma_f32_16x16x32_bf16 v[48:51], v[24:27], a[136:139], v[48:51]
    ds_read_b128 a[148:151], v109 offset:35840
    s_add_u32 s68, s48, 0
    v_mfma_f32_16x16x32_bf16 v[52:55], v[24:27], a[140:143], v[52:55]
    ds_read_b64_tr_b16 v[18:19], v8 offset:8704
    ds_read_b128 a[152:155], v109 offset:37888
    v_mfma_f32_16x16x32_bf16 v[68:71], v[28:31], a[140:143], v[68:71]
    buffer_load_dwordx4 v3, s[20:23], s68 offen offset:0 lds
    v_mfma_f32_16x16x32_bf16 v[64:67], v[28:31], a[136:139], v[64:67]
    ds_read_b64_tr_b16 v[20:21], v8 offset:8480
    v_mfma_f32_16x16x32_bf16 v[60:63], v[28:31], a[132:135], v[60:63]
    ds_read_b128 a[156:159], v109 offset:39936
    v_mfma_f32_16x16x32_bf16 v[56:59], v[28:31], a[128:131], v[56:59]
    ds_read_b64_tr_b16 v[22:23], v8 offset:8736
    s_waitcnt lgkmcnt(7)
    v_mfma_f32_16x16x32_bf16 v[72:75], v[32:35], a[128:131], v[72:75]
    buffer_load_dwordx4 v4, s[20:23], s68 offen offset:1056 lds
    v_mfma_f32_16x16x32_bf16 v[76:79], v[32:35], a[132:135], v[76:79]
    ds_read_b64_tr_b16 v[24:25], v8 offset:12672
    v_mfma_f32_16x16x32_bf16 v[80:83], v[32:35], a[136:139], v[80:83]
    v_mfma_f32_16x16x32_bf16 v[84:87], v[32:35], a[140:143], v[84:87]
    ds_read_b64_tr_b16 v[26:27], v8 offset:12928
    v_mfma_f32_16x16x32_bf16 v[100:103], v[36:39], a[140:143], v[100:103]
    buffer_load_dwordx4 v5, s[20:23], s68 offen offset:2112 lds
    v_mfma_f32_16x16x32_bf16 v[96:99], v[36:39], a[136:139], v[96:99]
    ds_read_b64_tr_b16 v[28:29], v8 offset:12704
    v_mfma_f32_16x16x32_bf16 v[92:95], v[36:39], a[132:135], v[92:95]
    v_mfma_f32_16x16x32_bf16 v[88:91], v[36:39], a[128:131], v[88:91]
    ds_read_b64_tr_b16 v[30:31], v8 offset:12960
    s_waitcnt lgkmcnt(4)
    buffer_load_dwordx4 v6, s[20:23], s68 offen offset:3168 lds
    buffer_load_dwordx2 v[130:131], v110, s[28:31], s75 offen offset:128 sc1
    v_mfma_f32_16x16x32_bf16 v[40:43], v[16:19], a[144:147], v[40:43]
    s_waitcnt vmcnt(14)
    s_barrier
    v_mfma_f32_16x16x32_bf16 v[44:47], v[16:19], a[148:151], v[44:47]
    ds_read_b64_tr_b16 v[32:33], v8 offset:16896
    s_add_u32 m0, s67, 118272
    v_mfma_f32_16x16x32_bf16 v[48:51], v[16:19], a[152:155], v[48:51]
    ds_read_b128 a[160:163], v108 offset:50688
    s_nop 0
    v_mfma_f32_16x16x32_bf16 v[52:55], v[16:19], a[156:159], v[52:55]
    ds_read_b64_tr_b16 v[34:35], v8 offset:17152
    ds_read_b128 a[164:167], v108 offset:52736
    v_mfma_f32_16x16x32_bf16 v[68:71], v[20:23], a[156:159], v[68:71]
    buffer_load_dwordx4 v104, s[16:19], s57 offen offset:0 lds
    v_mfma_f32_16x16x32_bf16 v[64:67], v[20:23], a[152:155], v[64:67]
    ds_read_b64_tr_b16 v[36:37], v8 offset:16928
    v_mfma_f32_16x16x32_bf16 v[60:63], v[20:23], a[148:151], v[60:63]
    ds_read_b128 a[168:171], v108 offset:54784
    v_mfma_f32_16x16x32_bf16 v[56:59], v[20:23], a[144:147], v[56:59]
    ds_read_b64_tr_b16 v[38:39], v8 offset:17184
    s_waitcnt lgkmcnt(7)
    v_mfma_f32_16x16x32_bf16 v[72:75], v[24:27], a[144:147], v[72:75]
    buffer_load_dwordx4 v105, s[16:19], s57 offen offset:1024 lds
    v_mfma_f32_16x16x32_bf16 v[76:79], v[24:27], a[148:151], v[76:79]
    ds_read_b64_tr_b16 v[16:17], v8 offset:21120
    v_mfma_f32_16x16x32_bf16 v[80:83], v[24:27], a[152:155], v[80:83]
    ds_read_b128 a[172:175], v108 offset:56832
    v_mfma_f32_16x16x32_bf16 v[84:87], v[24:27], a[156:159], v[84:87]
    ds_read_b64_tr_b16 v[18:19], v8 offset:21376
    v_mfma_f32_16x16x32_bf16 v[100:103], v[28:31], a[156:159], v[100:103]
    buffer_load_dwordx4 v106, s[16:19], s57 offen offset:2048 lds
    v_mfma_f32_16x16x32_bf16 v[96:99], v[28:31], a[152:155], v[96:99]
    ds_read_b64_tr_b16 v[20:21], v8 offset:21152
    v_mfma_f32_16x16x32_bf16 v[92:95], v[28:31], a[148:151], v[92:95]
    ds_read_b128 a[176:179], v109 offset:50688
    v_mfma_f32_16x16x32_bf16 v[88:91], v[28:31], a[144:147], v[88:91]
    ds_read_b64_tr_b16 v[22:23], v8 offset:21408
    s_waitcnt lgkmcnt(4)
    v_mfma_f32_16x16x32_bf16 v[40:43], v[32:35], a[160:163], v[40:43]
    buffer_load_dwordx4 v107, s[16:19], s57 offen offset:3072 lds
    v_mfma_f32_16x16x32_bf16 v[44:47], v[32:35], a[164:167], v[44:47]
    ds_read_b64_tr_b16 v[24:25], v8 offset:25344
    s_add_u32 m0, s66, 50688
    v_mfma_f32_16x16x32_bf16 v[48:51], v[32:35], a[168:171], v[48:51]
    ds_read_b128 a[180:183], v109 offset:52736
    s_add_u32 s68, s49, 0
    v_mfma_f32_16x16x32_bf16 v[52:55], v[32:35], a[172:175], v[52:55]
    ds_read_b64_tr_b16 v[26:27], v8 offset:25600
    ds_read_b128 a[184:187], v109 offset:54784
    v_mfma_f32_16x16x32_bf16 v[68:71], v[36:39], a[172:175], v[68:71]
    buffer_load_dwordx4 v3, s[20:23], s68 offen offset:0 lds
    v_mfma_f32_16x16x32_bf16 v[64:67], v[36:39], a[168:171], v[64:67]
    ds_read_b64_tr_b16 v[28:29], v8 offset:25376
    v_mfma_f32_16x16x32_bf16 v[60:63], v[36:39], a[164:167], v[60:63]
    ds_read_b128 a[188:191], v109 offset:56832
    v_mfma_f32_16x16x32_bf16 v[56:59], v[36:39], a[160:163], v[56:59]
    ds_read_b64_tr_b16 v[30:31], v8 offset:25632
    s_waitcnt lgkmcnt(7)
    v_mfma_f32_16x16x32_bf16 v[72:75], v[16:19], a[160:163], v[72:75]
    buffer_load_dwordx4 v4, s[20:23], s68 offen offset:1056 lds
    v_mfma_f32_16x16x32_bf16 v[76:79], v[16:19], a[164:167], v[76:79]
    ds_read_b64_tr_b16 v[32:33], v8 offset:29568
    v_mfma_f32_16x16x32_bf16 v[80:83], v[16:19], a[168:171], v[80:83]
    v_mfma_f32_16x16x32_bf16 v[84:87], v[16:19], a[172:175], v[84:87]
    ds_read_b64_tr_b16 v[34:35], v8 offset:29824
    v_mfma_f32_16x16x32_bf16 v[100:103], v[20:23], a[172:175], v[100:103]
    buffer_load_dwordx4 v5, s[20:23], s68 offen offset:2112 lds
    v_mfma_f32_16x16x32_bf16 v[96:99], v[20:23], a[168:171], v[96:99]
    ds_read_b64_tr_b16 v[36:37], v8 offset:29600
    v_mfma_f32_16x16x32_bf16 v[92:95], v[20:23], a[164:167], v[92:95]
    v_mfma_f32_16x16x32_bf16 v[88:91], v[20:23], a[160:163], v[88:91]
    ds_read_b64_tr_b16 v[38:39], v8 offset:29856
    s_waitcnt lgkmcnt(4)
    buffer_load_dwordx4 v6, s[20:23], s68 offen offset:3168 lds
    buffer_load_dwordx2 v[132:133], v110, s[28:31], s75 offen offset:256 sc1
    v_mfma_f32_16x16x32_bf16 v[40:43], v[24:27], a[176:179], v[40:43]
    s_waitcnt vmcnt(14)
    s_barrier
    v_mfma_f32_16x16x32_bf16 v[44:47], v[24:27], a[180:183], v[44:47]
    ds_read_b64_tr_b16 v[16:17], v7 offset:0
    s_add_u32 m0, s67, 135168
    v_mfma_f32_16x16x32_bf16 v[48:51], v[24:27], a[184:187], v[48:51]
    ds_read_b128 a[192:195], v108 offset:16896
    s_nop 0
    v_mfma_f32_16x16x32_bf16 v[52:55], v[24:27], a[188:191], v[52:55]
    ds_read_b64_tr_b16 v[18:19], v7 offset:256
    ds_read_b128 a[196:199], v108 offset:18944
    v_mfma_f32_16x16x32_bf16 v[68:71], v[28:31], a[188:191], v[68:71]
    buffer_load_dwordx4 v104, s[16:19], s58 offen offset:0 lds
    v_mfma_f32_16x16x32_bf16 v[64:67], v[28:31], a[184:187], v[64:67]
    ds_read_b64_tr_b16 v[20:21], v7 offset:32
    v_mfma_f32_16x16x32_bf16 v[60:63], v[28:31], a[180:183], v[60:63]
    ds_read_b128 a[200:203], v108 offset:20992
    v_mfma_f32_16x16x32_bf16 v[56:59], v[28:31], a[176:179], v[56:59]
    ds_read_b64_tr_b16 v[22:23], v7 offset:288
    s_waitcnt lgkmcnt(7)
    v_mfma_f32_16x16x32_bf16 v[72:75], v[32:35], a[176:179], v[72:75]
    buffer_load_dwordx4 v105, s[16:19], s58 offen offset:1024 lds
    v_mfma_f32_16x16x32_bf16 v[76:79], v[32:35], a[180:183], v[76:79]
    ds_read_b64_tr_b16 v[24:25], v7 offset:4224
    v_mfma_f32_16x16x32_bf16 v[80:83], v[32:35], a[184:187], v[80:83]
    ds_read_b128 a[204:207], v108 offset:23040
    v_mfma_f32_16x16x32_bf16 v[84:87], v[32:35], a[188:191], v[84:87]
    ds_read_b64_tr_b16 v[26:27], v7 offset:4480
    v_mfma_f32_16x16x32_bf16 v[100:103], v[36:39], a[188:191], v[100:103]
    buffer_load_dwordx4 v106, s[16:19], s58 offen offset:2048 lds
    v_mfma_f32_16x16x32_bf16 v[96:99], v[36:39], a[184:187], v[96:99]
    ds_read_b64_tr_b16 v[28:29], v7 offset:4256
    v_mfma_f32_16x16x32_bf16 v[92:95], v[36:39], a[180:183], v[92:95]
    ds_read_b128 a[208:211], v109 offset:16896
    v_mfma_f32_16x16x32_bf16 v[88:91], v[36:39], a[176:179], v[88:91]
    ds_read_b64_tr_b16 v[30:31], v7 offset:4512
    s_waitcnt lgkmcnt(4)
    v_mfma_f32_16x16x32_bf16 v[40:43], v[16:19], a[192:195], v[40:43]
    buffer_load_dwordx4 v107, s[16:19], s58 offen offset:3072 lds
    v_mfma_f32_16x16x32_bf16 v[44:47], v[16:19], a[196:199], v[44:47]
    ds_read_b64_tr_b16 v[32:33], v7 offset:8448
    s_add_u32 m0, s66, 67584
    v_mfma_f32_16x16x32_bf16 v[48:51], v[16:19], a[200:203], v[48:51]
    ds_read_b128 a[212:215], v109 offset:18944
    s_add_u32 s68, s40, 128
    v_mfma_f32_16x16x32_bf16 v[52:55], v[16:19], a[204:207], v[52:55]
    ds_read_b64_tr_b16 v[34:35], v7 offset:8704
    ds_read_b128 a[216:219], v109 offset:20992
    v_mfma_f32_16x16x32_bf16 v[68:71], v[20:23], a[204:207], v[68:71]
    buffer_load_dwordx4 v3, s[20:23], s68 offen offset:0 lds
    v_mfma_f32_16x16x32_bf16 v[64:67], v[20:23], a[200:203], v[64:67]
    ds_read_b64_tr_b16 v[36:37], v7 offset:8480
    v_mfma_f32_16x16x32_bf16 v[60:63], v[20:23], a[196:199], v[60:63]
    ds_read_b128 a[220:223], v109 offset:23040
    v_mfma_f32_16x16x32_bf16 v[56:59], v[20:23], a[192:195], v[56:59]
    ds_read_b64_tr_b16 v[38:39], v7 offset:8736
    s_waitcnt lgkmcnt(7)
    v_mfma_f32_16x16x32_bf16 v[72:75], v[24:27], a[192:195], v[72:75]
    buffer_load_dwordx4 v4, s[20:23], s68 offen offset:1056 lds
    v_mfma_f32_16x16x32_bf16 v[76:79], v[24:27], a[196:199], v[76:79]
    ds_read_b64_tr_b16 v[16:17], v7 offset:12672
    v_mfma_f32_16x16x32_bf16 v[80:83], v[24:27], a[200:203], v[80:83]
    v_mfma_f32_16x16x32_bf16 v[84:87], v[24:27], a[204:207], v[84:87]
    ds_read_b64_tr_b16 v[18:19], v7 offset:12928
    v_mfma_f32_16x16x32_bf16 v[100:103], v[28:31], a[204:207], v[100:103]
    buffer_load_dwordx4 v5, s[20:23], s68 offen offset:2112 lds
    v_mfma_f32_16x16x32_bf16 v[96:99], v[28:31], a[200:203], v[96:99]
    ds_read_b64_tr_b16 v[20:21], v7 offset:12704
    v_mfma_f32_16x16x32_bf16 v[92:95], v[28:31], a[196:199], v[92:95]
    v_mfma_f32_16x16x32_bf16 v[88:91], v[28:31], a[192:195], v[88:91]
    ds_read_b64_tr_b16 v[22:23], v7 offset:12960
    s_waitcnt lgkmcnt(4)
    buffer_load_dwordx4 v6, s[20:23], s68 offen offset:3168 lds
    buffer_load_dwordx2 v[134:135], v110, s[28:31], s75 offen offset:384 sc1
    v_mfma_f32_16x16x32_bf16 v[40:43], v[32:35], a[208:211], v[40:43]
    s_waitcnt vmcnt(14)
    s_barrier
    v_mfma_f32_16x16x32_bf16 v[44:47], v[32:35], a[212:215], v[44:47]
    ds_read_b64_tr_b16 v[24:25], v7 offset:16896
    s_add_u32 m0, s67, 101376
    v_mfma_f32_16x16x32_bf16 v[48:51], v[32:35], a[216:219], v[48:51]
    ds_read_b128 a[224:227], v108 offset:33792
    s_nop 0
    v_mfma_f32_16x16x32_bf16 v[52:55], v[32:35], a[220:223], v[52:55]
    ds_read_b64_tr_b16 v[26:27], v7 offset:17152
    ds_read_b128 a[228:231], v108 offset:35840
    v_mfma_f32_16x16x32_bf16 v[68:71], v[36:39], a[220:223], v[68:71]
    buffer_load_dwordx4 v104, s[16:19], s59 offen offset:0 lds
    v_mfma_f32_16x16x32_bf16 v[64:67], v[36:39], a[216:219], v[64:67]
    ds_read_b64_tr_b16 v[28:29], v7 offset:16928
    v_mfma_f32_16x16x32_bf16 v[60:63], v[36:39], a[212:215], v[60:63]
    ds_read_b128 a[232:235], v108 offset:37888
    v_mfma_f32_16x16x32_bf16 v[56:59], v[36:39], a[208:211], v[56:59]
    ds_read_b64_tr_b16 v[30:31], v7 offset:17184
    s_waitcnt lgkmcnt(7)
    v_mfma_f32_16x16x32_bf16 v[72:75], v[16:19], a[208:211], v[72:75]
    buffer_load_dwordx4 v105, s[16:19], s59 offen offset:1024 lds
    v_mfma_f32_16x16x32_bf16 v[76:79], v[16:19], a[212:215], v[76:79]
    ds_read_b64_tr_b16 v[32:33], v7 offset:21120
    v_mfma_f32_16x16x32_bf16 v[80:83], v[16:19], a[216:219], v[80:83]
    ds_read_b128 a[236:239], v108 offset:39936
    v_mfma_f32_16x16x32_bf16 v[84:87], v[16:19], a[220:223], v[84:87]
    ds_read_b64_tr_b16 v[34:35], v7 offset:21376
    v_mfma_f32_16x16x32_bf16 v[100:103], v[20:23], a[220:223], v[100:103]
    buffer_load_dwordx4 v106, s[16:19], s59 offen offset:2048 lds
    v_mfma_f32_16x16x32_bf16 v[96:99], v[20:23], a[216:219], v[96:99]
    ds_read_b64_tr_b16 v[36:37], v7 offset:21152
    v_mfma_f32_16x16x32_bf16 v[92:95], v[20:23], a[212:215], v[92:95]
    ds_read_b128 a[240:243], v109 offset:33792
    v_mfma_f32_16x16x32_bf16 v[88:91], v[20:23], a[208:211], v[88:91]
    ds_read_b64_tr_b16 v[38:39], v7 offset:21408
    s_waitcnt lgkmcnt(4)
    v_mfma_f32_16x16x32_bf16 v[40:43], v[24:27], a[224:227], v[40:43]
    buffer_load_dwordx4 v107, s[16:19], s59 offen offset:3072 lds
    v_mfma_f32_16x16x32_bf16 v[44:47], v[24:27], a[228:231], v[44:47]
    ds_read_b64_tr_b16 v[16:17], v7 offset:25344
    s_add_u32 s15, s72, 0
    v_mfma_f32_16x16x32_bf16 v[48:51], v[24:27], a[232:235], v[48:51]
    ds_read_b128 a[244:247], v109 offset:35840
    v_mfma_f32_16x16x32_bf16 v[52:55], v[24:27], a[236:239], v[52:55]
    ds_read_b64_tr_b16 v[18:19], v7 offset:25600
    ds_read_b128 a[248:251], v109 offset:37888
    v_mfma_f32_16x16x32_bf16 v[68:71], v[28:31], a[236:239], v[68:71]
    buffer_load_dwordx4 v[240:243], v11, s[28:31], s15 offen offset:0 sc1
    v_mfma_f32_16x16x32_bf16 v[64:67], v[28:31], a[232:235], v[64:67]
    ds_read_b64_tr_b16 v[20:21], v7 offset:25376
    v_mfma_f32_16x16x32_bf16 v[60:63], v[28:31], a[228:231], v[60:63]
    ds_read_b128 a[252:255], v109 offset:39936
    v_mfma_f32_16x16x32_bf16 v[56:59], v[28:31], a[224:227], v[56:59]
    ds_read_b64_tr_b16 v[22:23], v7 offset:25632
    s_waitcnt lgkmcnt(7)
    v_mfma_f32_16x16x32_bf16 v[72:75], v[32:35], a[224:227], v[72:75]
    buffer_load_dwordx4 v[244:247], v11, s[28:31], s15 offen offset:1024 sc1
    v_mfma_f32_16x16x32_bf16 v[76:79], v[32:35], a[228:231], v[76:79]
    ds_read_b64_tr_b16 v[24:25], v7 offset:29568
    v_mfma_f32_16x16x32_bf16 v[80:83], v[32:35], a[232:235], v[80:83]
    v_mfma_f32_16x16x32_bf16 v[84:87], v[32:35], a[236:239], v[84:87]
    ds_read_b64_tr_b16 v[26:27], v7 offset:29824
    v_mfma_f32_16x16x32_bf16 v[100:103], v[36:39], a[236:239], v[100:103]
    buffer_load_dwordx4 v[248:251], v11, s[28:31], s15 offen offset:2048 sc1
    v_mfma_f32_16x16x32_bf16 v[96:99], v[36:39], a[232:235], v[96:99]
    ds_read_b64_tr_b16 v[28:29], v7 offset:29600
    v_mfma_f32_16x16x32_bf16 v[92:95], v[36:39], a[228:231], v[92:95]
    v_mfma_f32_16x16x32_bf16 v[88:91], v[36:39], a[224:227], v[88:91]
    ds_read_b64_tr_b16 v[30:31], v7 offset:29856
    s_waitcnt lgkmcnt(4)
    buffer_load_dwordx4 v[252:255], v11, s[28:31], s15 offen offset:3072 sc1
    v_mfma_f32_16x16x32_bf16 v[40:43], v[16:19], a[240:243], v[40:43]
    s_waitcnt vmcnt(13)
    s_barrier
    v_mfma_f32_16x16x32_bf16 v[44:47], v[16:19], a[244:247], v[44:47]
    ds_read_b64_tr_b16 v[32:33], v7 offset:33792
    s_add_u32 m0, s66, 84480
    v_mfma_f32_16x16x32_bf16 v[48:51], v[16:19], a[248:251], v[48:51]
    ds_read_b128 v[168:171], v108 offset:50688
    s_add_u32 s68, s41, 128
    v_mfma_f32_16x16x32_bf16 v[52:55], v[16:19], a[252:255], v[52:55]
    ds_read_b64_tr_b16 v[34:35], v7 offset:34048
    ds_read_b128 v[172:175], v108 offset:52736
    v_mfma_f32_16x16x32_bf16 v[68:71], v[20:23], a[252:255], v[68:71]
    buffer_load_dwordx4 v3, s[20:23], s68 offen offset:0 lds
    v_mfma_f32_16x16x32_bf16 v[64:67], v[20:23], a[248:251], v[64:67]
    ds_read_b64_tr_b16 v[36:37], v7 offset:33824
    v_mfma_f32_16x16x32_bf16 v[60:63], v[20:23], a[244:247], v[60:63]
    ds_read_b128 v[176:179], v108 offset:54784
    v_mfma_f32_16x16x32_bf16 v[56:59], v[20:23], a[240:243], v[56:59]
    ds_read_b64_tr_b16 v[38:39], v7 offset:34080
    s_waitcnt lgkmcnt(7)
    v_mfma_f32_16x16x32_bf16 v[72:75], v[24:27], a[240:243], v[72:75]
    buffer_load_dwordx4 v4, s[20:23], s68 offen offset:1056 lds
    v_mfma_f32_16x16x32_bf16 v[76:79], v[24:27], a[244:247], v[76:79]
    ds_read_b64_tr_b16 v[16:17], v7 offset:38016
    v_mfma_f32_16x16x32_bf16 v[80:83], v[24:27], a[248:251], v[80:83]
    ds_read_b128 v[180:183], v108 offset:56832
    v_mfma_f32_16x16x32_bf16 v[84:87], v[24:27], a[252:255], v[84:87]
    ds_read_b64_tr_b16 v[18:19], v7 offset:38272
    v_mfma_f32_16x16x32_bf16 v[100:103], v[28:31], a[252:255], v[100:103]
    buffer_load_dwordx4 v5, s[20:23], s68 offen offset:2112 lds
    v_mfma_f32_16x16x32_bf16 v[96:99], v[28:31], a[248:251], v[96:99]
    ds_read_b64_tr_b16 v[20:21], v7 offset:38048
    v_mfma_f32_16x16x32_bf16 v[92:95], v[28:31], a[244:247], v[92:95]
    ds_read_b128 v[184:187], v109 offset:50688
    v_mfma_f32_16x16x32_bf16 v[88:91], v[28:31], a[240:243], v[88:91]
    ds_read_b64_tr_b16 v[22:23], v7 offset:38304
    s_waitcnt lgkmcnt(4)
    v_mfma_f32_16x16x32_bf16 v[40:43], v[32:35], v[168:171], v[40:43]
    buffer_load_dwordx4 v6, s[20:23], s68 offen offset:3168 lds
    v_mfma_f32_16x16x32_bf16 v[44:47], v[32:35], v[172:175], v[44:47]
    ds_read_b64_tr_b16 v[24:25], v7 offset:42240
    s_waitcnt vmcnt(12)
    v_mfma_f32_16x16x32_bf16 v[48:51], v[32:35], v[176:179], v[48:51]
    ds_read_b128 v[188:191], v109 offset:52736
    v_xor_b32 v136, s1, v129
    v_mfma_f32_16x16x32_bf16 v[52:55], v[32:35], v[180:183], v[52:55]
    ds_read_b64_tr_b16 v[26:27], v7 offset:42496
    ds_read_b128 v[192:195], v109 offset:54784
    v_mfma_f32_16x16x32_bf16 v[68:71], v[36:39], v[180:183], v[68:71]
    v_bitop3_b32 v136, v131, s1, v136 bitop3:0xbe
    v_bitop3_b32 v136, v133, s1, v136 bitop3:0xbe
    v_mfma_f32_16x16x32_bf16 v[64:67], v[36:39], v[176:179], v[64:67]
    ds_read_b64_tr_b16 v[28:29], v7 offset:42272
    v_bitop3_b32 v136, v135, s1, v136 bitop3:0xbe
    v_mfma_f32_16x16x32_bf16 v[60:63], v[36:39], v[172:175], v[60:63]
    ds_read_b128 v[196:199], v109 offset:56832
    v_mfma_f32_16x16x32_bf16 v[56:59], v[36:39], v[168:171], v[56:59]
    ds_read_b64_tr_b16 v[30:31], v7 offset:42528
    s_waitcnt lgkmcnt(7)
    v_mfma_f32_16x16x32_bf16 v[72:75], v[16:19], v[168:171], v[72:75]
    v_cmp_ne_u32 vcc, 0, v136
    s_cmp_lg_u64 vcc, 0
    s_cbranch_scc1 STF_spin
STF_ok:
    v_mfma_f32_16x16x32_bf16 v[76:79], v[16:19], v[172:175], v[76:79]
    ds_read_b64_tr_b16 v[32:33], v7 offset:46464
    s_mov_b32 s14, 0x05040100
    v_mfma_f32_16x16x32_bf16 v[80:83], v[16:19], v[176:179], v[80:83]
    v_perm_b32 v0, v130, v128, s14
    v_perm_b32 v9, v134, v132, s14
    v_mfma_f32_16x16x32_bf16 v[84:87], v[16:19], v[180:183], v[84:87]
    ds_read_b64_tr_b16 v[34:35], v7 offset:46720
    v_and_b32 v128, 0xffff0000, v128
    v_mfma_f32_16x16x32_bf16 v[100:103], v[20:23], v[180:183], v[100:103]
    v_rcp_f32 v232, v128
    v_mfma_f32_16x16x32_bf16 v[96:99], v[20:23], v[176:179], v[96:99]
    ds_read_b64_tr_b16 v[36:37], v7 offset:46496
    v_mul_f32 v1, v128, v128
    v_mfma_f32_16x16x32_bf16 v[92:95], v[20:23], v[172:175], v[92:95]
    v_mul_f32 v236, v232, v232
    v_mul_f32 v232, 0xc0135761, v232
    v_mfma_f32_16x16x32_bf16 v[88:91], v[20:23], v[168:171], v[88:91]
    ds_read_b64_tr_b16 v[38:39], v7 offset:46752
    s_waitcnt lgkmcnt(4)
    v_mul_f32 v236, 0x3d372713, v236
    v_mul_f32 v236, v236, v232
    v_and_b32 v130, 0xffff0000, v130
    v_rcp_f32 v233, v130
    v_mul_f32 v10, v130, v130
    v_mul_f32 v237, v233, v233
    v_mul_f32 v233, 0xc0135761, v233
    v_mul_f32 v237, 0x3d372713, v237
    v_mul_f32 v237, v237, v233
    v_and_b32 v132, 0xffff0000, v132
    v_rcp_f32 v234, v132
    v_mul_f32 v12, v132, v132
    v_mul_f32 v238, v234, v234
    v_mul_f32 v234, 0xc0135761, v234
    v_mul_f32 v238, 0x3d372713, v238
    v_mul_f32 v238, v238, v234
    v_and_b32 v134, 0xffff0000, v134
    v_rcp_f32 v235, v134
    v_mul_f32 v13, v134, v134
    v_mul_f32 v239, v235, v235
    v_mul_f32 v235, 0xc0135761, v235
    v_mul_f32 v239, 0x3d372713, v239
    v_mul_f32 v239, v239, v235
    v_mfma_f32_16x16x32_bf16 v[40:43], v[24:27], v[184:187], v[40:43]
    s_waitcnt vmcnt(8)
    s_barrier
    v_mfma_f32_16x16x32_bf16 v[44:47], v[24:27], v[188:191], v[44:47]
    ds_read_b64_tr_b16 v[16:17], v7 offset:50688
    s_waitcnt vmcnt(4)
    v_mfma_f32_16x16x32_bf16 v[48:51], v[24:27], v[192:195], v[48:51]
    ds_read_b128 v[200:203], v108 offset:16896
    v_xor_b32 v247, s1, v242
    v_mfma_f32_16x16x32_bf16 v[52:55], v[24:27], v[196:199], v[52:55]
    ds_read_b64_tr_b16 v[18:19], v7 offset:50944
    ds_read_b128 v[204:207], v108 offset:18944
    v_mfma_f32_16x16x32_bf16 v[68:71], v[28:31], v[196:199], v[68:71]
    v_bitop3_b32 v247, v246, s1, v247 bitop3:0xbe
    v_bitop3_b32 v247, v250, s1, v247 bitop3:0xbe
    v_mfma_f32_16x16x32_bf16 v[64:67], v[28:31], v[192:195], v[64:67]
    ds_read_b64_tr_b16 v[20:21], v7 offset:50720
    v_bitop3_b32 v247, v254, s1, v247 bitop3:0xbe
    v_mfma_f32_16x16x32_bf16 v[60:63], v[28:31], v[188:191], v[60:63]
    ds_read_b128 v[208:211], v108 offset:20992
    v_mfma_f32_16x16x32_bf16 v[56:59], v[28:31], v[184:187], v[56:59]
    ds_read_b64_tr_b16 v[22:23], v7 offset:50976
    s_waitcnt lgkmcnt(7)
    v_mfma_f32_16x16x32_bf16 v[72:75], v[32:35], v[184:187], v[72:75]
    v_cmp_ne_u32 vcc, 0, v247
    s_cmp_lg_u64 vcc, 0
    s_cbranch_scc1 AE0_spin
AE0_ok:
    v_mfma_f32_16x16x32_bf16 v[76:79], v[32:35], v[188:191], v[76:79]
    ds_read_b64_tr_b16 v[24:25], v7 offset:54912
    v_swap_b32 v241, v244
    v_mfma_f32_16x16x32_bf16 v[80:83], v[32:35], v[192:195], v[80:83]
    ds_read_b128 v[212:215], v108 offset:23040
    v_swap_b32 v249, v252
    v_mfma_f32_16x16x32_bf16 v[84:87], v[32:35], v[196:199], v[84:87]
    ds_read_b64_tr_b16 v[26:27], v7 offset:55168
    s_add_u32 m0, s66, 118272
    v_mfma_f32_16x16x32_bf16 v[100:103], v[36:39], v[196:199], v[100:103]
    s_add_u32 s68, s42, 128
    v_mfma_f32_16x16x32_bf16 v[96:99], v[36:39], v[192:195], v[96:99]
    ds_read_b64_tr_b16 v[28:29], v7 offset:54944
    v_mfma_f32_16x16x32_bf16 v[92:95], v[36:39], v[188:191], v[92:95]
    ds_read_b128 v[216:219], v109 offset:16896
    v_mfma_f32_16x16x32_bf16 v[88:91], v[36:39], v[184:187], v[88:91]
    ds_read_b64_tr_b16 v[30:31], v7 offset:55200
    s_waitcnt lgkmcnt(4)
    v_mfma_f32_16x16x32_bf16 v[40:43], v[16:19], v[200:203], v[40:43]
    buffer_load_dwordx4 v3, s[20:23], s68 offen offset:0 lds
    v_mfma_f32_16x16x32_bf16 v[44:47], v[16:19], v[204:207], v[44:47]
    ds_read_b64_tr_b16 v[32:33], v7 offset:59136
    v_mfma_f32_16x16x32_bf16 v[48:51], v[16:19], v[208:211], v[48:51]
    ds_read_b128 v[220:223], v109 offset:18944
    v_mfma_f32_16x16x32_bf16 v[52:55], v[16:19], v[212:215], v[52:55]
    ds_read_b64_tr_b16 v[34:35], v7 offset:59392
    ds_read_b128 v[224:227], v109 offset:20992
    v_mfma_f32_16x16x32_bf16 v[68:71], v[20:23], v[212:215], v[68:71]
    v_perm_b32 v242, v0, v0, s4
    v_perm_b32 v243, v0, v0, s4
    v_mfma_f32_16x16x32_bf16 v[64:67], v[20:23], v[208:211], v[64:67]
    ds_read_b64_tr_b16 v[36:37], v7 offset:59168
    v_mfma_f32_16x16x32_bf16 v[60:63], v[20:23], v[204:207], v[60:63]
    ds_read_b128 v[228:231], v109 offset:23040
    v_mfma_f32_16x16x32_bf16 v[56:59], v[20:23], v[200:203], v[56:59]
    ds_read_b64_tr_b16 v[38:39], v7 offset:59424
    v_mfma_f32_16x16x16_bf16 v[40:43], v[240:241], v[242:243], v[40:43]
    buffer_load_dwordx4 v4, s[20:23], s68 offen offset:1056 lds
    v_mfma_f32_16x16x16_bf16 v[56:59], v[244:245], v[242:243], v[56:59]
    v_mfma_f32_16x16x16_bf16 v[72:75], v[248:249], v[242:243], v[72:75]
    v_mfma_f32_16x16x16_bf16 v[88:91], v[252:253], v[242:243], v[88:91]
    s_waitcnt lgkmcnt(7)
    v_mfma_f32_16x16x32_bf16 v[72:75], v[24:27], v[200:203], v[72:75]
    buffer_load_dwordx4 v5, s[20:23], s68 offen offset:2112 lds
    v_mfma_f32_16x16x32_bf16 v[76:79], v[24:27], v[204:207], v[76:79]
    ds_read_b64_tr_b16 v[16:17], v7 offset:63360
    v_mfma_f32_16x16x32_bf16 v[80:83], v[24:27], v[208:211], v[80:83]
    v_mfma_f32_16x16x32_bf16 v[84:87], v[24:27], v[212:215], v[84:87]
    ds_read_b64_tr_b16 v[18:19], v7 offset:63616
    v_mfma_f32_16x16x32_bf16 v[100:103], v[28:31], v[212:215], v[100:103]
    v_perm_b32 v246, v0, v0, s5
    v_perm_b32 v247, v0, v0, s5
    v_mfma_f32_16x16x32_bf16 v[96:99], v[28:31], v[208:211], v[96:99]
    ds_read_b64_tr_b16 v[20:21], v7 offset:63392
    v_mfma_f32_16x16x32_bf16 v[92:95], v[28:31], v[204:207], v[92:95]
    buffer_load_dwordx4 v6, s[20:23], s68 offen offset:3168 lds
    v_mfma_f32_16x16x32_bf16 v[88:91], v[28:31], v[200:203], v[88:91]
    ds_read_b64_tr_b16 v[22:23], v7 offset:63648
    v_mfma_f32_16x16x16_bf16 v[44:47], v[240:241], v[246:247], v[44:47]
    v_mfma_f32_16x16x16_bf16 v[60:63], v[244:245], v[246:247], v[60:63]
    v_mfma_f32_16x16x16_bf16 v[76:79], v[248:249], v[246:247], v[76:79]
    v_mfma_f32_16x16x16_bf16 v[92:95], v[252:253], v[246:247], v[92:95]
    s_waitcnt lgkmcnt(4)
    v_mfma_f32_16x16x32_bf16 v[40:43], v[32:35], v[216:219], v[40:43]
    s_barrier
    v_mfma_f32_16x16x32_bf16 v[44:47], v[32:35], v[220:223], v[44:47]
    ds_read_b64_tr_b16 v[24:25], v8 offset:0
    s_add_u32 m0, s66, 0
    v_mfma_f32_16x16x32_bf16 v[48:51], v[32:35], v[224:227], v[48:51]
    s_add_u32 s68, s43, 128
    v_mfma_f32_16x16x32_bf16 v[52:55], v[32:35], v[228:231], v[52:55]
    ds_read_b64_tr_b16 v[26:27], v8 offset:256
    v_mfma_f32_16x16x32_bf16 v[68:71], v[36:39], v[228:231], v[68:71]
    v_perm_b32 v242, v9, v9, s4
    v_perm_b32 v243, v9, v9, s4
    v_mfma_f32_16x16x32_bf16 v[64:67], v[36:39], v[224:227], v[64:67]
    ds_read_b64_tr_b16 v[28:29], v8 offset:32
    v_mfma_f32_16x16x32_bf16 v[60:63], v[36:39], v[220:223], v[60:63]
    buffer_load_dwordx4 v3, s[20:23], s68 offen offset:0 lds
    v_mfma_f32_16x16x32_bf16 v[56:59], v[36:39], v[216:219], v[56:59]
    ds_read_b64_tr_b16 v[30:31], v8 offset:288
    v_mfma_f32_16x16x16_bf16 v[48:51], v[240:241], v[242:243], v[48:51]
    v_mfma_f32_16x16x16_bf16 v[64:67], v[244:245], v[242:243], v[64:67]
    v_mfma_f32_16x16x16_bf16 v[80:83], v[248:249], v[242:243], v[80:83]
    buffer_load_dwordx4 v4, s[20:23], s68 offen offset:1056 lds
    v_mfma_f32_16x16x16_bf16 v[96:99], v[252:253], v[242:243], v[96:99]
    s_waitcnt lgkmcnt(4)
    v_mfma_f32_16x16x32_bf16 v[72:75], v[16:19], v[216:219], v[72:75]
    v_mfma_f32_16x16x32_bf16 v[76:79], v[16:19], v[220:223], v[76:79]
    ds_read_b64_tr_b16 v[32:33], v8 offset:4224
    v_mfma_f32_16x16x32_bf16 v[80:83], v[16:19], v[224:227], v[80:83]
    buffer_load_dwordx4 v5, s[20:23], s68 offen offset:2112 lds
    v_mfma_f32_16x16x32_bf16 v[84:87], v[16:19], v[228:231], v[84:87]
    ds_read_b64_tr_b16 v[34:35], v8 offset:4480
    v_mfma_f32_16x16x32_bf16 v[100:103], v[20:23], v[228:231], v[100:103]
    v_perm_b32 v246, v9, v9, s5
    v_perm_b32 v247, v9, v9, s5
    v_mfma_f32_16x16x32_bf16 v[96:99], v[20:23], v[224:227], v[96:99]
    ds_read_b64_tr_b16 v[36:37], v8 offset:4256
    v_mfma_f32_16x16x32_bf16 v[92:95], v[20:23], v[220:223], v[92:95]
    buffer_load_dwordx4 v6, s[20:23], s68 offen offset:3168 lds
    v_mfma_f32_16x16x32_bf16 v[88:91], v[20:23], v[216:219], v[88:91]
    ds_read_b64_tr_b16 v[38:39], v8 offset:4512
    v_mfma_f32_16x16x16_bf16 v[52:55], v[240:241], v[246:247], v[52:55]
    v_mfma_f32_16x16x16_bf16 v[68:71], v[244:245], v[246:247], v[68:71]
    v_mfma_f32_16x16x16_bf16 v[84:87], v[248:249], v[246:247], v[84:87]
    v_mfma_f32_16x16x16_bf16 v[100:103], v[252:253], v[246:247], v[100:103]
    s_waitcnt lgkmcnt(4)
    v_mfma_f32_16x16x32_bf16 v[104:107], v[24:27], a[0:3], 0
    v_mov_b32 v240, s6
    v_mov_b32 v241, s6
    v_mfma_f32_16x16x32_bf16 v[108:111], v[24:27], a[4:7], 0
    ds_read_b64_tr_b16 v[16:17], v8 offset:8448
    v_mfma_f32_16x16x32_bf16 v[112:115], v[24:27], a[8:11], 0
    v_mov_b32 v242, s6
    v_mov_b32 v243, s6
    v_mfma_f32_16x16x32_bf16 v[116:119], v[24:27], a[12:15], 0
    ds_read_b64_tr_b16 v[18:19], v8 offset:8704
    v_mfma_f32_16x16x32_bf16 v[132:135], v[28:31], a[12:15], 0
    v_mul_f32 v14, v40, v40
    v_mul_f32 v15, v41, v41
    v_mfma_f32_16x16x32_bf16 v[128:131], v[28:31], a[8:11], 0
    ds_read_b64_tr_b16 v[20:21], v8 offset:8480
    v_fma_f32 v14, v14, v236, v232
    v_mfma_f32_16x16x32_bf16 v[124:127], v[28:31], a[4:7], 0
    v_fma_f32 v15, v15, v236, v232
    v_mul_f32 v14, v14, v40
    v_mfma_f32_16x16x32_bf16 v[120:123], v[28:31], a[0:3], 0
    ds_read_b64_tr_b16 v[22:23], v8 offset:8736
    v_mul_f32 v15, v15, v41
    v_mfma_f32_16x16x32_bf16 v[248:251], v[240:243], v[24:27], 0
    v_exp_f32 v14, v14
    v_mfma_f32_16x16x32_bf16 v[252:255], v[240:243], v[28:31], 0
    v_mul_f32 v40, v40, v72
    s_waitcnt lgkmcnt(4)
    v_mfma_f32_16x16x32_bf16 v[136:139], v[32:35], a[0:3], 0
    v_mov_b32 v244, s7
    v_mov_b32 v245, s7
    v_mfma_f32_16x16x32_bf16 v[140:143], v[32:35], a[4:7], 0
    ds_read_b64_tr_b16 v[24:25], v8 offset:12672
    v_mul_f32 v41, v41, v73
    v_mfma_f32_16x16x32_bf16 v[144:147], v[32:35], a[8:11], 0
    v_mov_b32 v246, s7
    v_mov_b32 v247, s7
    v_mfma_f32_16x16x32_bf16 v[148:151], v[32:35], a[12:15], 0
    ds_read_b64_tr_b16 v[26:27], v8 offset:12928
    v_fma_f32 v72, v14, v1, v1
    v_mfma_f32_16x16x32_bf16 v[164:167], v[36:39], a[12:15], 0
    v_exp_f32 v15, v15
    v_mfma_f32_16x16x32_bf16 v[160:163], v[36:39], a[8:11], 0
    ds_read_b64_tr_b16 v[28:29], v8 offset:12704
    v_fma_f32 v73, v15, v1, v1
    v_mfma_f32_16x16x32_bf16 v[156:159], v[36:39], a[4:7], 0
    v_rcp_f32 v72, v72
    v_mfma_f32_16x16x32_bf16 v[152:155], v[36:39], a[0:3], 0
    ds_read_b64_tr_b16 v[30:31], v8 offset:12960
    v_mul_f32 v40, v40, v72
    v_mfma_f32_16x16x32_bf16 v[248:251], v[244:247], v[32:35], v[248:251]
    v_rcp_f32 v73, v73
    v_mfma_f32_16x16x32_bf16 v[252:255], v[244:247], v[36:39], v[252:255]
    v_mul_f32 v41, v41, v73
    s_waitcnt lgkmcnt(4)
    v_mfma_f32_16x16x32_bf16 v[104:107], v[16:19], a[16:19], v[104:107]
    s_waitcnt vmcnt(8)
    s_barrier
    v_mfma_f32_16x16x32_bf16 v[108:111], v[16:19], a[20:23], v[108:111]
    ds_read_b64_tr_b16 v[32:33], v8 offset:16896
    s_add_u32 m0, s66, 16896
    v_mfma_f32_16x16x32_bf16 v[112:115], v[16:19], a[24:27], v[112:115]
    s_add_u32 s68, s44, 128
    v_cvt_pk_bf16_f32 v72, v40, v41
    v_mfma_f32_16x16x32_bf16 v[116:119], v[16:19], a[28:31], v[116:119]
    ds_read_b64_tr_b16 v[34:35], v8 offset:17152
    v_mul_f32 v14, v42, v42
    v_mfma_f32_16x16x32_bf16 v[132:135], v[20:23], a[28:31], v[132:135]
    buffer_load_dwordx4 v3, s[20:23], s68 offen offset:0 lds
    v_mfma_f32_16x16x32_bf16 v[128:131], v[20:23], a[24:27], v[128:131]
    ds_read_b64_tr_b16 v[36:37], v8 offset:16928
    v_mul_f32 v15, v43, v43
    v_mfma_f32_16x16x32_bf16 v[124:127], v[20:23], a[20:23], v[124:127]
    v_fma_f32 v14, v14, v236, v232
    v_fma_f32 v15, v15, v236, v232
    v_mfma_f32_16x16x32_bf16 v[120:123], v[20:23], a[16:19], v[120:123]
    ds_read_b64_tr_b16 v[38:39], v8 offset:17184
    v_mul_f32 v14, v14, v42
    v_mfma_f32_16x16x32_bf16 v[248:251], v[240:243], v[16:19], v[248:251]
    buffer_load_dwordx4 v4, s[20:23], s68 offen offset:1056 lds
    v_mfma_f32_16x16x32_bf16 v[252:255], v[240:243], v[20:23], v[252:255]
    v_mul_f32 v15, v15, v43
    s_waitcnt lgkmcnt(4)
    v_mfma_f32_16x16x32_bf16 v[136:139], v[24:27], a[16:19], v[136:139]
    v_exp_f32 v14, v14
    v_mfma_f32_16x16x32_bf16 v[140:143], v[24:27], a[20:23], v[140:143]
    ds_read_b64_tr_b16 v[16:17], v8 offset:21120
    v_mul_f32 v42, v42, v74
    v_mfma_f32_16x16x32_bf16 v[144:147], v[24:27], a[24:27], v[144:147]
    buffer_load_dwordx4 v5, s[20:23], s68 offen offset:2112 lds
    v_mfma_f32_16x16x32_bf16 v[148:151], v[24:27], a[28:31], v[148:151]
    ds_read_b64_tr_b16 v[18:19], v8 offset:21376
    v_mul_f32 v43, v43, v75
    v_mfma_f32_16x16x32_bf16 v[164:167], v[28:31], a[28:31], v[164:167]
    v_exp_f32 v15, v15
    v_mfma_f32_16x16x32_bf16 v[160:163], v[28:31], a[24:27], v[160:163]
    ds_read_b64_tr_b16 v[20:21], v8 offset:21152
    v_fma_f32 v74, v14, v1, v1
    v_mfma_f32_16x16x32_bf16 v[156:159], v[28:31], a[20:23], v[156:159]
    buffer_load_dwordx4 v6, s[20:23], s68 offen offset:3168 lds
    v_mfma_f32_16x16x32_bf16 v[152:155], v[28:31], a[16:19], v[152:155]
    ds_read_b64_tr_b16 v[22:23], v8 offset:21408
    s_add_u32 m0, s66, 101376
    v_mfma_f32_16x16x32_bf16 v[248:251], v[244:247], v[24:27], v[248:251]
    s_add_u32 s68, s45, 128
    v_fma_f32 v75, v15, v1, v1
    v_mfma_f32_16x16x32_bf16 v[252:255], v[244:247], v[28:31], v[252:255]
    v_mul_f32 v14, v56, v56
    s_waitcnt lgkmcnt(4)
    v_mfma_f32_16x16x32_bf16 v[104:107], v[32:35], a[32:35], v[104:107]
    v_mov_b32 v240, s10
    v_mov_b32 v241, s10
    v_mfma_f32_16x16x32_bf16 v[108:111], v[32:35], a[36:39], v[108:111]
    ds_read_b64_tr_b16 v[24:25], v8 offset:25344
    v_mul_f32 v15, v57, v57
    v_mfma_f32_16x16x32_bf16 v[112:115], v[32:35], a[40:43], v[112:115]
    v_mov_b32 v242, s10
    v_mov_b32 v243, s10
    v_mfma_f32_16x16x32_bf16 v[116:119], v[32:35], a[44:47], v[116:119]
    ds_read_b64_tr_b16 v[26:27], v8 offset:25600
    v_fma_f32 v14, v14, v236, v232
    v_mfma_f32_16x16x32_bf16 v[132:135], v[36:39], a[44:47], v[132:135]
    buffer_load_dwordx4 v3, s[20:23], s68 offen offset:0 lds
    v_mfma_f32_16x16x32_bf16 v[128:131], v[36:39], a[40:43], v[128:131]
    ds_read_b64_tr_b16 v[28:29], v8 offset:25376
    v_fma_f32 v15, v15, v236, v232
    v_mfma_f32_16x16x32_bf16 v[124:127], v[36:39], a[36:39], v[124:127]
    v_rcp_f32 v74, v74
    v_mfma_f32_16x16x32_bf16 v[120:123], v[36:39], a[32:35], v[120:123]
    ds_read_b64_tr_b16 v[30:31], v8 offset:25632
    v_mul_f32 v42, v42, v74
    v_mfma_f32_16x16x32_bf16 v[248:251], v[240:243], v[32:35], v[248:251]
    buffer_load_dwordx4 v4, s[20:23], s68 offen offset:1056 lds
    v_mfma_f32_16x16x32_bf16 v[252:255], v[240:243], v[36:39], v[252:255]
    v_mul_f32 v14, v14, v56
    s_waitcnt lgkmcnt(4)
    v_mfma_f32_16x16x32_bf16 v[136:139], v[16:19], a[32:35], v[136:139]
    v_mov_b32 v244, s11
    v_mov_b32 v245, s11
    v_mfma_f32_16x16x32_bf16 v[140:143], v[16:19], a[36:39], v[140:143]
    ds_read_b64_tr_b16 v[32:33], v8 offset:29568
    v_mul_f32 v15, v15, v57
    v_mfma_f32_16x16x32_bf16 v[144:147], v[16:19], a[40:43], v[144:147]
    v_mov_b32 v246, s11
    v_mov_b32 v247, s11
    v_mfma_f32_16x16x32_bf16 v[148:151], v[16:19], a[44:47], v[148:151]
    ds_read_b64_tr_b16 v[34:35], v8 offset:29824
    v_mul_f32 v56, v56, v88
    v_mfma_f32_16x16x32_bf16 v[164:167], v[20:23], a[44:47], v[164:167]
    buffer_load_dwordx4 v5, s[20:23], s68 offen offset:2112 lds
    v_mfma_f32_16x16x32_bf16 v[160:163], v[20:23], a[40:43], v[160:163]
    ds_read_b64_tr_b16 v[36:37], v8 offset:29600
    v_mul_f32 v57, v57, v89
    v_mfma_f32_16x16x32_bf16 v[156:159], v[20:23], a[36:39], v[156:159]
    v_rcp_f32 v75, v75
    v_mfma_f32_16x16x32_bf16 v[152:155], v[20:23], a[32:35], v[152:155]
    ds_read_b64_tr_b16 v[38:39], v8 offset:29856
    v_mul_f32 v43, v43, v75
    v_mfma_f32_16x16x32_bf16 v[248:251], v[244:247], v[16:19], v[248:251]
    buffer_load_dwordx4 v6, s[20:23], s68 offen offset:3168 lds
    v_mfma_f32_16x16x32_bf16 v[252:255], v[244:247], v[20:23], v[252:255]
    v_cvt_pk_bf16_f32 v73, v42, v43
    s_waitcnt lgkmcnt(4)
    v_mfma_f32_16x16x32_bf16 v[104:107], v[24:27], a[48:51], v[104:107]
    s_waitcnt vmcnt(12)
    s_barrier
    v_mfma_f32_16x16x32_bf16 v[108:111], v[24:27], a[52:55], v[108:111]
    ds_read_b64_tr_b16 v[16:17], v8 offset:50688
    s_add_u32 m0, s66, 33792
    v_mfma_f32_16x16x32_bf16 v[112:115], v[24:27], a[56:59], v[112:115]
    s_add_u32 s68, s46, 128
    v_mfma_f32_16x16x32_bf16 v[116:119], v[24:27], a[60:63], v[116:119]
    ds_read_b64_tr_b16 v[18:19], v8 offset:50944
    v_mfma_f32_16x16x32_bf16 v[132:135], v[28:31], a[60:63], v[132:135]
    buffer_load_dwordx4 v3, s[20:23], s68 offen offset:0 lds
    v_mfma_f32_16x16x32_bf16 v[128:131], v[28:31], a[56:59], v[128:131]
    ds_read_b64_tr_b16 v[20:21], v8 offset:50720
    v_mfma_f32_16x16x32_bf16 v[124:127], v[28:31], a[52:55], v[124:127]
    v_exp_f32 v14, v14
    v_mfma_f32_16x16x32_bf16 v[120:123], v[28:31], a[48:51], v[120:123]
    ds_read_b64_tr_b16 v[22:23], v8 offset:50976
    v_fma_f32 v88, v14, v1, v1
    v_mfma_f32_16x16x32_bf16 v[248:251], v[240:243], v[24:27], v[248:251]
    buffer_load_dwordx4 v4, s[20:23], s68 offen offset:1056 lds
    v_mfma_f32_16x16x32_bf16 v[252:255], v[240:243], v[28:31], v[252:255]
    v_mul_f32 v14, v58, v58
    s_waitcnt lgkmcnt(4)
    v_mfma_f32_16x16x32_bf16 v[136:139], v[32:35], a[48:51], v[136:139]
    v_exp_f32 v15, v15
    v_mfma_f32_16x16x32_bf16 v[140:143], v[32:35], a[52:55], v[140:143]
    ds_read_b64_tr_b16 v[24:25], v8 offset:54912
    v_fma_f32 v89, v15, v1, v1
    v_mfma_f32_16x16x32_bf16 v[144:147], v[32:35], a[56:59], v[144:147]
    buffer_load_dwordx4 v5, s[20:23], s68 offen offset:2112 lds
    v_mfma_f32_16x16x32_bf16 v[148:151], v[32:35], a[60:63], v[148:151]
    ds_read_b64_tr_b16 v[26:27], v8 offset:55168
    v_mul_f32 v15, v59, v59
    v_mfma_f32_16x16x32_bf16 v[164:167], v[36:39], a[60:63], v[164:167]
    v_rcp_f32 v88, v88
    v_mfma_f32_16x16x32_bf16 v[160:163], v[36:39], a[56:59], v[160:163]
    ds_read_b64_tr_b16 v[28:29], v8 offset:54944
    v_mul_f32 v56, v56, v88
    v_mfma_f32_16x16x32_bf16 v[156:159], v[36:39], a[52:55], v[156:159]
    buffer_load_dwordx4 v6, s[20:23], s68 offen offset:3168 lds
    v_mfma_f32_16x16x32_bf16 v[152:155], v[36:39], a[48:51], v[152:155]
    ds_read_b64_tr_b16 v[30:31], v8 offset:55200
    s_add_u32 m0, s66, 50688
    v_mfma_f32_16x16x32_bf16 v[248:251], v[244:247], v[32:35], v[248:251]
    s_add_u32 s68, s47, 128
    v_fma_f32 v14, v14, v236, v232
    v_mfma_f32_16x16x32_bf16 v[252:255], v[244:247], v[36:39], v[252:255]
    v_fma_f32 v15, v15, v236, v232
    s_waitcnt lgkmcnt(4)
    v_mfma_f32_16x16x32_bf16 v[104:107], v[16:19], a[64:67], v[104:107]
    buffer_load_dwordx4 v3, s[20:23], s68 offen offset:0 lds
    v_mfma_f32_16x16x32_bf16 v[108:111], v[16:19], a[68:71], v[108:111]
    ds_read_b64_tr_b16 v[32:33], v8 offset:59136
    v_mul_f32 v14, v14, v58
    v_mfma_f32_16x16x32_bf16 v[112:115], v[16:19], a[72:75], v[112:115]
    v_rcp_f32 v89, v89
    v_mfma_f32_16x16x32_bf16 v[116:119], v[16:19], a[76:79], v[116:119]
    ds_read_b64_tr_b16 v[34:35], v8 offset:59392
    v_mul_f32 v57, v57, v89
    v_mfma_f32_16x16x32_bf16 v[132:135], v[20:23], a[76:79], v[132:135]
    v_cvt_pk_bf16_f32 v249, v248, v248
    v_lshlrev_b32 v249, 16, v249
    v_mfma_f32_16x16x32_bf16 v[128:131], v[20:23], a[72:75], v[128:131]
    ds_read_b64_tr_b16 v[36:37], v8 offset:59168
    v_sub_f32 v248, v248, v249
    v_mfma_f32_16x16x32_bf16 v[124:127], v[20:23], a[68:71], v[124:127]
    v_cvt_pk_bf16_f32 v240, v249, v248
    v_cvt_pk_bf16_f32 v253, v252, v252
    v_mfma_f32_16x16x32_bf16 v[120:123], v[20:23], a[64:67], v[120:123]
    ds_read_b64_tr_b16 v[38:39], v8 offset:59424
    s_waitcnt lgkmcnt(4)
    v_mfma_f32_16x16x32_bf16 v[136:139], v[24:27], a[64:67], v[136:139]
    v_lshlrev_b32 v253, 16, v253
    v_sub_f32 v252, v252, v253
    v_mfma_f32_16x16x32_bf16 v[140:143], v[24:27], a[68:71], v[140:143]
    ds_read_b64_tr_b16 v[16:17], v8 offset:63360
    v_cvt_pk_bf16_f32 v241, v253, v252
    v_mfma_f32_16x16x32_bf16 v[144:147], v[24:27], a[72:75], v[144:147]
    v_mov_b32 v242, s1
    s_add_u32 s14, s73, 8192
    v_mfma_f32_16x16x32_bf16 v[148:151], v[24:27], a[76:79], v[148:151]
    ds_read_b64_tr_b16 v[18:19], v8 offset:63616
    v_cvt_pk_bf16_f32 v74, v56, v57
    v_mfma_f32_16x16x32_bf16 v[164:167], v[28:31], a[76:79], v[164:167]
    s_mov_b64 exec, 0xffff
    buffer_store_dwordx4 v[240:243], v11, s[28:31], s14 offen sc1
    s_mov_b64 exec, -1
    v_mfma_f32_16x16x32_bf16 v[160:163], v[28:31], a[72:75], v[160:163]
    ds_read_b64_tr_b16 v[20:21], v8 offset:63392
    v_mul_f32 v15, v15, v59
    v_mfma_f32_16x16x32_bf16 v[156:159], v[28:31], a[68:71], v[156:159]
    v_exp_f32 v14, v14
    v_mfma_f32_16x16x32_bf16 v[152:155], v[28:31], a[64:67], v[152:155]
    ds_read_b64_tr_b16 v[22:23], v8 offset:63648
    s_waitcnt lgkmcnt(4)
    buffer_load_dwordx4 v4, s[20:23], s68 offen offset:1056 lds
    buffer_load_dwordx4 v5, s[20:23], s68 offen offset:2112 lds
    buffer_load_dwordx4 v6, s[20:23], s68 offen offset:3168 lds
    v_mfma_f32_16x16x32_bf16 v[104:107], v[32:35], a[80:83], v[104:107]
    s_waitcnt vmcnt(17)
    s_barrier
    v_mfma_f32_16x16x32_bf16 v[108:111], v[32:35], a[84:87], v[108:111]
    ds_read_b64_tr_b16 v[24:25], v7 offset:0
    s_add_u32 m0, s66, 67584
    v_mfma_f32_16x16x32_bf16 v[112:115], v[32:35], a[88:91], v[112:115]
    s_add_u32 s68, s48, 128
    v_mul_f32 v58, v58, v90
    v_mfma_f32_16x16x32_bf16 v[116:119], v[32:35], a[92:95], v[116:119]
    ds_read_b64_tr_b16 v[26:27], v7 offset:256
    v_mul_f32 v59, v59, v91
    v_mfma_f32_16x16x32_bf16 v[132:135], v[36:39], a[92:95], v[132:135]
    buffer_load_dwordx4 v3, s[20:23], s68 offen offset:0 lds
    v_mfma_f32_16x16x32_bf16 v[128:131], v[36:39], a[88:91], v[128:131]
    ds_read_b64_tr_b16 v[28:29], v7 offset:32
    v_fma_f32 v90, v14, v1, v1
    v_mfma_f32_16x16x32_bf16 v[124:127], v[36:39], a[84:87], v[124:127]
    v_exp_f32 v15, v15
    v_mfma_f32_16x16x32_bf16 v[120:123], v[36:39], a[80:83], v[120:123]
    ds_read_b64_tr_b16 v[30:31], v7 offset:288
    s_waitcnt lgkmcnt(4)
    v_mfma_f32_16x16x32_bf16 v[136:139], v[16:19], a[80:83], v[136:139]
    buffer_load_dwordx4 v4, s[20:23], s68 offen offset:1056 lds
    v_mfma_f32_16x16x32_bf16 v[140:143], v[16:19], a[84:87], v[140:143]
    ds_read_b64_tr_b16 v[32:33], v7 offset:4224
    v_fma_f32 v91, v15, v1, v1
    v_mfma_f32_16x16x32_bf16 v[144:147], v[16:19], a[88:91], v[144:147]
    v_rcp_f32 v90, v90
    v_mfma_f32_16x16x32_bf16 v[148:151], v[16:19], a[92:95], v[148:151]
    ds_read_b64_tr_b16 v[34:35], v7 offset:4480
    v_mul_f32 v58, v58, v90
    v_mfma_f32_16x16x32_bf16 v[164:167], v[20:23], a[92:95], v[164:167]
    buffer_load_dwordx4 v5, s[20:23], s68 offen offset:2112 lds
    v_mfma_f32_16x16x32_bf16 v[160:163], v[20:23], a[88:91], v[160:163]
    ds_read_b64_tr_b16 v[36:37], v7 offset:4256
    v_mfma_f32_16x16x32_bf16 v[156:159], v[20:23], a[84:87], v[156:159]
    v_rcp_f32 v91, v91
    v_mfma_f32_16x16x32_bf16 v[152:155], v[20:23], a[80:83], v[152:155]
    ds_read_b64_tr_b16 v[38:39], v7 offset:4512
    s_waitcnt lgkmcnt(4)
    v_mfma_f32_16x16x32_bf16 v[104:107], v[24:27], a[96:99], v[104:107]
    buffer_load_dwordx4 v6, s[20:23], s68 offen offset:3168 lds
    v_mfma_f32_16x16x32_bf16 v[108:111], v[24:27], a[100:103], v[108:111]
    ds_read_b64_tr_b16 v[16:17], v7 offset:8448
    s_add_u32 m0, s66, 84480
    v_mfma_f32_16x16x32_bf16 v[112:115], v[24:27], a[104:107], v[112:115]
    s_add_u32 s68, s49, 128
    v_mul_f32 v59, v59, v91
    v_mfma_f32_16x16x32_bf16 v[116:119], v[24:27], a[108:111], v[116:119]
    ds_read_b64_tr_b16 v[18:19], v7 offset:8704
    v_cvt_pk_bf16_f32 v75, v58, v59
    v_mfma_f32_16x16x32_bf16 v[132:135], v[28:31], a[108:111], v[132:135]
    buffer_load_dwordx4 v3, s[20:23], s68 offen offset:0 lds
    v_mfma_f32_16x16x32_bf16 v[128:131], v[28:31], a[104:107], v[128:131]
    ds_read_b64_tr_b16 v[20:21], v7 offset:8480
    v_mfma_f32_16x16x32_bf16 v[124:127], v[28:31], a[100:103], v[124:127]
    buffer_store_dwordx4 v[72:75], v11, s[28:31], s63 offen offset:0 sc1
    v_mfma_f32_16x16x32_bf16 v[120:123], v[28:31], a[96:99], v[120:123]
    ds_read_b64_tr_b16 v[22:23], v7 offset:8736
    s_waitcnt lgkmcnt(4)
    v_mfma_f32_16x16x32_bf16 v[136:139], v[32:35], a[96:99], v[136:139]
    buffer_load_dwordx4 v4, s[20:23], s68 offen offset:1056 lds
    v_mfma_f32_16x16x32_bf16 v[140:143], v[32:35], a[100:103], v[140:143]
    ds_read_b64_tr_b16 v[24:25], v7 offset:12672
    v_mul_f32 v14, v44, v44
    v_mfma_f32_16x16x32_bf16 v[144:147], v[32:35], a[104:107], v[144:147]
    v_mul_f32 v15, v45, v45
    v_fma_f32 v14, v14, v237, v233
    v_mfma_f32_16x16x32_bf16 v[148:151], v[32:35], a[108:111], v[148:151]
    ds_read_b64_tr_b16 v[26:27], v7 offset:12928
    v_fma_f32 v15, v15, v237, v233
    v_mfma_f32_16x16x32_bf16 v[164:167], v[36:39], a[108:111], v[164:167]
    buffer_load_dwordx4 v5, s[20:23], s68 offen offset:2112 lds
    v_mfma_f32_16x16x32_bf16 v[160:163], v[36:39], a[104:107], v[160:163]
    ds_read_b64_tr_b16 v[28:29], v7 offset:12704
    v_mul_f32 v14, v14, v44
    v_mfma_f32_16x16x32_bf16 v[156:159], v[36:39], a[100:103], v[156:159]
    v_mul_f32 v15, v15, v45
    v_mul_f32 v44, v44, v76
    v_mfma_f32_16x16x32_bf16 v[152:155], v[36:39], a[96:99], v[152:155]
    ds_read_b64_tr_b16 v[30:31], v7 offset:12960
    s_waitcnt lgkmcnt(4)
    buffer_load_dwordx4 v6, s[20:23], s68 offen offset:3168 lds
    v_mfma_f32_16x16x32_bf16 v[104:107], v[16:19], a[112:115], v[104:107]
    s_waitcnt vmcnt(22)
    s_barrier
    v_mfma_f32_16x16x32_bf16 v[108:111], v[16:19], a[116:119], v[108:111]
    ds_read_b64_tr_b16 v[32:33], v7 offset:16896
    s_add_u32 m0, s66, 118272
    v_mfma_f32_16x16x32_bf16 v[112:115], v[16:19], a[120:123], v[112:115]
    s_add_u32 s68, s40, 256
    v_mul_f32 v45, v45, v77
    v_mfma_f32_16x16x32_bf16 v[116:119], v[16:19], a[124:127], v[116:119]
    ds_read_b64_tr_b16 v[34:35], v7 offset:17152
    v_mfma_f32_16x16x32_bf16 v[132:135], v[20:23], a[124:127], v[132:135]
    buffer_load_dwordx4 v3, s[20:23], s68 offen offset:0 lds
    v_mfma_f32_16x16x32_bf16 v[128:131], v[20:23], a[120:123], v[128:131]
    ds_read_b64_tr_b16 v[36:37], v7 offset:16928
    v_mfma_f32_16x16x32_bf16 v[124:127], v[20:23], a[116:119], v[124:127]
    v_exp_f32 v14, v14
    v_mfma_f32_16x16x32_bf16 v[120:123], v[20:23], a[112:115], v[120:123]
    ds_read_b64_tr_b16 v[38:39], v7 offset:17184
    s_waitcnt lgkmcnt(4)
    v_mfma_f32_16x16x32_bf16 v[136:139], v[24:27], a[112:115], v[136:139]
    buffer_load_dwordx4 v4, s[20:23], s68 offen offset:1056 lds
    v_mfma_f32_16x16x32_bf16 v[140:143], v[24:27], a[116:119], v[140:143]
    ds_read_b64_tr_b16 v[16:17], v7 offset:21120
    v_fma_f32 v76, v14, v10, v10
    v_mfma_f32_16x16x32_bf16 v[144:147], v[24:27], a[120:123], v[144:147]
    v_exp_f32 v15, v15
    v_mfma_f32_16x16x32_bf16 v[148:151], v[24:27], a[124:127], v[148:151]
    ds_read_b64_tr_b16 v[18:19], v7 offset:21376
    v_fma_f32 v77, v15, v10, v10
    v_mfma_f32_16x16x32_bf16 v[164:167], v[28:31], a[124:127], v[164:167]
    buffer_load_dwordx4 v5, s[20:23], s68 offen offset:2112 lds
    v_mfma_f32_16x16x32_bf16 v[160:163], v[28:31], a[120:123], v[160:163]
    ds_read_b64_tr_b16 v[20:21], v7 offset:21152
    v_mul_f32 v14, v46, v46
    v_mfma_f32_16x16x32_bf16 v[156:159], v[28:31], a[116:119], v[156:159]
    v_rcp_f32 v76, v76
    v_mfma_f32_16x16x32_bf16 v[152:155], v[28:31], a[112:115], v[152:155]
    ds_read_b64_tr_b16 v[22:23], v7 offset:21408
    s_waitcnt lgkmcnt(4)
    v_mfma_f32_16x16x32_bf16 v[104:107], v[32:35], a[128:131], v[104:107]
    buffer_load_dwordx4 v6, s[20:23], s68 offen offset:3168 lds
    v_mfma_f32_16x16x32_bf16 v[108:111], v[32:35], a[132:135], v[108:111]
    ds_read_b64_tr_b16 v[24:25], v7 offset:25344
    v_mul_f32 v44, v44, v76
    v_mfma_f32_16x16x32_bf16 v[112:115], v[32:35], a[136:139], v[112:115]
    v_rcp_f32 v77, v77
    v_mfma_f32_16x16x32_bf16 v[116:119], v[32:35], a[140:143], v[116:119]
    ds_read_b64_tr_b16 v[26:27], v7 offset:25600
    v_mul_f32 v45, v45, v77
    v_mfma_f32_16x16x32_bf16 v[132:135], v[36:39], a[140:143], v[132:135]
    v_cvt_pk_bf16_f32 v76, v44, v45
    v_mul_f32 v15, v47, v47
    v_mfma_f32_16x16x32_bf16 v[128:131], v[36:39], a[136:139], v[128:131]
    ds_read_b64_tr_b16 v[28:29], v7 offset:25376
    v_fma_f32 v14, v14, v237, v233
    v_mfma_f32_16x16x32_bf16 v[124:127], v[36:39], a[132:135], v[124:127]
    v_fma_f32 v15, v15, v237, v233
    v_mul_f32 v14, v14, v46
    v_mfma_f32_16x16x32_bf16 v[120:123], v[36:39], a[128:131], v[120:123]
    ds_read_b64_tr_b16 v[30:31], v7 offset:25632
    s_waitcnt lgkmcnt(4)
    v_mfma_f32_16x16x32_bf16 v[136:139], v[16:19], a[128:131], v[136:139]
    v_mul_f32 v15, v15, v47
    v_mul_f32 v46, v46, v78
    v_mfma_f32_16x16x32_bf16 v[140:143], v[16:19], a[132:135], v[140:143]
    ds_read_b64_tr_b16 v[32:33], v7 offset:29568
    v_mul_f32 v47, v47, v79
    v_mfma_f32_16x16x32_bf16 v[144:147], v[16:19], a[136:139], v[144:147]
    v_exp_f32 v14, v14
    v_mfma_f32_16x16x32_bf16 v[148:151], v[16:19], a[140:143], v[148:151]
    ds_read_b64_tr_b16 v[34:35], v7 offset:29824
    v_fma_f32 v78, v14, v10, v10
    v_mfma_f32_16x16x32_bf16 v[164:167], v[20:23], a[140:143], v[164:167]
    v_exp_f32 v15, v15
    v_mfma_f32_16x16x32_bf16 v[160:163], v[20:23], a[136:139], v[160:163]
    ds_read_b64_tr_b16 v[36:37], v7 offset:29600
    v_fma_f32 v79, v15, v10, v10
    v_mfma_f32_16x16x32_bf16 v[156:159], v[20:23], a[132:135], v[156:159]
    v_rcp_f32 v78, v78
    v_mfma_f32_16x16x32_bf16 v[152:155], v[20:23], a[128:131], v[152:155]
    ds_read_b64_tr_b16 v[38:39], v7 offset:29856
    s_waitcnt lgkmcnt(4)
    v_mfma_f32_16x16x32_bf16 v[104:107], v[24:27], a[144:147], v[104:107]
    s_waitcnt vmcnt(22)
    s_barrier
    v_mfma_f32_16x16x32_bf16 v[108:111], v[24:27], a[148:151], v[108:111]
    ds_read_b64_tr_b16 v[16:17], v8 offset:33792
    s_add_u32 m0, s66, 0
    v_mfma_f32_16x16x32_bf16 v[112:115], v[24:27], a[152:155], v[112:115]
    s_add_u32 s68, s41, 256
    v_mul_f32 v46, v46, v78
    v_mfma_f32_16x16x32_bf16 v[116:119], v[24:27], a[156:159], v[116:119]
    ds_read_b64_tr_b16 v[18:19], v8 offset:34048
    v_mul_f32 v14, v60, v60
    v_mfma_f32_16x16x32_bf16 v[132:135], v[28:31], a[156:159], v[132:135]
    buffer_load_dwordx4 v3, s[20:23], s68 offen offset:0 lds
    v_mfma_f32_16x16x32_bf16 v[128:131], v[28:31], a[152:155], v[128:131]
    ds_read_b64_tr_b16 v[20:21], v8 offset:33824
    v_mul_f32 v15, v61, v61
    v_mfma_f32_16x16x32_bf16 v[124:127], v[28:31], a[148:151], v[124:127]
    v_rcp_f32 v79, v79
    v_mfma_f32_16x16x32_bf16 v[120:123], v[28:31], a[144:147], v[120:123]
    ds_read_b64_tr_b16 v[22:23], v8 offset:34080
    s_waitcnt lgkmcnt(4)
    v_mfma_f32_16x16x32_bf16 v[136:139], v[32:35], a[144:147], v[136:139]
    buffer_load_dwordx4 v4, s[20:23], s68 offen offset:1056 lds
    v_mfma_f32_16x16x32_bf16 v[140:143], v[32:35], a[148:151], v[140:143]
    ds_read_b64_tr_b16 v[24:25], v8 offset:38016
    v_mul_f32 v47, v47, v79
    v_mfma_f32_16x16x32_bf16 v[144:147], v[32:35], a[152:155], v[144:147]
    v_cvt_pk_bf16_f32 v77, v46, v47
    v_fma_f32 v14, v14, v237, v233
    v_mfma_f32_16x16x32_bf16 v[148:151], v[32:35], a[156:159], v[148:151]
    ds_read_b64_tr_b16 v[26:27], v8 offset:38272
    v_fma_f32 v15, v15, v237, v233
    v_mfma_f32_16x16x32_bf16 v[164:167], v[36:39], a[156:159], v[164:167]
    buffer_load_dwordx4 v5, s[20:23], s68 offen offset:2112 lds
    v_mfma_f32_16x16x32_bf16 v[160:163], v[36:39], a[152:155], v[160:163]
    ds_read_b64_tr_b16 v[28:29], v8 offset:38048
    v_mul_f32 v14, v14, v60
    v_mfma_f32_16x16x32_bf16 v[156:159], v[36:39], a[148:151], v[156:159]
    v_mul_f32 v15, v15, v61
    v_mul_f32 v60, v60, v92
    v_mfma_f32_16x16x32_bf16 v[152:155], v[36:39], a[144:147], v[152:155]
    ds_read_b64_tr_b16 v[30:31], v8 offset:38304
    s_waitcnt lgkmcnt(4)
    v_mfma_f32_16x16x32_bf16 v[104:107], v[16:19], a[160:163], v[104:107]
    buffer_load_dwordx4 v6, s[20:23], s68 offen offset:3168 lds
    v_mfma_f32_16x16x32_bf16 v[108:111], v[16:19], a[164:167], v[108:111]
    ds_read_b64_tr_b16 v[32:33], v8 offset:42240
    v_mul_f32 v61, v61, v93
    v_mfma_f32_16x16x32_bf16 v[112:115], v[16:19], a[168:171], v[112:115]
    v_exp_f32 v14, v14
    v_mfma_f32_16x16x32_bf16 v[116:119], v[16:19], a[172:175], v[116:119]
    ds_read_b64_tr_b16 v[34:35], v8 offset:42496
    v_fma_f32 v92, v14, v10, v10
    v_mfma_f32_16x16x32_bf16 v[132:135], v[20:23], a[172:175], v[132:135]
    v_exp_f32 v15, v15
    v_mfma_f32_16x16x32_bf16 v[128:131], v[20:23], a[168:171], v[128:131]
    ds_read_b64_tr_b16 v[36:37], v8 offset:42272
    v_fma_f32 v93, v15, v10, v10
    v_mfma_f32_16x16x32_bf16 v[124:127], v[20:23], a[164:167], v[124:127]
    v_rcp_f32 v92, v92
    v_mfma_f32_16x16x32_bf16 v[120:123], v[20:23], a[160:163], v[120:123]
    ds_read_b64_tr_b16 v[38:39], v8 offset:42528
    s_waitcnt lgkmcnt(4)
    v_mfma_f32_16x16x32_bf16 v[136:139], v[24:27], a[160:163], v[136:139]
    v_rcp_f32 v93, v93
    v_mfma_f32_16x16x32_bf16 v[140:143], v[24:27], a[164:167], v[140:143]
    ds_read_b64_tr_b16 v[16:17], v8 offset:46464
    v_mul_f32 v60, v60, v92
    v_mfma_f32_16x16x32_bf16 v[144:147], v[24:27], a[168:171], v[144:147]
    v_mul_f32 v61, v61, v93
    v_cvt_pk_bf16_f32 v78, v60, v61
    v_mfma_f32_16x16x32_bf16 v[148:151], v[24:27], a[172:175], v[148:151]
    ds_read_b64_tr_b16 v[18:19], v8 offset:46720
    v_mul_f32 v14, v62, v62
    v_mfma_f32_16x16x32_bf16 v[164:167], v[28:31], a[172:175], v[164:167]
    v_mul_f32 v15, v63, v63
    v_fma_f32 v14, v14, v237, v233
    v_mfma_f32_16x16x32_bf16 v[160:163], v[28:31], a[168:171], v[160:163]
    ds_read_b64_tr_b16 v[20:21], v8 offset:46496
    v_fma_f32 v15, v15, v237, v233
    v_mfma_f32_16x16x32_bf16 v[156:159], v[28:31], a[164:167], v[156:159]
    v_mul_f32 v14, v14, v62
    v_mul_f32 v15, v15, v63
    v_mfma_f32_16x16x32_bf16 v[152:155], v[28:31], a[160:163], v[152:155]
    ds_read_b64_tr_b16 v[22:23], v8 offset:46752
    s_waitcnt lgkmcnt(4)
    v_mfma_f32_16x16x32_bf16 v[104:107], v[32:35], a[176:179], v[104:107]
    s_waitcnt vmcnt(22)
    s_barrier
    v_mfma_f32_16x16x32_bf16 v[108:111], v[32:35], a[180:183], v[108:111]
    ds_read_b64_tr_b16 v[24:25], v7 offset:33792
    v_mul_f32 v62, v62, v94
    v_mfma_f32_16x16x32_bf16 v[112:115], v[32:35], a[184:187], v[112:115]
    v_exp_f32 v14, v14
    v_mfma_f32_16x16x32_bf16 v[116:119], v[32:35], a[188:191], v[116:119]
    ds_read_b64_tr_b16 v[26:27], v7 offset:34048
    v_mul_f32 v63, v63, v95
    v_mfma_f32_16x16x32_bf16 v[132:135], v[36:39], a[188:191], v[132:135]
    v_exp_f32 v15, v15
    v_mfma_f32_16x16x32_bf16 v[128:131], v[36:39], a[184:187], v[128:131]
    ds_read_b64_tr_b16 v[28:29], v7 offset:33824
    v_fma_f32 v94, v14, v10, v10
    v_mfma_f32_16x16x32_bf16 v[124:127], v[36:39], a[180:183], v[124:127]
    v_fma_f32 v95, v15, v10, v10
    v_mfma_f32_16x16x32_bf16 v[120:123], v[36:39], a[176:179], v[120:123]
    ds_read_b64_tr_b16 v[30:31], v7 offset:34080
    s_waitcnt lgkmcnt(4)
    v_mfma_f32_16x16x32_bf16 v[136:139], v[16:19], a[176:179], v[136:139]
    v_rcp_f32 v94, v94
    v_mfma_f32_16x16x32_bf16 v[140:143], v[16:19], a[180:183], v[140:143]
    ds_read_b64_tr_b16 v[32:33], v7 offset:38016
    v_mul_f32 v62, v62, v94
    v_mfma_f32_16x16x32_bf16 v[144:147], v[16:19], a[184:187], v[144:147]
    v_rcp_f32 v95, v95
    v_mfma_f32_16x16x32_bf16 v[148:151], v[16:19], a[188:191], v[148:151]
    ds_read_b64_tr_b16 v[34:35], v7 offset:38272
    v_mul_f32 v63, v63, v95
    v_mfma_f32_16x16x32_bf16 v[164:167], v[20:23], a[188:191], v[164:167]
    v_cvt_pk_bf16_f32 v79, v62, v63
    v_mfma_f32_16x16x32_bf16 v[160:163], v[20:23], a[184:187], v[160:163]
    ds_read_b64_tr_b16 v[36:37], v7 offset:38048
    v_mfma_f32_16x16x32_bf16 v[156:159], v[20:23], a[180:183], v[156:159]
    buffer_store_dwordx4 v[76:79], v11, s[28:31], s63 offen offset:1024 sc1
    v_mfma_f32_16x16x32_bf16 v[152:155], v[20:23], a[176:179], v[152:155]
    ds_read_b64_tr_b16 v[38:39], v7 offset:38304
    s_waitcnt lgkmcnt(4)
    v_mfma_f32_16x16x32_bf16 v[104:107], v[24:27], a[192:195], v[104:107]
    v_mul_f32 v14, v48, v48
    v_mul_f32 v15, v49, v49
    v_mfma_f32_16x16x32_bf16 v[108:111], v[24:27], a[196:199], v[108:111]
    ds_read_b64_tr_b16 v[16:17], v7 offset:42240
    s_add_u32 s15, s72, 8192
    v_mfma_f32_16x16x32_bf16 v[112:115], v[24:27], a[200:203], v[112:115]
    buffer_load_dwordx4 v[240:243], v11, s[28:31], s15 offen offset:0 sc1
    v_mfma_f32_16x16x32_bf16 v[116:119], v[24:27], a[204:207], v[116:119]
    ds_read_b64_tr_b16 v[18:19], v7 offset:42496
    v_fma_f32 v14, v14, v238, v234
    v_mfma_f32_16x16x32_bf16 v[132:135], v[28:31], a[204:207], v[132:135]
    v_fma_f32 v15, v15, v238, v234
    v_mul_f32 v14, v14, v48
    v_mfma_f32_16x16x32_bf16 v[128:131], v[28:31], a[200:203], v[128:131]
    ds_read_b64_tr_b16 v[20:21], v7 offset:42272
    v_mul_f32 v15, v15, v49
    v_mfma_f32_16x16x32_bf16 v[124:127], v[28:31], a[196:199], v[124:127]
    buffer_load_dwordx4 v[244:247], v11, s[28:31], s15 offen offset:1024 sc1
    v_mfma_f32_16x16x32_bf16 v[120:123], v[28:31], a[192:195], v[120:123]
    ds_read_b64_tr_b16 v[22:23], v7 offset:42528
    s_waitcnt lgkmcnt(4)
    v_mfma_f32_16x16x32_bf16 v[136:139], v[32:35], a[192:195], v[136:139]
    v_exp_f32 v14, v14
    v_mul_f32 v48, v48, v80
    v_mfma_f32_16x16x32_bf16 v[140:143], v[32:35], a[196:199], v[140:143]
    ds_read_b64_tr_b16 v[24:25], v7 offset:46464
    v_mul_f32 v49, v49, v81
    v_mfma_f32_16x16x32_bf16 v[144:147], v[32:35], a[200:203], v[144:147]
    buffer_load_dwordx4 v[248:251], v11, s[28:31], s15 offen offset:2048 sc1
    v_mfma_f32_16x16x32_bf16 v[148:151], v[32:35], a[204:207], v[148:151]
    ds_read_b64_tr_b16 v[26:27], v7 offset:46720
    v_exp_f32 v15, v15
    v_mfma_f32_16x16x32_bf16 v[164:167], v[36:39], a[204:207], v[164:167]
    v_fma_f32 v80, v14, v12, v12
    v_fma_f32 v81, v15, v12, v12
    v_mul_f32 v14, v50, v50
    v_mfma_f32_16x16x32_bf16 v[160:163], v[36:39], a[200:203], v[160:163]
    ds_read_b64_tr_b16 v[28:29], v7 offset:46496
    v_mul_f32 v15, v51, v51
    v_mfma_f32_16x16x32_bf16 v[156:159], v[36:39], a[196:199], v[156:159]
    buffer_load_dwordx4 v[252:255], v11, s[28:31], s15 offen offset:3072 sc1
    v_mfma_f32_16x16x32_bf16 v[152:155], v[36:39], a[192:195], v[152:155]
    ds_read_b64_tr_b16 v[30:31], v7 offset:46752
    v_fma_f32 v14, v14, v238, v234
    s_waitcnt lgkmcnt(4)
    v_mfma_f32_16x16x32_bf16 v[104:107], v[16:19], a[208:211], v[104:107]
    s_waitcnt vmcnt(22)
    s_barrier
    v_mfma_f32_16x16x32_bf16 v[108:111], v[16:19], a[212:215], v[108:111]
    ds_read_b64_tr_b16 v[32:33], v7 offset:50688
    s_add_u32 m0, s66, 16896
    s_add_u32 s68, s42, 256
    v_mfma_f32_16x16x32_bf16 v[112:115], v[16:19], a[216:219], v[112:115]
    buffer_load_dwordx4 v3, s[20:23], s68 offen offset:0 lds
    v_fma_f32 v15, v15, v238, v234
    v_mfma_f32_16x16x32_bf16 v[116:119], v[16:19], a[220:223], v[116:119]
    ds_read_b64_tr_b16 v[34:35], v7 offset:50944
    v_rcp_f32 v80, v80
    v_mfma_f32_16x16x32_bf16 v[132:135], v[20:23], a[220:223], v[132:135]
    v_rcp_f32 v81, v81
    v_mul_f32 v48, v48, v80
    v_mfma_f32_16x16x32_bf16 v[128:131], v[20:23], a[216:219], v[128:131]
    ds_read_b64_tr_b16 v[36:37], v7 offset:50720
    v_mul_f32 v49, v49, v81
    v_cvt_pk_bf16_f32 v80, v48, v49
    v_mfma_f32_16x16x32_bf16 v[124:127], v[20:23], a[212:215], v[124:127]
    buffer_load_dwordx4 v4, s[20:23], s68 offen offset:1056 lds
    v_mul_f32 v14, v14, v50
    v_mfma_f32_16x16x32_bf16 v[120:123], v[20:23], a[208:211], v[120:123]
    ds_read_b64_tr_b16 v[38:39], v7 offset:50976
    v_mul_f32 v15, v15, v51
    s_waitcnt lgkmcnt(4)
    v_mfma_f32_16x16x32_bf16 v[136:139], v[24:27], a[208:211], v[136:139]
    v_exp_f32 v14, v14
    v_mul_f32 v50, v50, v82
    v_mfma_f32_16x16x32_bf16 v[140:143], v[24:27], a[212:215], v[140:143]
    ds_read_b64_tr_b16 v[16:17], v7 offset:54912
    v_exp_f32 v15, v15
    v_mfma_f32_16x16x32_bf16 v[144:147], v[24:27], a[216:219], v[144:147]
    buffer_load_dwordx4 v5, s[20:23], s68 offen offset:2112 lds
    v_mul_f32 v51, v51, v83
    v_mfma_f32_16x16x32_bf16 v[148:151], v[24:27], a[220:223], v[148:151]
    ds_read_b64_tr_b16 v[18:19], v7 offset:55168
    v_fma_f32 v82, v14, v12, v12
    v_fma_f32 v83, v15, v12, v12
    v_mfma_f32_16x16x32_bf16 v[164:167], v[28:31], a[220:223], v[164:167]
    v_rcp_f32 v82, v82
    v_mul_f32 v14, v64, v64
    v_mfma_f32_16x16x32_bf16 v[160:163], v[28:31], a[216:219], v[160:163]
    ds_read_b64_tr_b16 v[20:21], v7 offset:54944
    v_mul_f32 v50, v50, v82
    v_mfma_f32_16x16x32_bf16 v[156:159], v[28:31], a[212:215], v[156:159]
    buffer_load_dwordx4 v6, s[20:23], s68 offen offset:3168 lds
    v_mfma_f32_16x16x32_bf16 v[152:155], v[28:31], a[208:211], v[152:155]
    ds_read_b64_tr_b16 v[22:23], v7 offset:55200
    s_add_u32 m0, s66, 101376
    s_waitcnt lgkmcnt(4)
    v_mfma_f32_16x16x32_bf16 v[104:107], v[32:35], a[224:227], v[104:107]
    s_add_u32 s68, s43, 256
    v_rcp_f32 v83, v83
    v_mfma_f32_16x16x32_bf16 v[108:111], v[32:35], a[228:231], v[108:111]
    ds_read_b64_tr_b16 v[24:25], v7 offset:59136
    v_mul_f32 v51, v51, v83
    v_cvt_pk_bf16_f32 v81, v50, v51
    v_mfma_f32_16x16x32_bf16 v[112:115], v[32:35], a[232:235], v[112:115]
    buffer_load_dwordx4 v3, s[20:23], s68 offen offset:0 lds
    v_mul_f32 v15, v65, v65
    v_mfma_f32_16x16x32_bf16 v[116:119], v[32:35], a[236:239], v[116:119]
    ds_read_b64_tr_b16 v[26:27], v7 offset:59392
    v_fma_f32 v14, v14, v238, v234
    v_fma_f32 v15, v15, v238, v234
    v_mfma_f32_16x16x32_bf16 v[132:135], v[36:39], a[236:239], v[132:135]
    v_mul_f32 v14, v14, v64
    v_mul_f32 v15, v15, v65
    v_mul_f32 v64, v64, v96
    v_mfma_f32_16x16x32_bf16 v[128:131], v[36:39], a[232:235], v[128:131]
    ds_read_b64_tr_b16 v[28:29], v7 offset:59168
    v_mul_f32 v65, v65, v97
    v_mfma_f32_16x16x32_bf16 v[124:127], v[36:39], a[228:231], v[124:127]
    buffer_load_dwordx4 v4, s[20:23], s68 offen offset:1056 lds
    v_mfma_f32_16x16x32_bf16 v[120:123], v[36:39], a[224:227], v[120:123]
    ds_read_b64_tr_b16 v[30:31], v7 offset:59424
    s_waitcnt lgkmcnt(4)
    v_mfma_f32_16x16x32_bf16 v[136:139], v[16:19], a[224:227], v[136:139]
    v_exp_f32 v14, v14
    v_mfma_f32_16x16x32_bf16 v[140:143], v[16:19], a[228:231], v[140:143]
    ds_read_b64_tr_b16 v[32:33], v7 offset:63360
    v_exp_f32 v15, v15
    v_mfma_f32_16x16x32_bf16 v[144:147], v[16:19], a[232:235], v[144:147]
    buffer_load_dwordx4 v5, s[20:23], s68 offen offset:2112 lds
    v_fma_f32 v96, v14, v12, v12
    v_mfma_f32_16x16x32_bf16 v[148:151], v[16:19], a[236:239], v[148:151]
    ds_read_b64_tr_b16 v[34:35], v7 offset:63616
    v_fma_f32 v97, v15, v12, v12
    v_mul_f32 v14, v66, v66
    v_mfma_f32_16x16x32_bf16 v[164:167], v[20:23], a[236:239], v[164:167]
    v_rcp_f32 v96, v96
    v_mul_f32 v15, v67, v67
    v_mfma_f32_16x16x32_bf16 v[160:163], v[20:23], a[232:235], v[160:163]
    ds_read_b64_tr_b16 v[36:37], v7 offset:63392
    v_mul_f32 v64, v64, v96
    v_mfma_f32_16x16x32_bf16 v[156:159], v[20:23], a[228:231], v[156:159]
    buffer_load_dwordx4 v6, s[20:23], s68 offen offset:3168 lds
    v_mfma_f32_16x16x32_bf16 v[152:155], v[20:23], a[224:227], v[152:155]
    ds_read_b64_tr_b16 v[38:39], v7 offset:63648
    v_fma_f32 v14, v14, v238, v234
    s_waitcnt lgkmcnt(4)
    v_mfma_f32_16x16x32_bf16 v[104:107], v[24:27], a[240:243], v[104:107]
    s_waitcnt vmcnt(26)
    s_barrier
    v_mfma_f32_16x16x32_bf16 v[108:111], v[24:27], a[244:247], v[108:111]
    ds_read_b64_tr_b16 v[16:17], v8 offset:0
    s_add_u32 m0, s66, 33792
    s_add_u32 s68, s44, 256
    v_mfma_f32_16x16x32_bf16 v[112:115], v[24:27], a[248:251], v[112:115]
    buffer_load_dwordx4 v3, s[20:23], s68 offen offset:0 lds
    v_fma_f32 v15, v15, v238, v234
    v_mfma_f32_16x16x32_bf16 v[116:119], v[24:27], a[252:255], v[116:119]
    ds_read_b64_tr_b16 v[18:19], v8 offset:256
    v_rcp_f32 v97, v97
    v_mfma_f32_16x16x32_bf16 v[132:135], v[28:31], a[252:255], v[132:135]
    v_mul_f32 v65, v65, v97
    v_cvt_pk_bf16_f32 v82, v64, v65
    v_mul_f32 v14, v14, v66
    v_mfma_f32_16x16x32_bf16 v[128:131], v[28:31], a[248:251], v[128:131]
    ds_read_b64_tr_b16 v[20:21], v8 offset:32
    v_mul_f32 v15, v15, v67
    v_mul_f32 v66, v66, v98
    v_mfma_f32_16x16x32_bf16 v[124:127], v[28:31], a[244:247], v[124:127]
    buffer_load_dwordx4 v4, s[20:23], s68 offen offset:1056 lds
    v_mul_f32 v67, v67, v99
    v_mfma_f32_16x16x32_bf16 v[120:123], v[28:31], a[240:243], v[120:123]
    ds_read_b64_tr_b16 v[22:23], v8 offset:288
    s_waitcnt lgkmcnt(4)
    v_mfma_f32_16x16x32_bf16 v[136:139], v[32:35], a[240:243], v[136:139]
    v_exp_f32 v14, v14
    v_mfma_f32_16x16x32_bf16 v[140:143], v[32:35], a[244:247], v[140:143]
    ds_read_b64_tr_b16 v[24:25], v8 offset:4224
    v_exp_f32 v15, v15
    v_mfma_f32_16x16x32_bf16 v[144:147], v[32:35], a[248:251], v[144:147]
    buffer_load_dwordx4 v5, s[20:23], s68 offen offset:2112 lds
    v_fma_f32 v98, v14, v12, v12
    v_mfma_f32_16x16x32_bf16 v[148:151], v[32:35], a[252:255], v[148:151]
    ds_read_b64_tr_b16 v[26:27], v8 offset:4480
    v_fma_f32 v99, v15, v12, v12
    v_mfma_f32_16x16x32_bf16 v[164:167], v[36:39], a[252:255], v[164:167]
    v_rcp_f32 v98, v98
    v_mfma_f32_16x16x32_bf16 v[160:163], v[36:39], a[248:251], v[160:163]
    ds_read_b64_tr_b16 v[28:29], v8 offset:4256
    v_rcp_f32 v99, v99
    v_mfma_f32_16x16x32_bf16 v[156:159], v[36:39], a[244:247], v[156:159]
    buffer_load_dwordx4 v6, s[20:23], s68 offen offset:3168 lds
    v_mul_f32 v66, v66, v98
    v_mfma_f32_16x16x32_bf16 v[152:155], v[36:39], a[240:243], v[152:155]
    ds_read_b64_tr_b16 v[30:31], v8 offset:4512
    v_mul_f32 v67, v67, v99
    s_waitcnt lgkmcnt(4)
    v_mfma_f32_16x16x32_bf16 v[104:107], v[16:19], v[168:171], v[104:107]
    v_cvt_pk_bf16_f32 v83, v66, v67
    v_mfma_f32_16x16x32_bf16 v[108:111], v[16:19], v[172:175], v[108:111]
    ds_read_b64_tr_b16 v[32:33], v8 offset:8448
    v_mfma_f32_16x16x32_bf16 v[112:115], v[16:19], v[176:179], v[112:115]
    buffer_store_dwordx4 v[80:83], v11, s[28:31], s63 offen offset:2048 sc1
    v_mfma_f32_16x16x32_bf16 v[116:119], v[16:19], v[180:183], v[116:119]
    ds_read_b64_tr_b16 v[34:35], v8 offset:8704
    v_mul_f32 v14, v52, v52
    v_mul_f32 v15, v53, v53
    v_mfma_f32_16x16x32_bf16 v[132:135], v[20:23], v[180:183], v[132:135]
    v_fma_f32 v14, v14, v239, v235
    v_fma_f32 v15, v15, v239, v235
    v_mul_f32 v14, v14, v52
    v_mfma_f32_16x16x32_bf16 v[128:131], v[20:23], v[176:179], v[128:131]
    ds_read_b64_tr_b16 v[36:37], v8 offset:8480
    v_mul_f32 v15, v15, v53
    v_mfma_f32_16x16x32_bf16 v[124:127], v[20:23], v[172:175], v[124:127]
    v_exp_f32 v14, v14
    v_mul_f32 v52, v52, v84
    v_mfma_f32_16x16x32_bf16 v[120:123], v[20:23], v[168:171], v[120:123]
    ds_read_b64_tr_b16 v[38:39], v8 offset:8736
    s_waitcnt lgkmcnt(4)
    v_mfma_f32_16x16x32_bf16 v[136:139], v[24:27], v[168:171], v[136:139]
    v_exp_f32 v15, v15
    v_mul_f32 v53, v53, v85
    v_mfma_f32_16x16x32_bf16 v[140:143], v[24:27], v[172:175], v[140:143]
    ds_read_b64_tr_b16 v[16:17], v8 offset:12672
    v_fma_f32 v84, v14, v13, v13
    v_mfma_f32_16x16x32_bf16 v[144:147], v[24:27], v[176:179], v[144:147]
    v_fma_f32 v85, v15, v13, v13
    v_mul_f32 v14, v54, v54
    v_mfma_f32_16x16x32_bf16 v[148:151], v[24:27], v[180:183], v[148:151]
    ds_read_b64_tr_b16 v[18:19], v8 offset:12928
    v_mul_f32 v15, v55, v55
    v_mfma_f32_16x16x32_bf16 v[164:167], v[28:31], v[180:183], v[164:167]
    v_rcp_f32 v84, v84
    v_mfma_f32_16x16x32_bf16 v[160:163], v[28:31], v[176:179], v[160:163]
    ds_read_b64_tr_b16 v[20:21], v8 offset:12704
    v_mul_f32 v52, v52, v84
    v_mfma_f32_16x16x32_bf16 v[156:159], v[28:31], v[172:175], v[156:159]
    v_rcp_f32 v85, v85
    v_mfma_f32_16x16x32_bf16 v[152:155], v[28:31], v[168:171], v[152:155]
    ds_read_b64_tr_b16 v[22:23], v8 offset:12960
    s_waitcnt lgkmcnt(4)
    v_mfma_f32_16x16x32_bf16 v[104:107], v[32:35], v[184:187], v[104:107]
    s_waitcnt vmcnt(26)
    s_barrier
    v_mfma_f32_16x16x32_bf16 v[108:111], v[32:35], v[188:191], v[108:111]
    ds_read_b64_tr_b16 v[24:25], v8 offset:16896
    s_waitcnt vmcnt(13)
    v_xor_b32 v247, s1, v242
    v_mfma_f32_16x16x32_bf16 v[112:115], v[32:35], v[192:195], v[112:115]
    v_bitop3_b32 v247, v246, s1, v247 bitop3:0xbe
    v_bitop3_b32 v247, v250, s1, v247 bitop3:0xbe
    v_bitop3_b32 v247, v254, s1, v247 bitop3:0xbe
    v_mfma_f32_16x16x32_bf16 v[116:119], v[32:35], v[196:199], v[116:119]
    ds_read_b64_tr_b16 v[26:27], v8 offset:17152
    v_mul_f32 v53, v53, v85
    v_cvt_pk_bf16_f32 v84, v52, v53
    v_mfma_f32_16x16x32_bf16 v[132:135], v[36:39], v[196:199], v[132:135]
    v_cmp_ne_u32 vcc, 0, v247
    s_cmp_lg_u64 vcc, 0
    s_cbranch_scc1 AE1_spin
AE1_ok:
    v_mfma_f32_16x16x32_bf16 v[128:131], v[36:39], v[192:195], v[128:131]
    ds_read_b64_tr_b16 v[28:29], v8 offset:16928
    v_swap_b32 v241, v244
    v_swap_b32 v249, v252
    v_mfma_f32_16x16x32_bf16 v[124:127], v[36:39], v[188:191], v[124:127]
    s_add_u32 m0, s66, 50688
    s_add_u32 s68, s45, 256
    v_fma_f32 v14, v14, v239, v235
    v_mfma_f32_16x16x32_bf16 v[120:123], v[36:39], v[184:187], v[120:123]
    ds_read_b64_tr_b16 v[30:31], v8 offset:17184
    v_fma_f32 v15, v15, v239, v235
    s_waitcnt lgkmcnt(4)
    v_mfma_f32_16x16x32_bf16 v[136:139], v[16:19], v[184:187], v[136:139]
    buffer_load_dwordx4 v3, s[20:23], s68 offen offset:0 lds
    v_mul_f32 v14, v14, v54
    v_mfma_f32_16x16x32_bf16 v[140:143], v[16:19], v[188:191], v[140:143]
    ds_read_b64_tr_b16 v[32:33], v8 offset:21120
    v_mul_f32 v15, v15, v55
    v_mul_f32 v54, v54, v86
    v_mfma_f32_16x16x32_bf16 v[144:147], v[16:19], v[192:195], v[144:147]
    v_exp_f32 v14, v14
    v_mul_f32 v55, v55, v87
    v_mfma_f32_16x16x32_bf16 v[148:151], v[16:19], v[196:199], v[148:151]
    ds_read_b64_tr_b16 v[34:35], v8 offset:21376
    v_exp_f32 v15, v15
    v_mfma_f32_16x16x32_bf16 v[164:167], v[20:23], v[196:199], v[164:167]
    buffer_load_dwordx4 v4, s[20:23], s68 offen offset:1056 lds
    v_fma_f32 v86, v14, v13, v13
    v_mfma_f32_16x16x32_bf16 v[160:163], v[20:23], v[192:195], v[160:163]
    ds_read_b64_tr_b16 v[36:37], v8 offset:21152
    v_fma_f32 v87, v15, v13, v13
    v_mul_f32 v14, v68, v68
    v_mfma_f32_16x16x32_bf16 v[156:159], v[20:23], v[188:191], v[156:159]
    v_rcp_f32 v86, v86
    v_mul_f32 v15, v69, v69
    v_mfma_f32_16x16x32_bf16 v[152:155], v[20:23], v[184:187], v[152:155]
    ds_read_b64_tr_b16 v[38:39], v8 offset:21408
    v_mul_f32 v54, v54, v86
    s_waitcnt lgkmcnt(4)
    v_mfma_f32_16x16x32_bf16 v[104:107], v[24:27], v[200:203], v[104:107]
    buffer_load_dwordx4 v5, s[20:23], s68 offen offset:2112 lds
    v_fma_f32 v14, v14, v239, v235
    v_mfma_f32_16x16x32_bf16 v[108:111], v[24:27], v[204:207], v[108:111]
    ds_read_b64_tr_b16 v[16:17], v8 offset:25344
    v_rcp_f32 v87, v87
    v_mfma_f32_16x16x32_bf16 v[112:115], v[24:27], v[208:211], v[112:115]
    v_mul_f32 v55, v55, v87
    v_cvt_pk_bf16_f32 v85, v54, v55
    v_fma_f32 v15, v15, v239, v235
    v_mfma_f32_16x16x32_bf16 v[116:119], v[24:27], v[212:215], v[116:119]
    ds_read_b64_tr_b16 v[18:19], v8 offset:25600
    v_mul_f32 v14, v14, v68
    v_mul_f32 v15, v15, v69
    v_mfma_f32_16x16x32_bf16 v[132:135], v[28:31], v[212:215], v[132:135]
    v_perm_b32 v242, v0, v0, s4
    v_perm_b32 v243, v0, v0, s4
    v_mul_f32 v68, v68, v100
    v_mfma_f32_16x16x32_bf16 v[128:131], v[28:31], v[208:211], v[128:131]
    ds_read_b64_tr_b16 v[20:21], v8 offset:25376
    v_exp_f32 v14, v14
    v_mfma_f32_16x16x32_bf16 v[124:127], v[28:31], v[204:207], v[124:127]
    buffer_load_dwordx4 v6, s[20:23], s68 offen offset:3168 lds
    v_mul_f32 v69, v69, v101
    v_mfma_f32_16x16x32_bf16 v[120:123], v[28:31], v[200:203], v[120:123]
    ds_read_b64_tr_b16 v[22:23], v8 offset:25632
    v_exp_f32 v15, v15
    v_mfma_f32_16x16x16_bf16 v[104:107], v[240:241], v[242:243], v[104:107]
    v_fma_f32 v100, v14, v13, v13
    v_fma_f32 v101, v15, v13, v13
    v_mfma_f32_16x16x16_bf16 v[120:123], v[244:245], v[242:243], v[120:123]
    v_rcp_f32 v100, v100
    v_mfma_f32_16x16x16_bf16 v[136:139], v[248:249], v[242:243], v[136:139]
    v_rcp_f32 v101, v101
    v_mfma_f32_16x16x16_bf16 v[152:155], v[252:253], v[242:243], v[152:155]
    v_mul_f32 v68, v68, v100
    s_waitcnt lgkmcnt(4)
    v_mfma_f32_16x16x32_bf16 v[136:139], v[32:35], v[200:203], v[136:139]
    v_mul_f32 v69, v69, v101
    v_cvt_pk_bf16_f32 v86, v68, v69
    v_mfma_f32_16x16x32_bf16 v[140:143], v[32:35], v[204:207], v[140:143]
    ds_read_b64_tr_b16 v[24:25], v8 offset:29568
    v_mul_f32 v14, v70, v70
    v_mfma_f32_16x16x32_bf16 v[144:147], v[32:35], v[208:211], v[144:147]
    v_mul_f32 v15, v71, v71
    v_fma_f32 v14, v14, v239, v235
    v_mfma_f32_16x16x32_bf16 v[148:151], v[32:35], v[212:215], v[148:151]
    ds_read_b64_tr_b16 v[26:27], v8 offset:29824
    v_fma_f32 v15, v15, v239, v235
    v_mfma_f32_16x16x32_bf16 v[164:167], v[36:39], v[212:215], v[164:167]
    v_perm_b32 v246, v0, v0, s5
    v_perm_b32 v247, v0, v0, s5
    v_mfma_f32_16x16x32_bf16 v[160:163], v[36:39], v[208:211], v[160:163]
    ds_read_b64_tr_b16 v[28:29], v8 offset:29600
    v_mul_f32 v14, v14, v70
    v_mfma_f32_16x16x32_bf16 v[156:159], v[36:39], v[204:207], v[156:159]
    v_mul_f32 v15, v15, v71
    v_mul_f32 v70, v70, v102
    v_mfma_f32_16x16x32_bf16 v[152:155], v[36:39], v[200:203], v[152:155]
    ds_read_b64_tr_b16 v[30:31], v8 offset:29856
    v_mul_f32 v71, v71, v103
    v_mfma_f32_16x16x16_bf16 v[108:111], v[240:241], v[246:247], v[108:111]
    v_exp_f32 v14, v14
    v_mfma_f32_16x16x16_bf16 v[124:127], v[244:245], v[246:247], v[124:127]
    v_exp_f32 v15, v15
    v_mfma_f32_16x16x16_bf16 v[140:143], v[248:249], v[246:247], v[140:143]
    v_fma_f32 v102, v14, v13, v13
    v_fma_f32 v103, v15, v13, v13
    v_mfma_f32_16x16x16_bf16 v[156:159], v[252:253], v[246:247], v[156:159]
    s_waitcnt lgkmcnt(4)
    v_mfma_f32_16x16x32_bf16 v[104:107], v[16:19], v[216:219], v[104:107]
    s_barrier
    v_mfma_f32_16x16x32_bf16 v[108:111], v[16:19], v[220:223], v[108:111]
    ds_read_b64_tr_b16 v[32:33], v8 offset:50688
    s_add_u32 m0, s66, 67584
    v_mfma_f32_16x16x32_bf16 v[112:115], v[16:19], v[224:227], v[112:115]
    s_add_u32 s68, s46, 256
    v_mfma_f32_16x16x32_bf16 v[116:119], v[16:19], v[228:231], v[116:119]
    ds_read_b64_tr_b16 v[34:35], v8 offset:50944
    v_mfma_f32_16x16x32_bf16 v[132:135], v[20:23], v[228:231], v[132:135]
    v_perm_b32 v242, v9, v9, s4
    v_perm_b32 v243, v9, v9, s4
    v_mfma_f32_16x16x32_bf16 v[128:131], v[20:23], v[224:227], v[128:131]
    ds_read_b64_tr_b16 v[36:37], v8 offset:50720
    v_mfma_f32_16x16x32_bf16 v[124:127], v[20:23], v[220:223], v[124:127]
    buffer_load_dwordx4 v3, s[20:23], s68 offen offset:0 lds
    v_mfma_f32_16x16x32_bf16 v[120:123], v[20:23], v[216:219], v[120:123]
    ds_read_b64_tr_b16 v[38:39], v8 offset:50976
    v_mfma_f32_16x16x16_bf16 v[112:115], v[240:241], v[242:243], v[112:115]
    v_rcp_f32 v102, v102
    v_mfma_f32_16x16x16_bf16 v[128:131], v[244:245], v[242:243], v[128:131]
    v_rcp_f32 v103, v103
    v_mfma_f32_16x16x16_bf16 v[144:147], v[248:249], v[242:243], v[144:147]
    buffer_load_dwordx4 v4, s[20:23], s68 offen offset:1056 lds
    v_mfma_f32_16x16x16_bf16 v[160:163], v[252:253], v[242:243], v[160:163]
    v_mul_f32 v70, v70, v102
    s_waitcnt lgkmcnt(4)
    v_mfma_f32_16x16x32_bf16 v[136:139], v[24:27], v[216:219], v[136:139]
    v_mul_f32 v71, v71, v103
    v_cvt_pk_bf16_f32 v87, v70, v71
    v_mfma_f32_16x16x32_bf16 v[140:143], v[24:27], v[220:223], v[140:143]
    ds_read_b64_tr_b16 v[16:17], v8 offset:54912
    v_mfma_f32_16x16x32_bf16 v[144:147], v[24:27], v[224:227], v[144:147]
    buffer_load_dwordx4 v5, s[20:23], s68 offen offset:2112 lds
    v_mfma_f32_16x16x32_bf16 v[148:151], v[24:27], v[228:231], v[148:151]
    ds_read_b64_tr_b16 v[18:19], v8 offset:55168
    v_mfma_f32_16x16x32_bf16 v[164:167], v[28:31], v[228:231], v[164:167]
    v_perm_b32 v246, v9, v9, s5
    v_perm_b32 v247, v9, v9, s5
    v_mfma_f32_16x16x32_bf16 v[160:163], v[28:31], v[224:227], v[160:163]
    ds_read_b64_tr_b16 v[20:21], v8 offset:54944
    v_mfma_f32_16x16x32_bf16 v[156:159], v[28:31], v[220:223], v[156:159]
    buffer_load_dwordx4 v6, s[20:23], s68 offen offset:3168 lds
    v_mfma_f32_16x16x32_bf16 v[152:155], v[28:31], v[216:219], v[152:155]
    ds_read_b64_tr_b16 v[22:23], v8 offset:55200
    v_mfma_f32_16x16x16_bf16 v[116:119], v[240:241], v[246:247], v[116:119]
    buffer_store_dwordx4 v[84:87], v11, s[28:31], s63 offen offset:3072 sc1
    v_mfma_f32_16x16x16_bf16 v[132:135], v[244:245], v[246:247], v[132:135]
    v_mfma_f32_16x16x16_bf16 v[148:151], v[248:249], v[246:247], v[148:151]
    s_buffer_load_dword s56, s[28:31], s35 offset:64 glc
    v_mfma_f32_16x16x16_bf16 v[164:167], v[252:253], v[246:247], v[164:167]
    s_waitcnt lgkmcnt(4)
    v_mfma_f32_16x16x32_bf16 v[40:43], v[32:35], a[0:3], 0
    v_mov_b32 v240, s6
    v_mov_b32 v241, s6
    v_mfma_f32_16x16x32_bf16 v[44:47], v[32:35], a[4:7], 0
    ds_read_b64_tr_b16 v[24:25], v8 offset:59136
    v_mfma_f32_16x16x32_bf16 v[48:51], v[32:35], a[8:11], 0
    v_mov_b32 v242, s6
    v_mov_b32 v243, s6
    v_mfma_f32_16x16x32_bf16 v[52:55], v[32:35], a[12:15], 0
    ds_read_b64_tr_b16 v[26:27], v8 offset:59392
    v_mfma_f32_16x16x32_bf16 v[68:71], v[36:39], a[12:15], 0
    v_mul_f32 v14, v104, v104
    v_mul_f32 v15, v105, v105
    v_fma_f32 v14, v14, v236, v232
    v_mfma_f32_16x16x32_bf16 v[64:67], v[36:39], a[8:11], 0
    ds_read_b64_tr_b16 v[28:29], v8 offset:59168
    v_fma_f32 v15, v15, v236, v232
    v_mul_f32 v14, v14, v104
    v_mfma_f32_16x16x32_bf16 v[60:63], v[36:39], a[4:7], 0
    v_mul_f32 v15, v15, v105
    v_exp_f32 v14, v14
    v_mfma_f32_16x16x32_bf16 v[56:59], v[36:39], a[0:3], 0
    ds_read_b64_tr_b16 v[30:31], v8 offset:59424
    v_exp_f32 v15, v15
    v_mfma_f32_16x16x32_bf16 v[248:251], v[240:243], v[32:35], 0
    v_mul_f32 v104, v104, v136
    v_mul_f32 v105, v105, v137
    v_mfma_f32_16x16x32_bf16 v[252:255], v[240:243], v[36:39], 0
    v_fma_f32 v136, v14, v1, v1
    s_waitcnt lgkmcnt(4)
    v_mfma_f32_16x16x32_bf16 v[72:75], v[16:19], a[0:3], 0
    v_mov_b32 v244, s7
    v_mov_b32 v245, s7
    v_fma_f32 v137, v15, v1, v1
    v_mfma_f32_16x16x32_bf16 v[76:79], v[16:19], a[4:7], 0
    ds_read_b64_tr_b16 v[32:33], v8 offset:63360
    v_rcp_f32 v136, v136
    v_mfma_f32_16x16x32_bf16 v[80:83], v[16:19], a[8:11], 0
    v_mov_b32 v246, s7
    v_mov_b32 v247, s7
    v_mul_f32 v104, v104, v136
    v_mfma_f32_16x16x32_bf16 v[84:87], v[16:19], a[12:15], 0
    ds_read_b64_tr_b16 v[34:35], v8 offset:63616
    v_rcp_f32 v137, v137
    v_mfma_f32_16x16x32_bf16 v[100:103], v[20:23], a[12:15], 0
    v_mul_f32 v105, v105, v137
    v_cvt_pk_bf16_f32 v136, v104, v105
    v_mul_f32 v14, v106, v106
    v_mfma_f32_16x16x32_bf16 v[96:99], v[20:23], a[8:11], 0
    ds_read_b64_tr_b16 v[36:37], v8 offset:63392
    v_mul_f32 v15, v107, v107
    v_fma_f32 v14, v14, v236, v232
    v_mfma_f32_16x16x32_bf16 v[92:95], v[20:23], a[4:7], 0
    v_fma_f32 v15, v15, v236, v232
    v_mul_f32 v14, v14, v106
    v_mul_f32 v15, v15, v107
    v_mfma_f32_16x16x32_bf16 v[88:91], v[20:23], a[0:3], 0
    ds_read_b64_tr_b16 v[38:39], v8 offset:63648
    v_exp_f32 v14, v14
    v_mfma_f32_16x16x32_bf16 v[248:251], v[244:247], v[16:19], v[248:251]
    v_exp_f32 v15, v15
    v_mfma_f32_16x16x32_bf16 v[252:255], v[244:247], v[20:23], v[252:255]
    v_mul_f32 v106, v106, v138
    s_waitcnt lgkmcnt(4)
    v_mfma_f32_16x16x32_bf16 v[40:43], v[24:27], a[16:19], v[40:43]
    s_barrier
    v_mfma_f32_16x16x32_bf16 v[44:47], v[24:27], a[20:23], v[44:47]
    ds_read_b64_tr_b16 v[16:17], v7 offset:0
    s_add_u32 m0, s66, 84480
    s_add_u32 s68, s47, 256
    v_mfma_f32_16x16x32_bf16 v[48:51], v[24:27], a[24:27], v[48:51]
    buffer_load_dwordx4 v3, s[20:23], s68 offen offset:0 lds
    v_mul_f32 v107, v107, v139
    v_mfma_f32_16x16x32_bf16 v[52:55], v[24:27], a[28:31], v[52:55]
    ds_read_b64_tr_b16 v[18:19], v7 offset:256
    v_fma_f32 v138, v14, v1, v1
    v_fma_f32 v139, v15, v1, v1
    v_mfma_f32_16x16x32_bf16 v[68:71], v[28:31], a[28:31], v[68:71]
    v_rcp_f32 v138, v138
    v_mul_f32 v14, v120, v120
    v_mfma_f32_16x16x32_bf16 v[64:67], v[28:31], a[24:27], v[64:67]
    ds_read_b64_tr_b16 v[20:21], v7 offset:32
    v_rcp_f32 v139, v139
    v_mfma_f32_16x16x32_bf16 v[60:63], v[28:31], a[20:23], v[60:63]
    buffer_load_dwordx4 v4, s[20:23], s68 offen offset:1056 lds
    v_mul_f32 v106, v106, v138
    v_mfma_f32_16x16x32_bf16 v[56:59], v[28:31], a[16:19], v[56:59]
    ds_read_b64_tr_b16 v[22:23], v7 offset:288
    v_mul_f32 v107, v107, v139
    v_cvt_pk_bf16_f32 v137, v106, v107
    v_mfma_f32_16x16x32_bf16 v[248:251], v[240:243], v[24:27], v[248:251]
    v_mul_f32 v15, v121, v121
    v_fma_f32 v14, v14, v236, v232
    v_mfma_f32_16x16x32_bf16 v[252:255], v[240:243], v[28:31], v[252:255]
    v_fma_f32 v15, v15, v236, v232
    s_waitcnt lgkmcnt(4)
    v_mfma_f32_16x16x32_bf16 v[72:75], v[32:35], a[16:19], v[72:75]
    buffer_load_dwordx4 v5, s[20:23], s68 offen offset:2112 lds
    v_mul_f32 v14, v14, v120
    v_mfma_f32_16x16x32_bf16 v[76:79], v[32:35], a[20:23], v[76:79]
    ds_read_b64_tr_b16 v[24:25], v7 offset:4224
    v_mul_f32 v15, v15, v121
    v_mul_f32 v120, v120, v152
    v_mfma_f32_16x16x32_bf16 v[80:83], v[32:35], a[24:27], v[80:83]
    v_exp_f32 v14, v14
    v_mul_f32 v121, v121, v153
    v_mfma_f32_16x16x32_bf16 v[84:87], v[32:35], a[28:31], v[84:87]
    ds_read_b64_tr_b16 v[26:27], v7 offset:4480
    v_exp_f32 v15, v15
    v_mfma_f32_16x16x32_bf16 v[100:103], v[36:39], a[28:31], v[100:103]
    buffer_load_dwordx4 v6, s[20:23], s68 offen offset:3168 lds
    v_fma_f32 v152, v14, v1, v1
    v_mfma_f32_16x16x32_bf16 v[96:99], v[36:39], a[24:27], v[96:99]
    ds_read_b64_tr_b16 v[28:29], v7 offset:4256
    v_fma_f32 v153, v15, v1, v1
    v_mul_f32 v14, v122, v122
    v_mfma_f32_16x16x32_bf16 v[92:95], v[36:39], a[20:23], v[92:95]
    v_rcp_f32 v152, v152
    v_mul_f32 v15, v123, v123
    v_mfma_f32_16x16x32_bf16 v[88:91], v[36:39], a[16:19], v[88:91]
    ds_read_b64_tr_b16 v[30:31], v7 offset:4512
    s_waitcnt vmcnt(4)
    v_mul_f32 v120, v120, v152
    v_mfma_f32_16x16x32_bf16 v[248:251], v[244:247], v[32:35], v[248:251]
    s_mov_b64 exec, 2
    buffer_store_dword v2, off, s[28:31], s34 sc1
    s_mov_b64 exec, -1
    v_mfma_f32_16x16x32_bf16 v[252:255], v[244:247], v[36:39], v[252:255]
    v_fma_f32 v14, v14, v236, v232
    s_waitcnt lgkmcnt(4)
    v_mfma_f32_16x16x32_bf16 v[40:43], v[16:19], a[32:35], v[40:43]
    v_mov_b32 v240, s10
    v_mov_b32 v241, s10
    v_fma_f32 v15, v15, v236, v232
    v_mfma_f32_16x16x32_bf16 v[44:47], v[16:19], a[36:39], v[44:47]
    ds_read_b64_tr_b16 v[32:33], v7 offset:8448
    v_rcp_f32 v153, v153
    v_mfma_f32_16x16x32_bf16 v[48:51], v[16:19], a[40:43], v[48:51]
    v_mov_b32 v242, s10
    v_mov_b32 v243, s10
    v_mul_f32 v121, v121, v153
    v_mfma_f32_16x16x32_bf16 v[52:55], v[16:19], a[44:47], v[52:55]
    ds_read_b64_tr_b16 v[34:35], v7 offset:8704
    v_cvt_pk_bf16_f32 v138, v120, v121
    v_mul_f32 v14, v14, v122
    v_mfma_f32_16x16x32_bf16 v[68:71], v[20:23], a[44:47], v[68:71]
    v_mul_f32 v15, v15, v123
    v_exp_f32 v14, v14
    v_mfma_f32_16x16x32_bf16 v[64:67], v[20:23], a[40:43], v[64:67]
    ds_read_b64_tr_b16 v[36:37], v7 offset:8480
    v_exp_f32 v15, v15
    v_mfma_f32_16x16x32_bf16 v[60:63], v[20:23], a[36:39], v[60:63]
    v_mul_f32 v122, v122, v154
    v_mul_f32 v123, v123, v155
    v_fma_f32 v154, v14, v1, v1
    v_mfma_f32_16x16x32_bf16 v[56:59], v[20:23], a[32:35], v[56:59]
    ds_read_b64_tr_b16 v[38:39], v7 offset:8736
    v_fma_f32 v155, v15, v1, v1
    v_mfma_f32_16x16x32_bf16 v[248:251], v[240:243], v[16:19], v[248:251]
    v_rcp_f32 v154, v154
    v_mfma_f32_16x16x32_bf16 v[252:255], v[240:243], v[20:23], v[252:255]
    v_mul_f32 v122, v122, v154
    s_waitcnt lgkmcnt(4)
    v_mfma_f32_16x16x32_bf16 v[72:75], v[24:27], a[32:35], v[72:75]
    v_mov_b32 v244, s11
    v_mov_b32 v245, s11
    v_mfma_f32_16x16x32_bf16 v[76:79], v[24:27], a[36:39], v[76:79]
    ds_read_b64_tr_b16 v[16:17], v7 offset:12672
    v_rcp_f32 v155, v155
    v_mfma_f32_16x16x32_bf16 v[80:83], v[24:27], a[40:43], v[80:83]
    v_mov_b32 v246, s11
    v_mov_b32 v247, s11
    v_mul_f32 v123, v123, v155
    v_mfma_f32_16x16x32_bf16 v[84:87], v[24:27], a[44:47], v[84:87]
    ds_read_b64_tr_b16 v[18:19], v7 offset:12928
    v_cvt_pk_bf16_f32 v139, v122, v123
    v_mfma_f32_16x16x32_bf16 v[100:103], v[28:31], a[44:47], v[100:103]
    buffer_store_dwordx4 v[136:139], v11, s[28:31], s64 offen offset:0 sc1
    v_mfma_f32_16x16x32_bf16 v[96:99], v[28:31], a[40:43], v[96:99]
    ds_read_b64_tr_b16 v[20:21], v7 offset:12704
    v_mul_f32 v14, v108, v108
    v_mul_f32 v15, v109, v109
    v_mfma_f32_16x16x32_bf16 v[92:95], v[28:31], a[36:39], v[92:95]
    v_fma_f32 v14, v14, v237, v233
    v_fma_f32 v15, v15, v237, v233
    v_mul_f32 v14, v14, v108
    v_mfma_f32_16x16x32_bf16 v[88:91], v[28:31], a[32:35], v[88:91]
    ds_read_b64_tr_b16 v[22:23], v7 offset:12960
    v_mul_f32 v15, v15, v109
    v_mul_f32 v108, v108, v140
    v_mfma_f32_16x16x32_bf16 v[248:251], v[244:247], v[24:27], v[248:251]
    v_exp_f32 v14, v14
    v_mfma_f32_16x16x32_bf16 v[252:255], v[244:247], v[28:31], v[252:255]
    v_mul_f32 v109, v109, v141
    s_waitcnt lgkmcnt(4)
    v_mfma_f32_16x16x32_bf16 v[40:43], v[32:35], a[48:51], v[40:43]
    s_barrier
    v_mfma_f32_16x16x32_bf16 v[44:47], v[32:35], a[52:55], v[44:47]
    ds_read_b64_tr_b16 v[24:25], v7 offset:16896
    s_waitcnt lgkmcnt(0)
    s_add_u32 s100, s1, 0
    v_mfma_f32_16x16x32_bf16 v[48:51], v[32:35], a[56:59], v[48:51]
    s_sub_u32 s56, s56, s100
    s_cmp_gt_u32 s56, 3
    s_cbranch_scc1 FFN_pf_spin
FFN_pf_ok:
    v_mfma_f32_16x16x32_bf16 v[52:55], v[32:35], a[60:63], v[52:55]
    ds_read_b64_tr_b16 v[26:27], v7 offset:17152
    s_add_u32 m0, s66, 118272
    s_add_u32 s68, s48, 256
    v_mfma_f32_16x16x32_bf16 v[68:71], v[36:39], a[60:63], v[68:71]
    buffer_load_dwordx4 v3, s[20:23], s68 offen offset:0 lds
    v_fma_f32 v140, v14, v10, v10
    v_mfma_f32_16x16x32_bf16 v[64:67], v[36:39], a[56:59], v[64:67]
    ds_read_b64_tr_b16 v[28:29], v7 offset:16928
    v_exp_f32 v15, v15
    v_mfma_f32_16x16x32_bf16 v[60:63], v[36:39], a[52:55], v[60:63]
    v_fma_f32 v141, v15, v10, v10
    v_rcp_f32 v140, v140
    v_mfma_f32_16x16x32_bf16 v[56:59], v[36:39], a[48:51], v[56:59]
    ds_read_b64_tr_b16 v[30:31], v7 offset:17184
    v_rcp_f32 v141, v141
    v_mfma_f32_16x16x32_bf16 v[248:251], v[240:243], v[32:35], v[248:251]
    buffer_load_dwordx4 v4, s[20:23], s68 offen offset:1056 lds
    v_mfma_f32_16x16x32_bf16 v[252:255], v[240:243], v[36:39], v[252:255]
    v_mul_f32 v108, v108, v140
    s_waitcnt lgkmcnt(4)
    v_mfma_f32_16x16x32_bf16 v[72:75], v[16:19], a[48:51], v[72:75]
    v_mul_f32 v109, v109, v141
    v_cvt_pk_bf16_f32 v140, v108, v109
    v_mul_f32 v14, v110, v110
    v_mfma_f32_16x16x32_bf16 v[76:79], v[16:19], a[52:55], v[76:79]
    ds_read_b64_tr_b16 v[32:33], v7 offset:21120
    v_mul_f32 v15, v111, v111
    v_fma_f32 v14, v14, v237, v233
    v_mfma_f32_16x16x32_bf16 v[80:83], v[16:19], a[56:59], v[80:83]
    buffer_load_dwordx4 v5, s[20:23], s68 offen offset:2112 lds
    v_fma_f32 v15, v15, v237, v233
    v_mfma_f32_16x16x32_bf16 v[84:87], v[16:19], a[60:63], v[84:87]
    ds_read_b64_tr_b16 v[34:35], v7 offset:21376
    v_mul_f32 v14, v14, v110
    v_mul_f32 v15, v15, v111
    v_mfma_f32_16x16x32_bf16 v[100:103], v[20:23], a[60:63], v[100:103]
    v_exp_f32 v14, v14
    v_mul_f32 v110, v110, v142
    v_mfma_f32_16x16x32_bf16 v[96:99], v[20:23], a[56:59], v[96:99]
    ds_read_b64_tr_b16 v[36:37], v7 offset:21152
    v_exp_f32 v15, v15
    v_mfma_f32_16x16x32_bf16 v[92:95], v[20:23], a[52:55], v[92:95]
    buffer_load_dwordx4 v6, s[20:23], s68 offen offset:3168 lds
    s_add_u32 s13, s92, 819200
    v_mfma_f32_16x16x32_bf16 v[88:91], v[20:23], a[48:51], v[88:91]
    ds_read_b64_tr_b16 v[38:39], v7 offset:21408
    v_mul_f32 v111, v111, v143
    v_fma_f32 v142, v14, v10, v10
    v_mfma_f32_16x16x32_bf16 v[248:251], v[244:247], v[16:19], v[248:251]
    v_fma_f32 v143, v15, v10, v10
    v_mul_f32 v14, v124, v124
    v_mfma_f32_16x16x32_bf16 v[252:255], v[244:247], v[20:23], v[252:255]
    v_mul_f32 v15, v125, v125
    s_waitcnt lgkmcnt(4)
    v_mfma_f32_16x16x32_bf16 v[40:43], v[24:27], a[64:67], v[40:43]
    buffer_load_dwordx4 a[0:3], v11, s[28:31], s13 offen offset:0 sc1
    v_fma_f32 v14, v14, v237, v233
    v_mfma_f32_16x16x32_bf16 v[44:47], v[24:27], a[68:71], v[44:47]
    ds_read_b64_tr_b16 v[16:17], v7 offset:25344
    v_rcp_f32 v142, v142
    v_mfma_f32_16x16x32_bf16 v[48:51], v[24:27], a[72:75], v[48:51]
    v_rcp_f32 v143, v143
    v_mul_f32 v110, v110, v142
    v_mfma_f32_16x16x32_bf16 v[52:55], v[24:27], a[76:79], v[52:55]
    ds_read_b64_tr_b16 v[18:19], v7 offset:25600
    v_mul_f32 v111, v111, v143
    v_cvt_pk_bf16_f32 v141, v110, v111
    v_mfma_f32_16x16x32_bf16 v[68:71], v[28:31], a[76:79], v[68:71]
    v_cvt_pk_bf16_f32 v249, v248, v248
    v_lshlrev_b32 v249, 16, v249
    v_sub_f32 v248, v248, v249
    v_mfma_f32_16x16x32_bf16 v[64:67], v[28:31], a[72:75], v[64:67]
    ds_read_b64_tr_b16 v[20:21], v7 offset:25376
    v_cvt_pk_bf16_f32 v240, v249, v248
    v_cvt_pk_bf16_f32 v253, v252, v252
    v_mfma_f32_16x16x32_bf16 v[60:63], v[28:31], a[68:71], v[60:63]
    v_lshlrev_b32 v253, 16, v253
    v_sub_f32 v252, v252, v253
    v_cvt_pk_bf16_f32 v241, v253, v252
    v_mfma_f32_16x16x32_bf16 v[56:59], v[28:31], a[64:67], v[56:59]
    ds_read_b64_tr_b16 v[22:23], v7 offset:25632
    v_mov_b32 v242, s1
    s_waitcnt lgkmcnt(4)
    v_mfma_f32_16x16x32_bf16 v[72:75], v[32:35], a[64:67], v[72:75]
    s_add_u32 s14, s73, 16384
    v_fma_f32 v15, v15, v237, v233
    v_mul_f32 v14, v14, v124
    v_mfma_f32_16x16x32_bf16 v[76:79], v[32:35], a[68:71], v[76:79]
    ds_read_b64_tr_b16 v[24:25], v7 offset:29568
    v_mul_f32 v15, v15, v125
    v_mul_f32 v124, v124, v156
    v_mfma_f32_16x16x32_bf16 v[80:83], v[32:35], a[72:75], v[80:83]
    s_mov_b64 exec, 0xffff
    buffer_store_dwordx4 v[240:243], v11, s[28:31], s14 offen sc1
    s_mov_b64 exec, -1
    v_mfma_f32_16x16x32_bf16 v[84:87], v[32:35], a[76:79], v[84:87]
    ds_read_b64_tr_b16 v[26:27], v7 offset:29824
    v_exp_f32 v14, v14
    v_mfma_f32_16x16x32_bf16 v[100:103], v[36:39], a[76:79], v[100:103]
    v_exp_f32 v15, v15
    v_mul_f32 v125, v125, v157
    v_mfma_f32_16x16x32_bf16 v[96:99], v[36:39], a[72:75], v[96:99]
    ds_read_b64_tr_b16 v[28:29], v7 offset:29600
    v_fma_f32 v156, v14, v10, v10
    v_fma_f32 v157, v15, v10, v10
    v_mfma_f32_16x16x32_bf16 v[92:95], v[36:39], a[68:71], v[92:95]
    buffer_load_dwordx4 a[4:7], v11, s[28:31], s13 offen offset:1024 sc1
    v_mul_f32 v14, v126, v126
    v_mfma_f32_16x16x32_bf16 v[88:91], v[36:39], a[64:67], v[88:91]
    ds_read_b64_tr_b16 v[30:31], v7 offset:29856
    v_mul_f32 v15, v127, v127
    s_waitcnt lgkmcnt(4)
    v_mfma_f32_16x16x32_bf16 v[40:43], v[16:19], a[80:83], v[40:43]
    s_barrier
    v_mfma_f32_16x16x32_bf16 v[44:47], v[16:19], a[84:87], v[44:47]
    ds_read_b64_tr_b16 v[32:33], v8 offset:33792
    s_add_u32 m0, s66, 0
    s_add_u32 s68, s49, 256
    v_mfma_f32_16x16x32_bf16 v[48:51], v[16:19], a[88:91], v[48:51]
    buffer_load_dwordx4 v3, s[20:23], s68 offen offset:0 lds
    v_fma_f32 v14, v14, v237, v233
    v_mfma_f32_16x16x32_bf16 v[52:55], v[16:19], a[92:95], v[52:55]
    ds_read_b64_tr_b16 v[34:35], v8 offset:34048
    v_rcp_f32 v156, v156
    v_mfma_f32_16x16x32_bf16 v[68:71], v[20:23], a[92:95], v[68:71]
    v_rcp_f32 v157, v157
    v_mul_f32 v124, v124, v156
    v_mfma_f32_16x16x32_bf16 v[64:67], v[20:23], a[88:91], v[64:67]
    ds_read_b64_tr_b16 v[36:37], v8 offset:33824
    v_mul_f32 v125, v125, v157
    v_cvt_pk_bf16_f32 v142, v124, v125
    v_mfma_f32_16x16x32_bf16 v[60:63], v[20:23], a[84:87], v[60:63]
    buffer_load_dwordx4 v4, s[20:23], s68 offen offset:1056 lds
    v_fma_f32 v15, v15, v237, v233
    v_mfma_f32_16x16x32_bf16 v[56:59], v[20:23], a[80:83], v[56:59]
    ds_read_b64_tr_b16 v[38:39], v8 offset:34080
    v_mul_f32 v14, v14, v126
    s_waitcnt lgkmcnt(4)
    v_mfma_f32_16x16x32_bf16 v[72:75], v[24:27], a[80:83], v[72:75]
    v_mul_f32 v15, v15, v127
    v_exp_f32 v14, v14
    v_mfma_f32_16x16x32_bf16 v[76:79], v[24:27], a[84:87], v[76:79]
    ds_read_b64_tr_b16 v[16:17], v8 offset:38016
    v_exp_f32 v15, v15
    v_mfma_f32_16x16x32_bf16 v[80:83], v[24:27], a[88:91], v[80:83]
    buffer_load_dwordx4 v5, s[20:23], s68 offen offset:2112 lds
    v_mul_f32 v126, v126, v158
    v_mfma_f32_16x16x32_bf16 v[84:87], v[24:27], a[92:95], v[84:87]
    ds_read_b64_tr_b16 v[18:19], v8 offset:38272
    v_mul_f32 v127, v127, v159
    v_fma_f32 v158, v14, v10, v10
    v_mfma_f32_16x16x32_bf16 v[100:103], v[28:31], a[92:95], v[100:103]
    v_fma_f32 v159, v15, v10, v10
    v_rcp_f32 v158, v158
    v_mfma_f32_16x16x32_bf16 v[96:99], v[28:31], a[88:91], v[96:99]
    ds_read_b64_tr_b16 v[20:21], v8 offset:38048
    v_rcp_f32 v159, v159
    v_mfma_f32_16x16x32_bf16 v[92:95], v[28:31], a[84:87], v[92:95]
    buffer_load_dwordx4 v6, s[20:23], s68 offen offset:3168 lds
    v_mul_f32 v126, v126, v158
    v_mfma_f32_16x16x32_bf16 v[88:91], v[28:31], a[80:83], v[88:91]
    ds_read_b64_tr_b16 v[22:23], v8 offset:38304
    v_mul_f32 v127, v127, v159
    s_waitcnt lgkmcnt(4)
    v_mfma_f32_16x16x32_bf16 v[40:43], v[32:35], a[96:99], v[40:43]
    v_cvt_pk_bf16_f32 v143, v126, v127
    v_mfma_f32_16x16x32_bf16 v[44:47], v[32:35], a[100:103], v[44:47]
    ds_read_b64_tr_b16 v[24:25], v8 offset:42240
    v_mfma_f32_16x16x32_bf16 v[48:51], v[32:35], a[104:107], v[48:51]
    buffer_load_dwordx4 a[8:11], v11, s[28:31], s13 offen offset:2048 sc1
    v_mfma_f32_16x16x32_bf16 v[52:55], v[32:35], a[108:111], v[52:55]
    ds_read_b64_tr_b16 v[26:27], v8 offset:42496
    v_mfma_f32_16x16x32_bf16 v[68:71], v[36:39], a[108:111], v[68:71]
    buffer_store_dwordx4 v[140:143], v11, s[28:31], s64 offen offset:1024 sc1
    v_mfma_f32_16x16x32_bf16 v[64:67], v[36:39], a[104:107], v[64:67]
    ds_read_b64_tr_b16 v[28:29], v8 offset:42272
    v_mul_f32 v14, v112, v112
    v_mul_f32 v15, v113, v113
    v_mfma_f32_16x16x32_bf16 v[60:63], v[36:39], a[100:103], v[60:63]
    buffer_load_dwordx4 a[12:15], v11, s[28:31], s13 offen offset:3072 sc1
    s_add_u32 s13, s92, 860160
    v_mfma_f32_16x16x32_bf16 v[56:59], v[36:39], a[96:99], v[56:59]
    ds_read_b64_tr_b16 v[30:31], v8 offset:42528
    v_fma_f32 v14, v14, v238, v234
    s_waitcnt lgkmcnt(4)
    v_mfma_f32_16x16x32_bf16 v[72:75], v[16:19], a[96:99], v[72:75]
    v_fma_f32 v15, v15, v238, v234
    v_mul_f32 v14, v14, v112
    v_mul_f32 v15, v15, v113
    v_mfma_f32_16x16x32_bf16 v[76:79], v[16:19], a[100:103], v[76:79]
    ds_read_b64_tr_b16 v[32:33], v8 offset:46464
    v_exp_f32 v14, v14
    v_mfma_f32_16x16x32_bf16 v[80:83], v[16:19], a[104:107], v[80:83]
    buffer_load_dwordx4 a[16:19], v11, s[28:31], s13 offen offset:0 sc1
    v_mul_f32 v112, v112, v144
    v_mfma_f32_16x16x32_bf16 v[84:87], v[16:19], a[108:111], v[84:87]
    ds_read_b64_tr_b16 v[34:35], v8 offset:46720
    v_exp_f32 v15, v15
    v_mfma_f32_16x16x32_bf16 v[100:103], v[20:23], a[108:111], v[100:103]
    v_mul_f32 v113, v113, v145
    v_fma_f32 v144, v14, v12, v12
    v_fma_f32 v145, v15, v12, v12
    v_mfma_f32_16x16x32_bf16 v[96:99], v[20:23], a[104:107], v[96:99]
    ds_read_b64_tr_b16 v[36:37], v8 offset:46496
    v_rcp_f32 v144, v144
    v_mfma_f32_16x16x32_bf16 v[92:95], v[20:23], a[100:103], v[92:95]
    buffer_load_dwordx4 a[20:23], v11, s[28:31], s13 offen offset:1024 sc1
    v_mul_f32 v112, v112, v144
    v_mfma_f32_16x16x32_bf16 v[88:91], v[20:23], a[96:99], v[88:91]
    ds_read_b64_tr_b16 v[38:39], v8 offset:46752
    v_mul_f32 v14, v114, v114
    s_waitcnt lgkmcnt(4)
    v_mfma_f32_16x16x32_bf16 v[40:43], v[24:27], a[112:115], v[40:43]
    s_barrier
    v_mfma_f32_16x16x32_bf16 v[44:47], v[24:27], a[116:119], v[44:47]
    ds_read_b64_tr_b16 v[16:17], v7 offset:33792
    v_rcp_f32 v145, v145
    v_mfma_f32_16x16x32_bf16 v[48:51], v[24:27], a[120:123], v[48:51]
    buffer_load_dwordx4 a[24:27], v11, s[28:31], s13 offen offset:2048 sc1
    v_mul_f32 v113, v113, v145
    v_mfma_f32_16x16x32_bf16 v[52:55], v[24:27], a[124:127], v[52:55]
    ds_read_b64_tr_b16 v[18:19], v7 offset:34048
    v_cvt_pk_bf16_f32 v144, v112, v113
    v_mul_f32 v15, v115, v115
    v_mfma_f32_16x16x32_bf16 v[68:71], v[28:31], a[124:127], v[68:71]
    v_fma_f32 v14, v14, v238, v234
    v_fma_f32 v15, v15, v238, v234
    v_mul_f32 v14, v14, v114
    v_mfma_f32_16x16x32_bf16 v[64:67], v[28:31], a[120:123], v[64:67]
    ds_read_b64_tr_b16 v[20:21], v7 offset:33824
    v_mul_f32 v15, v15, v115
    v_mul_f32 v114, v114, v146
    v_mfma_f32_16x16x32_bf16 v[60:63], v[28:31], a[116:119], v[60:63]
    buffer_load_dwordx4 a[28:31], v11, s[28:31], s13 offen offset:3072 sc1
    s_add_u32 s13, s92, 1064960
    v_mfma_f32_16x16x32_bf16 v[56:59], v[28:31], a[112:115], v[56:59]
    ds_read_b64_tr_b16 v[22:23], v7 offset:34080
    v_mul_f32 v115, v115, v147
    s_waitcnt lgkmcnt(4)
    v_mfma_f32_16x16x32_bf16 v[72:75], v[32:35], a[112:115], v[72:75]
    v_exp_f32 v14, v14
    v_mfma_f32_16x16x32_bf16 v[76:79], v[32:35], a[116:119], v[76:79]
    ds_read_b64_tr_b16 v[24:25], v7 offset:38016
    v_exp_f32 v15, v15
    v_mfma_f32_16x16x32_bf16 v[80:83], v[32:35], a[120:123], v[80:83]
    buffer_load_dwordx4 a[32:35], v11, s[28:31], s13 offen offset:0 sc1
    v_fma_f32 v146, v14, v12, v12
    v_mfma_f32_16x16x32_bf16 v[84:87], v[32:35], a[124:127], v[84:87]
    ds_read_b64_tr_b16 v[26:27], v7 offset:38272
    v_fma_f32 v147, v15, v12, v12
    v_mul_f32 v14, v128, v128
    v_mfma_f32_16x16x32_bf16 v[100:103], v[36:39], a[124:127], v[100:103]
    v_rcp_f32 v146, v146
    v_mul_f32 v15, v129, v129
    v_mfma_f32_16x16x32_bf16 v[96:99], v[36:39], a[120:123], v[96:99]
    ds_read_b64_tr_b16 v[28:29], v7 offset:38048
    v_rcp_f32 v147, v147
    v_mfma_f32_16x16x32_bf16 v[92:95], v[36:39], a[116:119], v[92:95]
    buffer_load_dwordx4 a[36:39], v11, s[28:31], s13 offen offset:1024 sc1
    v_mul_f32 v114, v114, v146
    v_mfma_f32_16x16x32_bf16 v[88:91], v[36:39], a[112:115], v[88:91]
    ds_read_b64_tr_b16 v[30:31], v7 offset:38304
    v_mul_f32 v115, v115, v147
    s_waitcnt lgkmcnt(4)
    v_mfma_f32_16x16x32_bf16 v[40:43], v[16:19], a[128:131], v[40:43]
    v_cvt_pk_bf16_f32 v145, v114, v115
    v_fma_f32 v14, v14, v238, v234
    v_fma_f32 v15, v15, v238, v234
    v_mfma_f32_16x16x32_bf16 v[44:47], v[16:19], a[132:135], v[44:47]
    ds_read_b64_tr_b16 v[32:33], v7 offset:42240
    v_mul_f32 v14, v14, v128
    v_mul_f32 v15, v15, v129
    v_mfma_f32_16x16x32_bf16 v[48:51], v[16:19], a[136:139], v[48:51]
    buffer_load_dwordx4 a[40:43], v11, s[28:31], s13 offen offset:2048 sc1
    v_mul_f32 v128, v128, v160
    v_mfma_f32_16x16x32_bf16 v[52:55], v[16:19], a[140:143], v[52:55]
    ds_read_b64_tr_b16 v[34:35], v7 offset:42496
    v_exp_f32 v14, v14
    v_mfma_f32_16x16x32_bf16 v[68:71], v[20:23], a[140:143], v[68:71]
    v_exp_f32 v15, v15
    v_mul_f32 v129, v129, v161
    v_mfma_f32_16x16x32_bf16 v[64:67], v[20:23], a[136:139], v[64:67]
    ds_read_b64_tr_b16 v[36:37], v7 offset:42272
    v_fma_f32 v160, v14, v12, v12
    v_fma_f32 v161, v15, v12, v12
    v_mfma_f32_16x16x32_bf16 v[60:63], v[20:23], a[132:135], v[60:63]
    buffer_load_dwordx4 a[44:47], v11, s[28:31], s13 offen offset:3072 sc1
    s_add_u32 s13, s92, 1105920
    v_mfma_f32_16x16x32_bf16 v[56:59], v[20:23], a[128:131], v[56:59]
    ds_read_b64_tr_b16 v[38:39], v7 offset:42528
    v_mul_f32 v14, v130, v130
    s_waitcnt lgkmcnt(4)
    v_mfma_f32_16x16x32_bf16 v[72:75], v[24:27], a[128:131], v[72:75]
    v_rcp_f32 v160, v160
    v_mul_f32 v15, v131, v131
    v_mfma_f32_16x16x32_bf16 v[76:79], v[24:27], a[132:135], v[76:79]
    ds_read_b64_tr_b16 v[16:17], v7 offset:46464
    v_rcp_f32 v161, v161
    v_mfma_f32_16x16x32_bf16 v[80:83], v[24:27], a[136:139], v[80:83]
    buffer_load_dwordx4 a[48:51], v11, s[28:31], s13 offen offset:0 sc1
    v_mul_f32 v128, v128, v160
    v_mfma_f32_16x16x32_bf16 v[84:87], v[24:27], a[140:143], v[84:87]
    ds_read_b64_tr_b16 v[18:19], v7 offset:46720
    v_mul_f32 v129, v129, v161
    v_cvt_pk_bf16_f32 v146, v128, v129
    v_mfma_f32_16x16x32_bf16 v[100:103], v[28:31], a[140:143], v[100:103]
    v_fma_f32 v14, v14, v238, v234
    v_fma_f32 v15, v15, v238, v234
    v_mul_f32 v14, v14, v130
    v_mfma_f32_16x16x32_bf16 v[96:99], v[28:31], a[136:139], v[96:99]
    ds_read_b64_tr_b16 v[20:21], v7 offset:46496
    v_mul_f32 v15, v15, v131
    v_mul_f32 v130, v130, v162
    v_mfma_f32_16x16x32_bf16 v[92:95], v[28:31], a[132:135], v[92:95]
    buffer_load_dwordx4 a[52:55], v11, s[28:31], s13 offen offset:1024 sc1
    v_mul_f32 v131, v131, v163
    v_mfma_f32_16x16x32_bf16 v[88:91], v[28:31], a[128:131], v[88:91]
    ds_read_b64_tr_b16 v[22:23], v7 offset:46752
    s_waitcnt lgkmcnt(4)
    v_mfma_f32_16x16x32_bf16 v[40:43], v[32:35], a[144:147], v[40:43]
    s_barrier
    v_mfma_f32_16x16x32_bf16 v[44:47], v[32:35], a[148:151], v[44:47]
    ds_read_b64_tr_b16 v[24:25], v7 offset:50688
    v_exp_f32 v14, v14
    v_mfma_f32_16x16x32_bf16 v[48:51], v[32:35], a[152:155], v[48:51]
    buffer_load_dwordx4 a[56:59], v11, s[28:31], s13 offen offset:2048 sc1
    v_fma_f32 v162, v14, v12, v12
    v_mfma_f32_16x16x32_bf16 v[52:55], v[32:35], a[156:159], v[52:55]
    ds_read_b64_tr_b16 v[26:27], v7 offset:50944
    v_exp_f32 v15, v15
    v_mfma_f32_16x16x32_bf16 v[68:71], v[36:39], a[156:159], v[68:71]
    v_fma_f32 v163, v15, v12, v12
    v_rcp_f32 v162, v162
    v_mfma_f32_16x16x32_bf16 v[64:67], v[36:39], a[152:155], v[64:67]
    ds_read_b64_tr_b16 v[28:29], v7 offset:50720
    v_rcp_f32 v163, v163
    v_mfma_f32_16x16x32_bf16 v[60:63], v[36:39], a[148:151], v[60:63]
    buffer_load_dwordx4 a[60:63], v11, s[28:31], s13 offen offset:3072 sc1
    s_add_u32 s13, s92, 901120
    v_mfma_f32_16x16x32_bf16 v[56:59], v[36:39], a[144:147], v[56:59]
    ds_read_b64_tr_b16 v[30:31], v7 offset:50976
    v_mul_f32 v130, v130, v162
    s_waitcnt lgkmcnt(4)
    v_mfma_f32_16x16x32_bf16 v[72:75], v[16:19], a[144:147], v[72:75]
    v_mul_f32 v131, v131, v163
    v_cvt_pk_bf16_f32 v147, v130, v131
    v_mfma_f32_16x16x32_bf16 v[76:79], v[16:19], a[148:151], v[76:79]
    ds_read_b64_tr_b16 v[32:33], v7 offset:54912
    v_mfma_f32_16x16x32_bf16 v[80:83], v[16:19], a[152:155], v[80:83]
    buffer_load_dwordx4 a[64:67], v11, s[28:31], s13 offen offset:0 sc1
    v_mfma_f32_16x16x32_bf16 v[84:87], v[16:19], a[156:159], v[84:87]
    ds_read_b64_tr_b16 v[34:35], v7 offset:55168
    v_mfma_f32_16x16x32_bf16 v[100:103], v[20:23], a[156:159], v[100:103]
    buffer_store_dwordx4 v[144:147], v11, s[28:31], s64 offen offset:2048 sc1
    v_mfma_f32_16x16x32_bf16 v[96:99], v[20:23], a[152:155], v[96:99]
    ds_read_b64_tr_b16 v[36:37], v7 offset:54944
    v_mul_f32 v14, v116, v116
    v_mul_f32 v15, v117, v117
    v_mfma_f32_16x16x32_bf16 v[92:95], v[20:23], a[148:151], v[92:95]
    buffer_load_dwordx4 a[68:71], v11, s[28:31], s13 offen offset:1024 sc1
    v_fma_f32 v14, v14, v239, v235
    v_mfma_f32_16x16x32_bf16 v[88:91], v[20:23], a[144:147], v[88:91]
    ds_read_b64_tr_b16 v[38:39], v7 offset:55200
    v_fma_f32 v15, v15, v239, v235
    s_waitcnt lgkmcnt(4)
    v_mfma_f32_16x16x32_bf16 v[40:43], v[24:27], a[160:163], v[40:43]
    v_mul_f32 v14, v14, v116
    v_mul_f32 v15, v15, v117
    v_mul_f32 v116, v116, v148
    v_mfma_f32_16x16x32_bf16 v[44:47], v[24:27], a[164:167], v[44:47]
    ds_read_b64_tr_b16 v[16:17], v7 offset:59136
    v_exp_f32 v14, v14
    v_mfma_f32_16x16x32_bf16 v[48:51], v[24:27], a[168:171], v[48:51]
    buffer_load_dwordx4 a[72:75], v11, s[28:31], s13 offen offset:2048 sc1
    v_mul_f32 v117, v117, v149
    v_mfma_f32_16x16x32_bf16 v[52:55], v[24:27], a[172:175], v[52:55]
    ds_read_b64_tr_b16 v[18:19], v7 offset:59392
    v_exp_f32 v15, v15
    v_mfma_f32_16x16x32_bf16 v[68:71], v[28:31], a[172:175], v[68:71]
    v_fma_f32 v148, v14, v13, v13
    v_fma_f32 v149, v15, v13, v13
    v_mul_f32 v14, v118, v118
    v_mfma_f32_16x16x32_bf16 v[64:67], v[28:31], a[168:171], v[64:67]
    ds_read_b64_tr_b16 v[20:21], v7 offset:59168
    v_mul_f32 v15, v119, v119
    v_mfma_f32_16x16x32_bf16 v[60:63], v[28:31], a[164:167], v[60:63]
    buffer_load_dwordx4 a[76:79], v11, s[28:31], s13 offen offset:3072 sc1
    v_mfma_f32_16x16x32_bf16 v[56:59], v[28:31], a[160:163], v[56:59]
    ds_read_b64_tr_b16 v[22:23], v7 offset:59424
    s_waitcnt lgkmcnt(4)
    v_mfma_f32_16x16x32_bf16 v[72:75], v[32:35], a[160:163], v[72:75]
    s_add_u32 s13, s92, 942080
    v_rcp_f32 v148, v148
    v_mfma_f32_16x16x32_bf16 v[76:79], v[32:35], a[164:167], v[76:79]
    ds_read_b64_tr_b16 v[24:25], v7 offset:63360
    v_rcp_f32 v149, v149
    v_mfma_f32_16x16x32_bf16 v[80:83], v[32:35], a[168:171], v[80:83]
    buffer_load_dwordx4 a[80:83], v11, s[28:31], s13 offen offset:0 sc1
    v_mfma_f32_16x16x32_bf16 v[84:87], v[32:35], a[172:175], v[84:87]
    ds_read_b64_tr_b16 v[26:27], v7 offset:63616
    v_mul_f32 v116, v116, v148
    v_mul_f32 v117, v117, v149
    v_mfma_f32_16x16x32_bf16 v[100:103], v[36:39], a[172:175], v[100:103]
    v_cvt_pk_bf16_f32 v148, v116, v117
    v_fma_f32 v14, v14, v239, v235
    v_mfma_f32_16x16x32_bf16 v[96:99], v[36:39], a[168:171], v[96:99]
    ds_read_b64_tr_b16 v[28:29], v7 offset:63392
    v_fma_f32 v15, v15, v239, v235
    v_mfma_f32_16x16x32_bf16 v[92:95], v[36:39], a[164:167], v[92:95]
    buffer_load_dwordx4 a[84:87], v11, s[28:31], s13 offen offset:1024 sc1
    v_mfma_f32_16x16x32_bf16 v[88:91], v[36:39], a[160:163], v[88:91]
    ds_read_b64_tr_b16 v[30:31], v7 offset:63648
    s_waitcnt lgkmcnt(4)
    v_mfma_f32_16x16x32_bf16 v[40:43], v[16:19], a[176:179], v[40:43]
    s_barrier
    v_mfma_f32_16x16x32_bf16 v[44:47], v[16:19], a[180:183], v[44:47]
    ds_read_b64_tr_b16 v[32:33], v8 offset:0
    v_mul_f32 v14, v14, v118
    v_mul_f32 v15, v15, v119
    v_mfma_f32_16x16x32_bf16 v[48:51], v[16:19], a[184:187], v[48:51]
    buffer_load_dwordx4 a[88:91], v11, s[28:31], s13 offen offset:2048 sc1
    v_mul_f32 v118, v118, v150
    v_mfma_f32_16x16x32_bf16 v[52:55], v[16:19], a[188:191], v[52:55]
    ds_read_b64_tr_b16 v[34:35], v8 offset:256
    v_exp_f32 v14, v14
    v_mfma_f32_16x16x32_bf16 v[68:71], v[20:23], a[188:191], v[68:71]
    v_exp_f32 v15, v15
    v_mul_f32 v119, v119, v151
    v_mfma_f32_16x16x32_bf16 v[64:67], v[20:23], a[184:187], v[64:67]
    ds_read_b64_tr_b16 v[36:37], v8 offset:32
    v_fma_f32 v150, v14, v13, v13
    v_mfma_f32_16x16x32_bf16 v[60:63], v[20:23], a[180:183], v[60:63]
    buffer_load_dwordx4 a[92:95], v11, s[28:31], s13 offen offset:3072 sc1
    v_mfma_f32_16x16x32_bf16 v[56:59], v[20:23], a[176:179], v[56:59]
    ds_read_b64_tr_b16 v[38:39], v8 offset:288
    s_waitcnt lgkmcnt(4)
    v_mfma_f32_16x16x32_bf16 v[72:75], v[24:27], a[176:179], v[72:75]
    s_add_u32 s13, s92, 1146880
    v_fma_f32 v151, v15, v13, v13
    v_mul_f32 v14, v132, v132
    v_mfma_f32_16x16x32_bf16 v[76:79], v[24:27], a[180:183], v[76:79]
    ds_read_b64_tr_b16 v[16:17], v8 offset:4224
    v_mul_f32 v15, v133, v133
    v_mfma_f32_16x16x32_bf16 v[80:83], v[24:27], a[184:187], v[80:83]
    buffer_load_dwordx4 a[96:99], v11, s[28:31], s13 offen offset:0 sc1
    v_mfma_f32_16x16x32_bf16 v[84:87], v[24:27], a[188:191], v[84:87]
    ds_read_b64_tr_b16 v[18:19], v8 offset:4480
    v_rcp_f32 v150, v150
    v_mfma_f32_16x16x32_bf16 v[100:103], v[28:31], a[188:191], v[100:103]
    v_rcp_f32 v151, v151
    v_mul_f32 v118, v118, v150
    v_mfma_f32_16x16x32_bf16 v[96:99], v[28:31], a[184:187], v[96:99]
    ds_read_b64_tr_b16 v[20:21], v8 offset:4256
    v_mul_f32 v119, v119, v151
    v_mfma_f32_16x16x32_bf16 v[92:95], v[28:31], a[180:183], v[92:95]
    buffer_load_dwordx4 a[100:103], v11, s[28:31], s13 offen offset:1024 sc1
    v_mfma_f32_16x16x32_bf16 v[88:91], v[28:31], a[176:179], v[88:91]
    ds_read_b64_tr_b16 v[22:23], v8 offset:4512
    s_waitcnt lgkmcnt(4)
    v_mfma_f32_16x16x32_bf16 v[40:43], v[32:35], a[192:195], v[40:43]
    v_cvt_pk_bf16_f32 v149, v118, v119
    v_fma_f32 v14, v14, v239, v235
    v_fma_f32 v15, v15, v239, v235
    v_mfma_f32_16x16x32_bf16 v[44:47], v[32:35], a[196:199], v[44:47]
    ds_read_b64_tr_b16 v[24:25], v8 offset:8448
    s_add_u32 s15, s72, 16384
    v_mfma_f32_16x16x32_bf16 v[48:51], v[32:35], a[200:203], v[48:51]
    buffer_load_dwordx4 v[240:243], v11, s[28:31], s15 offen offset:0 sc1
    v_mfma_f32_16x16x32_bf16 v[52:55], v[32:35], a[204:207], v[52:55]
    ds_read_b64_tr_b16 v[26:27], v8 offset:8704
    v_mul_f32 v14, v14, v132
    v_mul_f32 v15, v15, v133
    v_mfma_f32_16x16x32_bf16 v[68:71], v[36:39], a[204:207], v[68:71]
    v_exp_f32 v14, v14
    v_mul_f32 v132, v132, v164
    v_mfma_f32_16x16x32_bf16 v[64:67], v[36:39], a[200:203], v[64:67]
    ds_read_b64_tr_b16 v[28:29], v8 offset:8480
    v_mul_f32 v133, v133, v165
    v_mfma_f32_16x16x32_bf16 v[60:63], v[36:39], a[196:199], v[60:63]
    buffer_load_dwordx4 v[244:247], v11, s[28:31], s15 offen offset:1024 sc1
    v_mfma_f32_16x16x32_bf16 v[56:59], v[36:39], a[192:195], v[56:59]
    ds_read_b64_tr_b16 v[30:31], v8 offset:8736
    s_waitcnt lgkmcnt(4)
    v_mfma_f32_16x16x32_bf16 v[72:75], v[16:19], a[192:195], v[72:75]
    v_exp_f32 v15, v15
    v_fma_f32 v164, v14, v13, v13
    v_mfma_f32_16x16x32_bf16 v[76:79], v[16:19], a[196:199], v[76:79]
    ds_read_b64_tr_b16 v[32:33], v8 offset:12672
    v_fma_f32 v165, v15, v13, v13
    v_mfma_f32_16x16x32_bf16 v[80:83], v[16:19], a[200:203], v[80:83]
    buffer_load_dwordx4 v[248:251], v11, s[28:31], s15 offen offset:2048 sc1
    v_mfma_f32_16x16x32_bf16 v[84:87], v[16:19], a[204:207], v[84:87]
    ds_read_b64_tr_b16 v[34:35], v8 offset:12928
    v_mul_f32 v14, v134, v134
    v_mfma_f32_16x16x32_bf16 v[100:103], v[20:23], a[204:207], v[100:103]
    v_rcp_f32 v164, v164
    v_mfma_f32_16x16x32_bf16 v[96:99], v[20:23], a[200:203], v[96:99]
    ds_read_b64_tr_b16 v[36:37], v8 offset:12704
    v_mul_f32 v132, v132, v164
    v_mfma_f32_16x16x32_bf16 v[92:95], v[20:23], a[196:199], v[92:95]
    buffer_load_dwordx4 v[252:255], v11, s[28:31], s15 offen offset:3072 sc1
    v_mfma_f32_16x16x32_bf16 v[88:91], v[20:23], a[192:195], v[88:91]
    ds_read_b64_tr_b16 v[38:39], v8 offset:12960
    v_mul_f32 v15, v135, v135
    s_waitcnt lgkmcnt(4)
    v_mfma_f32_16x16x32_bf16 v[40:43], v[24:27], a[208:211], v[40:43]
    s_waitcnt vmcnt(43)
    s_barrier
    v_mfma_f32_16x16x32_bf16 v[44:47], v[24:27], a[212:215], v[44:47]
    ds_read_b64_tr_b16 v[16:17], v8 offset:16896
    v_rcp_f32 v165, v165
    v_mfma_f32_16x16x32_bf16 v[48:51], v[24:27], a[216:219], v[48:51]
    buffer_load_dwordx4 a[104:107], v11, s[28:31], s13 offen offset:2048 sc1
    v_mul_f32 v133, v133, v165
    v_mfma_f32_16x16x32_bf16 v[52:55], v[24:27], a[220:223], v[52:55]
    ds_read_b64_tr_b16 v[18:19], v8 offset:17152
    v_cvt_pk_bf16_f32 v150, v132, v133
    v_fma_f32 v14, v14, v239, v235
    v_mfma_f32_16x16x32_bf16 v[68:71], v[28:31], a[220:223], v[68:71]
    v_fma_f32 v15, v15, v239, v235
    v_mul_f32 v14, v14, v134
    v_mul_f32 v15, v15, v135
    v_mfma_f32_16x16x32_bf16 v[64:67], v[28:31], a[216:219], v[64:67]
    ds_read_b64_tr_b16 v[20:21], v8 offset:16928
    v_exp_f32 v14, v14
    v_mfma_f32_16x16x32_bf16 v[60:63], v[28:31], a[212:215], v[60:63]
    buffer_load_dwordx4 a[108:111], v11, s[28:31], s13 offen offset:3072 sc1
    s_add_u32 s13, s92, 1187840
    v_mfma_f32_16x16x32_bf16 v[56:59], v[28:31], a[208:211], v[56:59]
    ds_read_b64_tr_b16 v[22:23], v8 offset:17184
    v_mul_f32 v134, v134, v166
    s_waitcnt lgkmcnt(4)
    v_mfma_f32_16x16x32_bf16 v[72:75], v[32:35], a[208:211], v[72:75]
    v_exp_f32 v15, v15
    v_mul_f32 v135, v135, v167
    v_mfma_f32_16x16x32_bf16 v[76:79], v[32:35], a[212:215], v[76:79]
    ds_read_b64_tr_b16 v[24:25], v8 offset:21120
    v_fma_f32 v166, v14, v13, v13
    v_fma_f32 v167, v15, v13, v13
    v_mfma_f32_16x16x32_bf16 v[80:83], v[32:35], a[216:219], v[80:83]
    buffer_load_dwordx4 a[112:115], v11, s[28:31], s13 offen offset:0 sc1
    v_mfma_f32_16x16x32_bf16 v[84:87], v[32:35], a[220:223], v[84:87]
    ds_read_b64_tr_b16 v[26:27], v8 offset:21376
    v_rcp_f32 v166, v166
    v_mfma_f32_16x16x32_bf16 v[100:103], v[36:39], a[220:223], v[100:103]
    v_rcp_f32 v167, v167
    v_mul_f32 v134, v134, v166
    v_mfma_f32_16x16x32_bf16 v[96:99], v[36:39], a[216:219], v[96:99]
    ds_read_b64_tr_b16 v[28:29], v8 offset:21152
    v_mul_f32 v135, v135, v167
    v_cvt_pk_bf16_f32 v151, v134, v135
    v_mfma_f32_16x16x32_bf16 v[92:95], v[36:39], a[212:215], v[92:95]
    buffer_load_dwordx4 a[116:119], v11, s[28:31], s13 offen offset:1024 sc1
    v_mfma_f32_16x16x32_bf16 v[88:91], v[36:39], a[208:211], v[88:91]
    ds_read_b64_tr_b16 v[30:31], v8 offset:21408
    s_waitcnt lgkmcnt(4)
    v_mfma_f32_16x16x32_bf16 v[40:43], v[16:19], a[224:227], v[40:43]
    buffer_store_dwordx4 v[148:151], v11, s[28:31], s64 offen offset:3072 sc1
    v_mfma_f32_16x16x32_bf16 v[44:47], v[16:19], a[228:231], v[44:47]
    ds_read_b64_tr_b16 v[32:33], v8 offset:25344
    s_add_u32 s14, s32, 0
    s_and_b32 s14, s14, 3
    v_mfma_f32_16x16x32_bf16 v[48:51], v[16:19], a[232:235], v[48:51]
    buffer_load_dwordx4 a[120:123], v11, s[28:31], s13 offen offset:2048 sc1
    s_lshl_b32 s14, s14, 10
    v_add_u32 v3, s14, v11
    v_mfma_f32_16x16x32_bf16 v[52:55], v[16:19], a[236:239], v[52:55]
    ds_read_b64_tr_b16 v[34:35], v8 offset:25600
    s_add_u32 s14, s32, 1
    s_and_b32 s14, s14, 3
    v_mfma_f32_16x16x32_bf16 v[68:71], v[20:23], a[236:239], v[68:71]
    s_lshl_b32 s14, s14, 10
    v_add_u32 v4, s14, v11
    s_add_u32 s14, s32, 2
    s_and_b32 s14, s14, 3
    v_mfma_f32_16x16x32_bf16 v[64:67], v[20:23], a[232:235], v[64:67]
    ds_read_b64_tr_b16 v[36:37], v8 offset:25376
    s_lshl_b32 s14, s14, 10
    v_add_u32 v5, s14, v11
    v_mfma_f32_16x16x32_bf16 v[60:63], v[20:23], a[228:231], v[60:63]
    buffer_load_dwordx4 a[124:127], v11, s[28:31], s13 offen offset:3072 sc1
    s_add_u32 s13, s93, 0
    v_mfma_f32_16x16x32_bf16 v[56:59], v[20:23], a[224:227], v[56:59]
    ds_read_b64_tr_b16 v[38:39], v8 offset:25632
    s_add_u32 s14, s32, 3
    s_and_b32 s14, s14, 3
    s_waitcnt lgkmcnt(4)
    v_mfma_f32_16x16x32_bf16 v[72:75], v[24:27], a[224:227], v[72:75]
    s_lshl_b32 s14, s14, 10
    v_add_u32 v6, s14, v11
    v_mfma_f32_16x16x32_bf16 v[76:79], v[24:27], a[228:231], v[76:79]
    ds_read_b64_tr_b16 v[16:17], v8 offset:29568
    v_mfma_f32_16x16x32_bf16 v[80:83], v[24:27], a[232:235], v[80:83]
    buffer_load_dwordx4 a[128:131], v11, s[28:31], s13 offen offset:0 sc1
    v_mfma_f32_16x16x32_bf16 v[84:87], v[24:27], a[236:239], v[84:87]
    ds_read_b64_tr_b16 v[18:19], v8 offset:29824
    v_mfma_f32_16x16x32_bf16 v[100:103], v[28:31], a[236:239], v[100:103]
    v_mfma_f32_16x16x32_bf16 v[96:99], v[28:31], a[232:235], v[96:99]
    ds_read_b64_tr_b16 v[20:21], v8 offset:29600
    v_mfma_f32_16x16x32_bf16 v[92:95], v[28:31], a[228:231], v[92:95]
    buffer_load_dwordx4 a[132:135], v11, s[28:31], s13 offen offset:1024 sc1
    v_mfma_f32_16x16x32_bf16 v[88:91], v[28:31], a[224:227], v[88:91]
    ds_read_b64_tr_b16 v[22:23], v8 offset:29856
    s_waitcnt lgkmcnt(4)
    v_mfma_f32_16x16x32_bf16 v[40:43], v[32:35], a[240:243], v[40:43]
    s_waitcnt vmcnt(46)
    s_barrier
    v_mfma_f32_16x16x32_bf16 v[44:47], v[32:35], a[244:247], v[44:47]
    ds_read_b64_tr_b16 v[24:25], v8 offset:50688
    s_buffer_load_dwordx4 s[56:59], s[28:31], s35 offset:0 glc
    v_mfma_f32_16x16x32_bf16 v[48:51], v[32:35], a[248:251], v[48:51]
    v_mfma_f32_16x16x32_bf16 v[52:55], v[32:35], a[252:255], v[52:55]
    ds_read_b64_tr_b16 v[26:27], v8 offset:50944
    v_mfma_f32_16x16x32_bf16 v[68:71], v[36:39], a[252:255], v[68:71]
    buffer_load_dwordx4 a[136:139], v11, s[28:31], s13 offen offset:2048 sc1
    v_mfma_f32_16x16x32_bf16 v[64:67], v[36:39], a[248:251], v[64:67]
    ds_read_b64_tr_b16 v[28:29], v8 offset:50720
    v_mfma_f32_16x16x32_bf16 v[60:63], v[36:39], a[244:247], v[60:63]
    v_mfma_f32_16x16x32_bf16 v[56:59], v[36:39], a[240:243], v[56:59]
    ds_read_b64_tr_b16 v[30:31], v8 offset:50976
    s_waitcnt lgkmcnt(4)
    v_mfma_f32_16x16x32_bf16 v[72:75], v[16:19], a[240:243], v[72:75]
    buffer_load_dwordx4 a[140:143], v11, s[28:31], s13 offen offset:3072 sc1
    v_mfma_f32_16x16x32_bf16 v[76:79], v[16:19], a[244:247], v[76:79]
    ds_read_b64_tr_b16 v[32:33], v8 offset:54912
    s_add_u32 s13, s93, 40960
    v_mfma_f32_16x16x32_bf16 v[80:83], v[16:19], a[248:251], v[80:83]
    v_mfma_f32_16x16x32_bf16 v[84:87], v[16:19], a[252:255], v[84:87]
    ds_read_b64_tr_b16 v[34:35], v8 offset:55168
    v_mfma_f32_16x16x32_bf16 v[100:103], v[20:23], a[252:255], v[100:103]
    buffer_load_dwordx4 a[144:147], v11, s[28:31], s13 offen offset:0 sc1
    v_mfma_f32_16x16x32_bf16 v[96:99], v[20:23], a[248:251], v[96:99]
    ds_read_b64_tr_b16 v[36:37], v8 offset:54944
    v_mfma_f32_16x16x32_bf16 v[92:95], v[20:23], a[244:247], v[92:95]
    v_mfma_f32_16x16x32_bf16 v[88:91], v[20:23], a[240:243], v[88:91]
    ds_read_b64_tr_b16 v[38:39], v8 offset:55200
    s_waitcnt lgkmcnt(4)
    v_mfma_f32_16x16x32_bf16 v[40:43], v[24:27], v[168:171], v[40:43]
    buffer_load_dwordx4 a[148:151], v11, s[28:31], s13 offen offset:1024 sc1
    v_mfma_f32_16x16x32_bf16 v[44:47], v[24:27], v[172:175], v[44:47]
    ds_read_b64_tr_b16 v[16:17], v8 offset:59136
    v_mfma_f32_16x16x32_bf16 v[48:51], v[24:27], v[176:179], v[48:51]
    v_mfma_f32_16x16x32_bf16 v[52:55], v[24:27], v[180:183], v[52:55]
    ds_read_b64_tr_b16 v[18:19], v8 offset:59392
    v_mfma_f32_16x16x32_bf16 v[68:71], v[28:31], v[180:183], v[68:71]
    buffer_load_dwordx4 a[152:155], v11, s[28:31], s13 offen offset:2048 sc1
    v_mfma_f32_16x16x32_bf16 v[64:67], v[28:31], v[176:179], v[64:67]
    ds_read_b64_tr_b16 v[20:21], v8 offset:59168
    v_mfma_f32_16x16x32_bf16 v[60:63], v[28:31], v[172:175], v[60:63]
    v_mfma_f32_16x16x32_bf16 v[56:59], v[28:31], v[168:171], v[56:59]
    ds_read_b64_tr_b16 v[22:23], v8 offset:59424
    s_waitcnt lgkmcnt(4)
    v_mfma_f32_16x16x32_bf16 v[72:75], v[32:35], v[168:171], v[72:75]
    buffer_load_dwordx4 a[156:159], v11, s[28:31], s13 offen offset:3072 sc1
    v_mfma_f32_16x16x32_bf16 v[76:79], v[32:35], v[172:175], v[76:79]
    ds_read_b64_tr_b16 v[24:25], v8 offset:63360
    s_waitcnt vmcnt(10)
    v_mfma_f32_16x16x32_bf16 v[80:83], v[32:35], v[176:179], v[80:83]
    v_mfma_f32_16x16x32_bf16 v[84:87], v[32:35], v[180:183], v[84:87]
    ds_read_b64_tr_b16 v[26:27], v8 offset:63616
    v_mfma_f32_16x16x32_bf16 v[100:103], v[36:39], v[180:183], v[100:103]
    s_mov_b64 exec, 4
    buffer_store_dword v2, off, s[28:31], s34 sc1
    s_mov_b64 exec, -1
    v_mfma_f32_16x16x32_bf16 v[96:99], v[36:39], v[176:179], v[96:99]
    ds_read_b64_tr_b16 v[28:29], v8 offset:63392
    s_add_u32 s13, s93, 81920
    v_mfma_f32_16x16x32_bf16 v[92:95], v[36:39], v[172:175], v[92:95]
    v_mfma_f32_16x16x32_bf16 v[88:91], v[36:39], v[168:171], v[88:91]
    ds_read_b64_tr_b16 v[30:31], v8 offset:63648
    s_waitcnt lgkmcnt(4)
    v_mfma_f32_16x16x32_bf16 v[40:43], v[16:19], v[184:187], v[40:43]
    s_barrier
    v_mfma_f32_16x16x32_bf16 v[44:47], v[16:19], v[188:191], v[44:47]
    ds_read_b64_tr_b16 v[32:33], v7 offset:0
    v_mfma_f32_16x16x32_bf16 v[48:51], v[16:19], v[192:195], v[48:51]
    v_xor_b32 v247, s1, v242
    v_bitop3_b32 v247, v246, s1, v247 bitop3:0xbe
    v_mfma_f32_16x16x32_bf16 v[52:55], v[16:19], v[196:199], v[52:55]
    ds_read_b64_tr_b16 v[34:35], v7 offset:256
    v_bitop3_b32 v247, v250, s1, v247 bitop3:0xbe
    v_mfma_f32_16x16x32_bf16 v[68:71], v[20:23], v[196:199], v[68:71]
    v_bitop3_b32 v247, v254, s1, v247 bitop3:0xbe
    v_mfma_f32_16x16x32_bf16 v[64:67], v[20:23], v[192:195], v[64:67]
    ds_read_b64_tr_b16 v[36:37], v7 offset:32
    v_mfma_f32_16x16x32_bf16 v[60:63], v[20:23], v[188:191], v[60:63]
    v_cmp_ne_u32 vcc, 0, v247
    s_cmp_lg_u64 vcc, 0
    s_cbranch_scc1 AE2_spin
AE2_ok:
    v_mfma_f32_16x16x32_bf16 v[56:59], v[20:23], v[184:187], v[56:59]
    ds_read_b64_tr_b16 v[38:39], v7 offset:288
    s_waitcnt lgkmcnt(4)
    v_mfma_f32_16x16x32_bf16 v[72:75], v[24:27], v[184:187], v[72:75]
    v_swap_b32 v241, v244
    v_swap_b32 v249, v252
    v_mfma_f32_16x16x32_bf16 v[76:79], v[24:27], v[188:191], v[76:79]
    ds_read_b64_tr_b16 v[16:17], v7 offset:4224
    v_mfma_f32_16x16x32_bf16 v[80:83], v[24:27], v[192:195], v[80:83]
    buffer_load_dwordx4 a[160:163], v11, s[28:31], s13 offen offset:0 sc1
    v_mfma_f32_16x16x32_bf16 v[84:87], v[24:27], v[196:199], v[84:87]
    ds_read_b64_tr_b16 v[18:19], v7 offset:4480
    v_mfma_f32_16x16x32_bf16 v[100:103], v[28:31], v[196:199], v[100:103]
    v_mfma_f32_16x16x32_bf16 v[96:99], v[28:31], v[192:195], v[96:99]
    ds_read_b64_tr_b16 v[20:21], v7 offset:4256
    v_mfma_f32_16x16x32_bf16 v[92:95], v[28:31], v[188:191], v[92:95]
    buffer_load_dwordx4 a[164:167], v11, s[28:31], s13 offen offset:1024 sc1
    v_mfma_f32_16x16x32_bf16 v[88:91], v[28:31], v[184:187], v[88:91]
    ds_read_b64_tr_b16 v[22:23], v7 offset:4512
    s_waitcnt lgkmcnt(4)
    v_mfma_f32_16x16x32_bf16 v[40:43], v[32:35], v[200:203], v[40:43]
    v_mfma_f32_16x16x32_bf16 v[44:47], v[32:35], v[204:207], v[44:47]
    ds_read_b64_tr_b16 v[24:25], v7 offset:8448
    v_mfma_f32_16x16x32_bf16 v[48:51], v[32:35], v[208:211], v[48:51]
    buffer_load_dwordx4 a[168:171], v11, s[28:31], s13 offen offset:2048 sc1
    v_mfma_f32_16x16x32_bf16 v[52:55], v[32:35], v[212:215], v[52:55]
    ds_read_b64_tr_b16 v[26:27], v7 offset:8704
    v_mfma_f32_16x16x32_bf16 v[68:71], v[36:39], v[212:215], v[68:71]
    v_perm_b32 v242, v0, v0, s4
    v_perm_b32 v243, v0, v0, s4
    v_mfma_f32_16x16x32_bf16 v[64:67], v[36:39], v[208:211], v[64:67]
    ds_read_b64_tr_b16 v[28:29], v7 offset:8480
    v_mfma_f32_16x16x32_bf16 v[60:63], v[36:39], v[204:207], v[60:63]
    buffer_load_dwordx4 a[172:175], v11, s[28:31], s13 offen offset:3072 sc1
    v_mfma_f32_16x16x32_bf16 v[56:59], v[36:39], v[200:203], v[56:59]
    ds_read_b64_tr_b16 v[30:31], v7 offset:8736
    s_waitcnt lgkmcnt(0)
    v_mfma_f32_16x16x16_bf16 v[40:43], v[240:241], v[242:243], v[40:43]
    s_add_u32 s100, s1, 1
    s_sub_u32 s56, s56, s100
    v_mfma_f32_16x16x16_bf16 v[56:59], v[244:245], v[242:243], v[56:59]
    s_sub_u32 s57, s57, s100
    s_sub_u32 s58, s58, s100
    v_mfma_f32_16x16x16_bf16 v[72:75], v[248:249], v[242:243], v[72:75]
    s_sub_u32 s59, s59, s100
    s_max_u32 s56, s56, s57
    v_mfma_f32_16x16x16_bf16 v[88:91], v[252:253], v[242:243], v[88:91]
    s_max_u32 s58, s58, s59
    s_waitcnt lgkmcnt(4)
    v_mfma_f32_16x16x32_bf16 v[72:75], v[16:19], v[200:203], v[72:75]
    s_max_u32 s56, s56, s58
    v_mfma_f32_16x16x32_bf16 v[76:79], v[16:19], v[204:207], v[76:79]
    ds_read_b64_tr_b16 v[32:33], v7 offset:12672
    v_mfma_f32_16x16x32_bf16 v[80:83], v[16:19], v[208:211], v[80:83]
    s_cmp_gt_u32 s56, 2
    s_cbranch_scc1 FFN_fe_spin
FFN_fe_ok:
    v_mfma_f32_16x16x32_bf16 v[84:87], v[16:19], v[212:215], v[84:87]
    ds_read_b64_tr_b16 v[34:35], v7 offset:12928
    s_add_u32 s13, s77, 81920
    v_mfma_f32_16x16x32_bf16 v[100:103], v[20:23], v[212:215], v[100:103]
    v_perm_b32 v246, v0, v0, s5
    v_perm_b32 v247, v0, v0, s5
    v_mfma_f32_16x16x32_bf16 v[96:99], v[20:23], v[208:211], v[96:99]
    ds_read_b64_tr_b16 v[36:37], v7 offset:12704
    v_mfma_f32_16x16x32_bf16 v[92:95], v[20:23], v[204:207], v[92:95]
    buffer_load_dwordx4 v[184:187], v3, s[28:31], s13 offen sc1
    v_mfma_f32_16x16x32_bf16 v[88:91], v[20:23], v[200:203], v[88:91]
    ds_read_b64_tr_b16 v[38:39], v7 offset:12960
    v_mfma_f32_16x16x16_bf16 v[44:47], v[240:241], v[246:247], v[44:47]
    v_mfma_f32_16x16x16_bf16 v[60:63], v[244:245], v[246:247], v[60:63]
    buffer_load_dwordx4 v[188:191], v4, s[28:31], s13 offen sc1
    v_mfma_f32_16x16x16_bf16 v[76:79], v[248:249], v[246:247], v[76:79]
    v_mfma_f32_16x16x16_bf16 v[92:95], v[252:253], v[246:247], v[92:95]
    s_waitcnt lgkmcnt(4)
    v_mfma_f32_16x16x32_bf16 v[40:43], v[24:27], v[216:219], v[40:43]
    buffer_load_dwordx4 v[192:195], v5, s[28:31], s13 offen sc1
    v_mfma_f32_16x16x32_bf16 v[44:47], v[24:27], v[220:223], v[44:47]
    v_mfma_f32_16x16x32_bf16 v[48:51], v[24:27], v[224:227], v[48:51]
    v_mfma_f32_16x16x32_bf16 v[52:55], v[24:27], v[228:231], v[52:55]
    buffer_load_dwordx4 v[196:199], v6, s[28:31], s13 offen sc1
    v_mfma_f32_16x16x32_bf16 v[68:71], v[28:31], v[228:231], v[68:71]
    v_perm_b32 v242, v9, v9, s4
    v_perm_b32 v243, v9, v9, s4
    v_mfma_f32_16x16x32_bf16 v[64:67], v[28:31], v[224:227], v[64:67]
    s_add_u32 s13, s93, 122880
    v_mfma_f32_16x16x32_bf16 v[60:63], v[28:31], v[220:223], v[60:63]
    buffer_load_dwordx4 a[176:179], v11, s[28:31], s13 offen offset:0 sc1
    v_mfma_f32_16x16x32_bf16 v[56:59], v[28:31], v[216:219], v[56:59]
    v_mfma_f32_16x16x16_bf16 v[48:51], v[240:241], v[242:243], v[48:51]
    v_mfma_f32_16x16x16_bf16 v[64:67], v[244:245], v[242:243], v[64:67]
    buffer_load_dwordx4 a[180:183], v11, s[28:31], s13 offen offset:1024 sc1
    v_mfma_f32_16x16x16_bf16 v[80:83], v[248:249], v[242:243], v[80:83]
    v_mfma_f32_16x16x16_bf16 v[96:99], v[252:253], v[242:243], v[96:99]
    s_waitcnt lgkmcnt(0)
    v_mfma_f32_16x16x32_bf16 v[72:75], v[32:35], v[216:219], v[72:75]
    buffer_load_dwordx4 a[184:187], v11, s[28:31], s13 offen offset:2048 sc1
    v_mfma_f32_16x16x32_bf16 v[76:79], v[32:35], v[220:223], v[76:79]
    v_mfma_f32_16x16x32_bf16 v[80:83], v[32:35], v[224:227], v[80:83]
    v_mfma_f32_16x16x32_bf16 v[84:87], v[32:35], v[228:231], v[84:87]
    buffer_load_dwordx4 a[188:191], v11, s[28:31], s13 offen offset:3072 sc1
    v_mfma_f32_16x16x32_bf16 v[100:103], v[36:39], v[228:231], v[100:103]
    v_perm_b32 v246, v9, v9, s5
    v_perm_b32 v247, v9, v9, s5
    v_mfma_f32_16x16x32_bf16 v[96:99], v[36:39], v[224:227], v[96:99]
    s_add_u32 s13, s93, 163840
    v_mfma_f32_16x16x32_bf16 v[92:95], v[36:39], v[220:223], v[92:95]
    buffer_load_dwordx4 a[192:195], v11, s[28:31], s13 offen offset:0 sc1
    v_mfma_f32_16x16x32_bf16 v[88:91], v[36:39], v[216:219], v[88:91]
    v_mfma_f32_16x16x16_bf16 v[52:55], v[240:241], v[246:247], v[52:55]
    v_mfma_f32_16x16x16_bf16 v[68:71], v[244:245], v[246:247], v[68:71]
    buffer_load_dwordx4 a[196:199], v11, s[28:31], s13 offen offset:1024 sc1
    v_mfma_f32_16x16x16_bf16 v[84:87], v[248:249], v[246:247], v[84:87]
    v_mfma_f32_16x16x16_bf16 v[100:103], v[252:253], v[246:247], v[100:103]
    v_mov_b32 v7, v11
    s_nop 7
    v_pk_mul_f32 v[16:17], v[40:41], v[40:41]
    buffer_load_dwordx4 a[200:203], v11, s[28:31], s13 offen offset:2048 sc1
    v_pk_mul_f32 v[18:19], v[42:43], v[42:43]
    v_pk_mul_f32 v[20:21], v[56:57], v[56:57]
    v_pk_mul_f32 v[22:23], v[58:59], v[58:59]
    v_pk_fma_f32 v[16:17], v[16:17], v[236:237], v[232:233] op_sel:[0,0,0] op_sel_hi:[1,0,0]
    v_pk_fma_f32 v[18:19], v[18:19], v[236:237], v[232:233] op_sel:[0,0,0] op_sel_hi:[1,0,0]
    v_pk_fma_f32 v[20:21], v[20:21], v[236:237], v[232:233] op_sel:[0,0,0] op_sel_hi:[1,0,0]
    v_pk_fma_f32 v[22:23], v[22:23], v[236:237], v[232:233] op_sel:[0,0,0] op_sel_hi:[1,0,0]
    v_pk_mul_f32 v[16:17], v[16:17], v[40:41]
    v_pk_mul_f32 v[18:19], v[18:19], v[42:43]
    buffer_load_dwordx4 a[204:207], v11, s[28:31], s13 offen offset:3072 sc1
    v_pk_mul_f32 v[20:21], v[20:21], v[56:57]
    v_pk_mul_f32 v[22:23], v[22:23], v[58:59]
    v_exp_f32 v16, v16
    v_exp_f32 v17, v17
    v_exp_f32 v18, v18
    v_exp_f32 v19, v19
    v_exp_f32 v20, v20
    v_exp_f32 v21, v21
    v_exp_f32 v22, v22
    s_add_u32 s13, s77, 86016
    buffer_load_dwordx4 v[200:203], v3, s[28:31], s13 offen sc1
    v_exp_f32 v23, v23
    v_pk_mul_f32 v[40:41], v[40:41], v[72:73]
    v_pk_mul_f32 v[42:43], v[42:43], v[74:75]
    v_pk_mul_f32 v[56:57], v[56:57], v[88:89]
    v_pk_mul_f32 v[58:59], v[58:59], v[90:91]
    v_pk_fma_f32 v[16:17], v[16:17], v[0:1], v[0:1] op_sel:[0,1,1] op_sel_hi:[1,1,1]
    v_pk_fma_f32 v[18:19], v[18:19], v[0:1], v[0:1] op_sel:[0,1,1] op_sel_hi:[1,1,1]
    v_pk_fma_f32 v[20:21], v[20:21], v[0:1], v[0:1] op_sel:[0,1,1] op_sel_hi:[1,1,1]
    v_pk_fma_f32 v[22:23], v[22:23], v[0:1], v[0:1] op_sel:[0,1,1] op_sel_hi:[1,1,1]
    buffer_load_dwordx4 v[204:207], v4, s[28:31], s13 offen sc1
    v_rcp_f32 v16, v16
    v_rcp_f32 v17, v17
    v_rcp_f32 v18, v18
    v_rcp_f32 v19, v19
    v_rcp_f32 v20, v20
    v_rcp_f32 v21, v21
    v_rcp_f32 v22, v22
    v_rcp_f32 v23, v23
    v_pk_mul_f32 v[40:41], v[40:41], v[16:17]
    buffer_load_dwordx4 v[208:211], v5, s[28:31], s13 offen sc1
    v_pk_mul_f32 v[42:43], v[42:43], v[18:19]
    v_pk_mul_f32 v[56:57], v[56:57], v[20:21]
    v_pk_mul_f32 v[58:59], v[58:59], v[22:23]
    v_cvt_pk_bf16_f32 v72, v40, v41
    v_cvt_pk_bf16_f32 v73, v42, v43
    v_cvt_pk_bf16_f32 v74, v56, v57
    v_cvt_pk_bf16_f32 v75, v58, v59
    buffer_store_dwordx4 v[72:75], v11, s[28:31], s65 offen offset:0 sc1
    v_pk_mul_f32 v[16:17], v[44:45], v[44:45]
    buffer_load_dwordx4 v[212:215], v6, s[28:31], s13 offen sc1
    v_pk_mul_f32 v[18:19], v[46:47], v[46:47]
    v_pk_mul_f32 v[20:21], v[60:61], v[60:61]
    v_pk_mul_f32 v[22:23], v[62:63], v[62:63]
    v_pk_fma_f32 v[16:17], v[16:17], v[236:237], v[232:233] op_sel:[0,1,1] op_sel_hi:[1,1,1]
    v_pk_fma_f32 v[18:19], v[18:19], v[236:237], v[232:233] op_sel:[0,1,1] op_sel_hi:[1,1,1]
    v_pk_fma_f32 v[20:21], v[20:21], v[236:237], v[232:233] op_sel:[0,1,1] op_sel_hi:[1,1,1]
    v_pk_fma_f32 v[22:23], v[22:23], v[236:237], v[232:233] op_sel:[0,1,1] op_sel_hi:[1,1,1]
    v_pk_mul_f32 v[16:17], v[16:17], v[44:45]
    v_pk_mul_f32 v[18:19], v[18:19], v[46:47]
    s_add_u32 s13, s77, 106496
    buffer_load_dwordx4 v[216:219], v3, s[28:31], s13 offen sc1
    v_pk_mul_f32 v[20:21], v[20:21], v[60:61]
    v_pk_mul_f32 v[22:23], v[22:23], v[62:63]
    v_exp_f32 v16, v16
    v_exp_f32 v17, v17
    v_exp_f32 v18, v18
    v_exp_f32 v19, v19
    v_exp_f32 v20, v20
    v_exp_f32 v21, v21
    v_exp_f32 v22, v22
    buffer_load_dwordx4 v[220:223], v4, s[28:31], s13 offen sc1
    v_exp_f32 v23, v23
    v_pk_mul_f32 v[44:45], v[44:45], v[76:77]
    v_pk_mul_f32 v[46:47], v[46:47], v[78:79]
    v_pk_mul_f32 v[60:61], v[60:61], v[92:93]
    v_pk_mul_f32 v[62:63], v[62:63], v[94:95]
    v_pk_fma_f32 v[16:17], v[16:17], v[10:11], v[10:11] op_sel:[0,0,0] op_sel_hi:[1,0,0]
    v_pk_fma_f32 v[18:19], v[18:19], v[10:11], v[10:11] op_sel:[0,0,0] op_sel_hi:[1,0,0]
    v_pk_fma_f32 v[20:21], v[20:21], v[10:11], v[10:11] op_sel:[0,0,0] op_sel_hi:[1,0,0]
    v_pk_fma_f32 v[22:23], v[22:23], v[10:11], v[10:11] op_sel:[0,0,0] op_sel_hi:[1,0,0]
    buffer_load_dwordx4 v[224:227], v5, s[28:31], s13 offen sc1
    v_rcp_f32 v16, v16
    v_rcp_f32 v17, v17
    v_rcp_f32 v18, v18
    v_rcp_f32 v19, v19
    v_rcp_f32 v20, v20
    v_rcp_f32 v21, v21
    v_rcp_f32 v22, v22
    v_rcp_f32 v23, v23
    v_pk_mul_f32 v[44:45], v[44:45], v[16:17]
    buffer_load_dwordx4 v[228:231], v6, s[28:31], s13 offen sc1
    v_pk_mul_f32 v[46:47], v[46:47], v[18:19]
    v_pk_mul_f32 v[60:61], v[60:61], v[20:21]
    v_pk_mul_f32 v[62:63], v[62:63], v[22:23]
    v_cvt_pk_bf16_f32 v76, v44, v45
    v_cvt_pk_bf16_f32 v77, v46, v47
    v_cvt_pk_bf16_f32 v78, v60, v61
    v_cvt_pk_bf16_f32 v79, v62, v63
    buffer_store_dwordx4 v[76:79], v11, s[28:31], s65 offen offset:1024 sc1
    v_pk_mul_f32 v[16:17], v[48:49], v[48:49]
    s_add_u32 s13, s77, 110592
    buffer_load_dwordx4 v[24:27], v3, s[28:31], s13 offen sc1
    v_pk_mul_f32 v[18:19], v[50:51], v[50:51]
    v_pk_mul_f32 v[20:21], v[64:65], v[64:65]
    v_pk_mul_f32 v[22:23], v[66:67], v[66:67]
    v_pk_fma_f32 v[16:17], v[16:17], v[238:239], v[234:235] op_sel:[0,0,0] op_sel_hi:[1,0,0]
    v_pk_fma_f32 v[18:19], v[18:19], v[238:239], v[234:235] op_sel:[0,0,0] op_sel_hi:[1,0,0]
    v_pk_fma_f32 v[20:21], v[20:21], v[238:239], v[234:235] op_sel:[0,0,0] op_sel_hi:[1,0,0]
    v_pk_fma_f32 v[22:23], v[22:23], v[238:239], v[234:235] op_sel:[0,0,0] op_sel_hi:[1,0,0]
    v_pk_mul_f32 v[16:17], v[16:17], v[48:49]
    v_pk_mul_f32 v[18:19], v[18:19], v[50:51]
    buffer_load_dwordx4 v[28:31], v4, s[28:31], s13 offen sc1
    v_pk_mul_f32 v[20:21], v[20:21], v[64:65]
    v_pk_mul_f32 v[22:23], v[22:23], v[66:67]
    v_exp_f32 v16, v16
    v_exp_f32 v17, v17
    v_exp_f32 v18, v18
    v_exp_f32 v19, v19
    v_exp_f32 v20, v20
    v_exp_f32 v21, v21
    v_exp_f32 v22, v22
    buffer_load_dwordx4 v[32:35], v5, s[28:31], s13 offen sc1
    v_exp_f32 v23, v23
    v_pk_mul_f32 v[48:49], v[48:49], v[80:81]
    v_pk_mul_f32 v[50:51], v[50:51], v[82:83]
    v_pk_mul_f32 v[64:65], v[64:65], v[96:97]
    v_pk_mul_f32 v[66:67], v[66:67], v[98:99]
    v_pk_fma_f32 v[16:17], v[16:17], v[12:13], v[12:13] op_sel:[0,0,0] op_sel_hi:[1,0,0]
    v_pk_fma_f32 v[18:19], v[18:19], v[12:13], v[12:13] op_sel:[0,0,0] op_sel_hi:[1,0,0]
    v_pk_fma_f32 v[20:21], v[20:21], v[12:13], v[12:13] op_sel:[0,0,0] op_sel_hi:[1,0,0]
    v_pk_fma_f32 v[22:23], v[22:23], v[12:13], v[12:13] op_sel:[0,0,0] op_sel_hi:[1,0,0]
    buffer_load_dwordx4 v[36:39], v6, s[28:31], s13 offen sc1
    v_rcp_f32 v16, v16
    v_rcp_f32 v17, v17
    v_rcp_f32 v18, v18
    v_rcp_f32 v19, v19
    v_rcp_f32 v20, v20
    v_rcp_f32 v21, v21
    v_rcp_f32 v22, v22
    v_rcp_f32 v23, v23
    v_pk_mul_f32 v[48:49], v[48:49], v[16:17]
    s_add_u32 s13, s92, 983040
    buffer_load_dwordx4 a[208:211], v11, s[28:31], s13 offen offset:0 sc1
    v_pk_mul_f32 v[50:51], v[50:51], v[18:19]
    v_pk_mul_f32 v[64:65], v[64:65], v[20:21]
    v_pk_mul_f32 v[66:67], v[66:67], v[22:23]
    v_cvt_pk_bf16_f32 v80, v48, v49
    v_cvt_pk_bf16_f32 v81, v50, v51
    v_cvt_pk_bf16_f32 v82, v64, v65
    v_cvt_pk_bf16_f32 v83, v66, v67
    buffer_store_dwordx4 v[80:83], v11, s[28:31], s65 offen offset:2048 sc1
    v_pk_mul_f32 v[16:17], v[52:53], v[52:53]
    buffer_load_dwordx4 a[212:215], v11, s[28:31], s13 offen offset:1024 sc1
    v_pk_mul_f32 v[18:19], v[54:55], v[54:55]
    v_pk_mul_f32 v[20:21], v[68:69], v[68:69]
    v_pk_mul_f32 v[22:23], v[70:71], v[70:71]
    v_pk_fma_f32 v[16:17], v[16:17], v[238:239], v[234:235] op_sel:[0,1,1] op_sel_hi:[1,1,1]
    v_pk_fma_f32 v[18:19], v[18:19], v[238:239], v[234:235] op_sel:[0,1,1] op_sel_hi:[1,1,1]
    v_pk_fma_f32 v[20:21], v[20:21], v[238:239], v[234:235] op_sel:[0,1,1] op_sel_hi:[1,1,1]
    v_pk_fma_f32 v[22:23], v[22:23], v[238:239], v[234:235] op_sel:[0,1,1] op_sel_hi:[1,1,1]
    v_pk_mul_f32 v[16:17], v[16:17], v[52:53]
    v_pk_mul_f32 v[18:19], v[18:19], v[54:55]
    buffer_load_dwordx4 a[216:219], v11, s[28:31], s13 offen offset:2048 sc1
    v_pk_mul_f32 v[20:21], v[20:21], v[68:69]
    v_pk_mul_f32 v[22:23], v[22:23], v[70:71]
    v_exp_f32 v16, v16
    v_exp_f32 v17, v17
    v_exp_f32 v18, v18
    v_exp_f32 v19, v19
    s_buffer_load_dwordx4 s[56:59], s[28:31], s35 offset:0 glc
    v_exp_f32 v20, v20
    v_exp_f32 v21, v21
    v_exp_f32 v22, v22
    buffer_load_dwordx4 a[220:223], v11, s[28:31], s13 offen offset:3072 sc1
    v_exp_f32 v23, v23
    v_pk_mul_f32 v[52:53], v[52:53], v[84:85]
    v_pk_mul_f32 v[54:55], v[54:55], v[86:87]
    v_pk_mul_f32 v[68:69], v[68:69], v[100:101]
    v_pk_mul_f32 v[70:71], v[70:71], v[102:103]
    v_pk_fma_f32 v[16:17], v[16:17], v[12:13], v[12:13] op_sel:[0,1,1] op_sel_hi:[1,1,1]
    v_pk_fma_f32 v[18:19], v[18:19], v[12:13], v[12:13] op_sel:[0,1,1] op_sel_hi:[1,1,1]
    v_pk_fma_f32 v[20:21], v[20:21], v[12:13], v[12:13] op_sel:[0,1,1] op_sel_hi:[1,1,1]
    v_pk_fma_f32 v[22:23], v[22:23], v[12:13], v[12:13] op_sel:[0,1,1] op_sel_hi:[1,1,1]
    v_rcp_f32 v16, v16
    v_rcp_f32 v17, v17
    v_rcp_f32 v18, v18
    v_rcp_f32 v19, v19
    v_rcp_f32 v20, v20
    v_rcp_f32 v21, v21
    v_rcp_f32 v22, v22
    v_rcp_f32 v23, v23
    v_pk_mul_f32 v[52:53], v[52:53], v[16:17]
    v_pk_mul_f32 v[54:55], v[54:55], v[18:19]
    v_pk_mul_f32 v[68:69], v[68:69], v[20:21]
    v_pk_mul_f32 v[70:71], v[70:71], v[22:23]
    v_cvt_pk_bf16_f32 v84, v52, v53
    v_cvt_pk_bf16_f32 v85, v54, v55
    v_cvt_pk_bf16_f32 v86, v68, v69
    v_cvt_pk_bf16_f32 v87, v70, v71
    buffer_store_dwordx4 v[84:87], v11, s[28:31], s65 offen offset:3072 sc1
    s_waitcnt vmcnt(28)
    v_mfma_f32_16x16x32_bf16 v[104:107], a[0:3], v[184:187], 0
    s_waitcnt lgkmcnt(0)
    s_add_u32 s100, s1, 2
    s_sub_u32 s56, s56, s100
    s_sub_u32 s57, s57, s100
    v_mfma_f32_16x16x32_bf16 v[120:123], a[0:3], v[188:191], 0
    s_sub_u32 s58, s58, s100
    s_sub_u32 s59, s59, s100
    s_max_u32 s56, s56, s57
    s_max_u32 s58, s58, s59
    v_mfma_f32_16x16x32_bf16 v[136:139], a[0:3], v[192:195], 0
    s_max_u32 s56, s56, s58
    s_cmp_gt_u32 s56, 1
    s_cbranch_scc1 P2ffn_f4_spin
P2ffn_f4_ok:
    s_add_u32 s13, s77, 90112
    v_mfma_f32_16x16x32_bf16 v[152:155], a[0:3], v[196:199], 0
    buffer_load_dwordx4 v[240:243], v3, s[28:31], s13 offen sc1
    v_mfma_f32_16x16x32_bf16 v[156:159], a[4:7], v[196:199], 0
    v_mfma_f32_16x16x32_bf16 v[140:143], a[4:7], v[192:195], 0
    v_mfma_f32_16x16x32_bf16 v[124:127], a[4:7], v[188:191], 0
    buffer_load_dwordx4 v[244:247], v4, s[28:31], s13 offen sc1
    v_mfma_f32_16x16x32_bf16 v[108:111], a[4:7], v[184:187], 0
    v_mfma_f32_16x16x32_bf16 v[112:115], a[8:11], v[184:187], 0
    v_mfma_f32_16x16x32_bf16 v[128:131], a[8:11], v[188:191], 0
    buffer_load_dwordx4 v[248:251], v5, s[28:31], s13 offen sc1
    v_mfma_f32_16x16x32_bf16 v[144:147], a[8:11], v[192:195], 0
    v_mfma_f32_16x16x32_bf16 v[160:163], a[8:11], v[196:199], 0
    v_mfma_f32_16x16x32_bf16 v[164:167], a[12:15], v[196:199], 0
    buffer_load_dwordx4 v[252:255], v6, s[28:31], s13 offen sc1
    v_mfma_f32_16x16x32_bf16 v[148:151], a[12:15], v[192:195], 0
    v_mfma_f32_16x16x32_bf16 v[132:135], a[12:15], v[188:191], 0
    v_mfma_f32_16x16x32_bf16 v[116:119], a[12:15], v[184:187], 0
    s_waitcnt vmcnt(19)
    v_mfma_f32_16x16x32_bf16 v[104:107], a[16:19], v[200:203], v[104:107]
    s_add_u32 s13, s77, 94208
    v_mfma_f32_16x16x32_bf16 v[120:123], a[16:19], v[204:207], v[120:123]
    buffer_load_dwordx4 v[184:187], v3, s[28:31], s13 offen sc1
    v_mfma_f32_16x16x32_bf16 v[136:139], a[16:19], v[208:211], v[136:139]
    v_mfma_f32_16x16x32_bf16 v[152:155], a[16:19], v[212:215], v[152:155]
    v_mfma_f32_16x16x32_bf16 v[156:159], a[20:23], v[212:215], v[156:159]
    buffer_load_dwordx4 v[188:191], v4, s[28:31], s13 offen sc1
    v_mfma_f32_16x16x32_bf16 v[140:143], a[20:23], v[208:211], v[140:143]
    v_mfma_f32_16x16x32_bf16 v[124:127], a[20:23], v[204:207], v[124:127]
    v_mfma_f32_16x16x32_bf16 v[108:111], a[20:23], v[200:203], v[108:111]
    s_waitcnt vmcnt(6)
    v_mfma_f32_16x16x32_bf16 v[112:115], a[24:27], v[200:203], v[112:115]
    s_mov_b64 exec, 8
    buffer_store_dword v2, off, s[28:31], s34 sc1
    s_mov_b64 exec, -1
    v_mfma_f32_16x16x32_bf16 v[128:131], a[24:27], v[204:207], v[128:131]
    v_mfma_f32_16x16x32_bf16 v[144:147], a[24:27], v[208:211], v[144:147]
    v_mfma_f32_16x16x32_bf16 v[160:163], a[24:27], v[212:215], v[160:163]
    buffer_load_dwordx4 v[192:195], v5, s[28:31], s13 offen sc1
    v_mfma_f32_16x16x32_bf16 v[164:167], a[28:31], v[212:215], v[164:167]
    v_mfma_f32_16x16x32_bf16 v[148:151], a[28:31], v[208:211], v[148:151]
    v_mfma_f32_16x16x32_bf16 v[132:135], a[28:31], v[204:207], v[132:135]
    buffer_load_dwordx4 v[196:199], v6, s[28:31], s13 offen sc1
    v_mfma_f32_16x16x32_bf16 v[116:119], a[28:31], v[200:203], v[116:119]
    s_add_u32 s13, s77, 114688
    buffer_load_dwordx4 a[0:3], v3, s[28:31], s13 offen sc1
    buffer_load_dwordx4 a[4:7], v4, s[28:31], s13 offen sc1
    buffer_load_dwordx4 a[8:11], v5, s[28:31], s13 offen sc1
    buffer_load_dwordx4 a[12:15], v6, s[28:31], s13 offen sc1
    v_mfma_f32_16x16x32_bf16 v[104:107], a[32:35], v[216:219], v[104:107]
    s_add_u32 s13, s77, 118784
    v_mfma_f32_16x16x32_bf16 v[120:123], a[32:35], v[220:223], v[120:123]
    buffer_load_dwordx4 v[200:203], v3, s[28:31], s13 offen sc1
    v_mfma_f32_16x16x32_bf16 v[136:139], a[32:35], v[224:227], v[136:139]
    v_mfma_f32_16x16x32_bf16 v[152:155], a[32:35], v[228:231], v[152:155]
    v_mfma_f32_16x16x32_bf16 v[156:159], a[36:39], v[228:231], v[156:159]
    buffer_load_dwordx4 v[204:207], v4, s[28:31], s13 offen sc1
    v_mfma_f32_16x16x32_bf16 v[140:143], a[36:39], v[224:227], v[140:143]
    v_mfma_f32_16x16x32_bf16 v[124:127], a[36:39], v[220:223], v[124:127]
    v_mfma_f32_16x16x32_bf16 v[108:111], a[36:39], v[216:219], v[108:111]
    buffer_load_dwordx4 v[208:211], v5, s[28:31], s13 offen sc1
    v_mfma_f32_16x16x32_bf16 v[112:115], a[40:43], v[216:219], v[112:115]
    v_mfma_f32_16x16x32_bf16 v[128:131], a[40:43], v[220:223], v[128:131]
    v_mfma_f32_16x16x32_bf16 v[144:147], a[40:43], v[224:227], v[144:147]
    buffer_load_dwordx4 v[212:215], v6, s[28:31], s13 offen sc1
    v_mfma_f32_16x16x32_bf16 v[160:163], a[40:43], v[228:231], v[160:163]
    v_mfma_f32_16x16x32_bf16 v[164:167], a[44:47], v[228:231], v[164:167]
    v_mfma_f32_16x16x32_bf16 v[148:151], a[44:47], v[224:227], v[148:151]
    v_mfma_f32_16x16x32_bf16 v[132:135], a[44:47], v[220:223], v[132:135]
    v_mfma_f32_16x16x32_bf16 v[116:119], a[44:47], v[216:219], v[116:119]
    v_mfma_f32_16x16x32_bf16 v[104:107], a[48:51], v[24:27], v[104:107]
    s_buffer_load_dwordx4 s[56:59], s[28:31], s35 offset:16 glc
    s_add_u32 s13, s92, 1024000
    v_mfma_f32_16x16x32_bf16 v[120:123], a[48:51], v[28:31], v[120:123]
    v_mfma_f32_16x16x32_bf16 v[136:139], a[48:51], v[32:35], v[136:139]
    v_mfma_f32_16x16x32_bf16 v[152:155], a[48:51], v[36:39], v[152:155]
    buffer_load_dwordx4 a[224:227], v7, s[28:31], s13 offen offset:0 sc1
    v_mfma_f32_16x16x32_bf16 v[156:159], a[52:55], v[36:39], v[156:159]
    v_mfma_f32_16x16x32_bf16 v[140:143], a[52:55], v[32:35], v[140:143]
    v_mfma_f32_16x16x32_bf16 v[124:127], a[52:55], v[28:31], v[124:127]
    buffer_load_dwordx4 a[228:231], v7, s[28:31], s13 offen offset:1024 sc1
    v_mfma_f32_16x16x32_bf16 v[108:111], a[52:55], v[24:27], v[108:111]
    v_mfma_f32_16x16x32_bf16 v[112:115], a[56:59], v[24:27], v[112:115]
    v_mfma_f32_16x16x32_bf16 v[128:131], a[56:59], v[28:31], v[128:131]
    buffer_load_dwordx4 a[232:235], v7, s[28:31], s13 offen offset:2048 sc1
    v_mfma_f32_16x16x32_bf16 v[144:147], a[56:59], v[32:35], v[144:147]
    v_mfma_f32_16x16x32_bf16 v[160:163], a[56:59], v[36:39], v[160:163]
    v_mfma_f32_16x16x32_bf16 v[164:167], a[60:63], v[36:39], v[164:167]
    buffer_load_dwordx4 a[236:239], v7, s[28:31], s13 offen offset:3072 sc1
    v_mfma_f32_16x16x32_bf16 v[148:151], a[60:63], v[32:35], v[148:151]
    v_mfma_f32_16x16x32_bf16 v[132:135], a[60:63], v[28:31], v[132:135]
    v_mfma_f32_16x16x32_bf16 v[116:119], a[60:63], v[24:27], v[116:119]
    s_waitcnt vmcnt(17)
    v_mfma_f32_16x16x32_bf16 v[104:107], a[64:67], v[240:243], v[104:107]
    s_add_u32 s13, s92, 1228800
    v_mfma_f32_16x16x32_bf16 v[120:123], a[64:67], v[244:247], v[120:123]
    buffer_load_dwordx4 a[240:243], v7, s[28:31], s13 offen offset:0 sc1
    v_mfma_f32_16x16x32_bf16 v[136:139], a[64:67], v[248:251], v[136:139]
    v_mfma_f32_16x16x32_bf16 v[152:155], a[64:67], v[252:255], v[152:155]
    v_mfma_f32_16x16x32_bf16 v[156:159], a[68:71], v[252:255], v[156:159]
    buffer_load_dwordx4 a[244:247], v7, s[28:31], s13 offen offset:1024 sc1
    v_mfma_f32_16x16x32_bf16 v[140:143], a[68:71], v[248:251], v[140:143]
    v_mfma_f32_16x16x32_bf16 v[124:127], a[68:71], v[244:247], v[124:127]
    v_mfma_f32_16x16x32_bf16 v[108:111], a[68:71], v[240:243], v[108:111]
    buffer_load_dwordx4 a[248:251], v7, s[28:31], s13 offen offset:2048 sc1
    v_mfma_f32_16x16x32_bf16 v[112:115], a[72:75], v[240:243], v[112:115]
    v_mfma_f32_16x16x32_bf16 v[128:131], a[72:75], v[244:247], v[128:131]
    v_mfma_f32_16x16x32_bf16 v[144:147], a[72:75], v[248:251], v[144:147]
    buffer_load_dwordx4 a[252:255], v7, s[28:31], s13 offen offset:3072 sc1
    v_mfma_f32_16x16x32_bf16 v[160:163], a[72:75], v[252:255], v[160:163]
    v_mfma_f32_16x16x32_bf16 v[164:167], a[76:79], v[252:255], v[164:167]
    v_mfma_f32_16x16x32_bf16 v[148:151], a[76:79], v[248:251], v[148:151]
    v_mfma_f32_16x16x32_bf16 v[132:135], a[76:79], v[244:247], v[132:135]
    v_mfma_f32_16x16x32_bf16 v[116:119], a[76:79], v[240:243], v[116:119]
    s_waitcnt vmcnt(16)
    v_mfma_f32_16x16x32_bf16 v[104:107], a[80:83], v[184:187], v[104:107]
    s_waitcnt lgkmcnt(0)
    s_add_u32 s100, s1, 1
    v_mfma_f32_16x16x32_bf16 v[120:123], a[80:83], v[188:191], v[120:123]
    s_sub_u32 s56, s56, s100
    s_sub_u32 s57, s57, s100
    v_mfma_f32_16x16x32_bf16 v[136:139], a[80:83], v[192:195], v[136:139]
    s_sub_u32 s58, s58, s100
    s_sub_u32 s59, s59, s100
    v_mfma_f32_16x16x32_bf16 v[152:155], a[80:83], v[196:199], v[152:155]
    s_max_u32 s56, s56, s57
    s_max_u32 s58, s58, s59
    v_mfma_f32_16x16x32_bf16 v[156:159], a[84:87], v[196:199], v[156:159]
    s_max_u32 s56, s56, s58
    v_mfma_f32_16x16x32_bf16 v[140:143], a[84:87], v[192:195], v[140:143]
    s_cmp_gt_u32 s56, 2
    s_cbranch_scc1 P2ffn_f8_spin
P2ffn_f8_ok:
    v_mfma_f32_16x16x32_bf16 v[124:127], a[84:87], v[188:191], v[124:127]
    s_add_u32 s13, s78, 0
    v_mfma_f32_16x16x32_bf16 v[108:111], a[84:87], v[184:187], v[108:111]
    buffer_load_dwordx4 a[16:19], v3, s[28:31], s13 offen sc1
    v_mfma_f32_16x16x32_bf16 v[112:115], a[88:91], v[184:187], v[112:115]
    v_mfma_f32_16x16x32_bf16 v[128:131], a[88:91], v[188:191], v[128:131]
    v_mfma_f32_16x16x32_bf16 v[144:147], a[88:91], v[192:195], v[144:147]
    buffer_load_dwordx4 a[20:23], v4, s[28:31], s13 offen sc1
    v_mfma_f32_16x16x32_bf16 v[160:163], a[88:91], v[196:199], v[160:163]
    v_mfma_f32_16x16x32_bf16 v[164:167], a[92:95], v[196:199], v[164:167]
    v_mfma_f32_16x16x32_bf16 v[148:151], a[92:95], v[192:195], v[148:151]
    buffer_load_dwordx4 a[24:27], v5, s[28:31], s13 offen sc1
    v_mfma_f32_16x16x32_bf16 v[132:135], a[92:95], v[188:191], v[132:135]
    v_mfma_f32_16x16x32_bf16 v[116:119], a[92:95], v[184:187], v[116:119]
    buffer_load_dwordx4 a[28:31], v6, s[28:31], s13 offen sc1
    s_add_u32 s13, s78, 4096
    buffer_load_dwordx4 v[216:219], v3, s[28:31], s13 offen sc1
    buffer_load_dwordx4 v[220:223], v4, s[28:31], s13 offen sc1
    buffer_load_dwordx4 v[224:227], v5, s[28:31], s13 offen sc1
    buffer_load_dwordx4 v[228:231], v6, s[28:31], s13 offen sc1
    s_waitcnt vmcnt(20)
    v_mfma_f32_16x16x32_bf16 v[104:107], a[96:99], a[0:3], v[104:107]
    s_add_u32 s13, s78, 8192
    v_mfma_f32_16x16x32_bf16 v[120:123], a[96:99], a[4:7], v[120:123]
    buffer_load_dwordx4 a[32:35], v3, s[28:31], s13 offen sc1
    v_mfma_f32_16x16x32_bf16 v[136:139], a[96:99], a[8:11], v[136:139]
    v_mfma_f32_16x16x32_bf16 v[152:155], a[96:99], a[12:15], v[152:155]
    v_mfma_f32_16x16x32_bf16 v[156:159], a[100:103], a[12:15], v[156:159]
    buffer_load_dwordx4 a[36:39], v4, s[28:31], s13 offen sc1
    v_mfma_f32_16x16x32_bf16 v[140:143], a[100:103], a[8:11], v[140:143]
    v_mfma_f32_16x16x32_bf16 v[124:127], a[100:103], a[4:7], v[124:127]
    v_mfma_f32_16x16x32_bf16 v[108:111], a[100:103], a[0:3], v[108:111]
    buffer_load_dwordx4 a[40:43], v5, s[28:31], s13 offen sc1
    v_mfma_f32_16x16x32_bf16 v[112:115], a[104:107], a[0:3], v[112:115]
    v_mfma_f32_16x16x32_bf16 v[128:131], a[104:107], a[4:7], v[128:131]
    v_mfma_f32_16x16x32_bf16 v[144:147], a[104:107], a[8:11], v[144:147]
    buffer_load_dwordx4 a[44:47], v6, s[28:31], s13 offen sc1
    v_mfma_f32_16x16x32_bf16 v[160:163], a[104:107], a[12:15], v[160:163]
    v_mfma_f32_16x16x32_bf16 v[164:167], a[108:111], a[12:15], v[164:167]
    v_mfma_f32_16x16x32_bf16 v[148:151], a[108:111], a[8:11], v[148:151]
    v_mfma_f32_16x16x32_bf16 v[132:135], a[108:111], a[4:7], v[132:135]
    v_mfma_f32_16x16x32_bf16 v[116:119], a[108:111], a[0:3], v[116:119]
    s_waitcnt vmcnt(20)
    v_mfma_f32_16x16x32_bf16 v[104:107], a[112:115], v[200:203], v[104:107]
    s_add_u32 s13, s78, 12288
    v_mfma_f32_16x16x32_bf16 v[120:123], a[112:115], v[204:207], v[120:123]
    buffer_load_dwordx4 v[24:27], v3, s[28:31], s13 offen sc1
    v_mfma_f32_16x16x32_bf16 v[136:139], a[112:115], v[208:211], v[136:139]
    v_mfma_f32_16x16x32_bf16 v[152:155], a[112:115], v[212:215], v[152:155]
    v_mfma_f32_16x16x32_bf16 v[156:159], a[116:119], v[212:215], v[156:159]
    buffer_load_dwordx4 v[28:31], v4, s[28:31], s13 offen sc1
    v_mfma_f32_16x16x32_bf16 v[140:143], a[116:119], v[208:211], v[140:143]
    v_mfma_f32_16x16x32_bf16 v[124:127], a[116:119], v[204:207], v[124:127]
    v_mfma_f32_16x16x32_bf16 v[108:111], a[116:119], v[200:203], v[108:111]
    buffer_load_dwordx4 v[32:35], v5, s[28:31], s13 offen sc1
    v_mfma_f32_16x16x32_bf16 v[112:115], a[120:123], v[200:203], v[112:115]
    v_mfma_f32_16x16x32_bf16 v[128:131], a[120:123], v[204:207], v[128:131]
    v_mfma_f32_16x16x32_bf16 v[144:147], a[120:123], v[208:211], v[144:147]
    buffer_load_dwordx4 v[36:39], v6, s[28:31], s13 offen sc1
    v_mfma_f32_16x16x32_bf16 v[160:163], a[120:123], v[212:215], v[160:163]
    v_mfma_f32_16x16x32_bf16 v[164:167], a[124:127], v[212:215], v[164:167]
    v_mfma_f32_16x16x32_bf16 v[148:151], a[124:127], v[208:211], v[148:151]
    v_mfma_f32_16x16x32_bf16 v[132:135], a[124:127], v[204:207], v[132:135]
    v_mfma_f32_16x16x32_bf16 v[116:119], a[124:127], v[200:203], v[116:119]
    s_waitcnt vmcnt(12)
    v_mfma_f32_16x16x32_bf16 v[104:107], a[128:131], a[16:19], v[104:107]
    s_buffer_load_dwordx4 s[56:59], s[28:31], s35 offset:0 glc
    s_add_u32 s13, s78, 16384
    v_mfma_f32_16x16x32_bf16 v[120:123], a[128:131], a[20:23], v[120:123]
    v_mfma_f32_16x16x32_bf16 v[136:139], a[128:131], a[24:27], v[136:139]
    v_mfma_f32_16x16x32_bf16 v[152:155], a[128:131], a[28:31], v[152:155]
    buffer_load_dwordx4 a[48:51], v3, s[28:31], s13 offen sc1
    v_mfma_f32_16x16x32_bf16 v[156:159], a[132:135], a[28:31], v[156:159]
    v_mfma_f32_16x16x32_bf16 v[140:143], a[132:135], a[24:27], v[140:143]
    v_mfma_f32_16x16x32_bf16 v[124:127], a[132:135], a[20:23], v[124:127]
    buffer_load_dwordx4 a[52:55], v4, s[28:31], s13 offen sc1
    v_mfma_f32_16x16x32_bf16 v[108:111], a[132:135], a[16:19], v[108:111]
    v_mfma_f32_16x16x32_bf16 v[112:115], a[136:139], a[16:19], v[112:115]
    v_mfma_f32_16x16x32_bf16 v[128:131], a[136:139], a[20:23], v[128:131]
    buffer_load_dwordx4 a[56:59], v5, s[28:31], s13 offen sc1
    v_mfma_f32_16x16x32_bf16 v[144:147], a[136:139], a[24:27], v[144:147]
    v_mfma_f32_16x16x32_bf16 v[160:163], a[136:139], a[28:31], v[160:163]
    v_mfma_f32_16x16x32_bf16 v[164:167], a[140:143], a[28:31], v[164:167]
    buffer_load_dwordx4 a[60:63], v6, s[28:31], s13 offen sc1
    v_mfma_f32_16x16x32_bf16 v[148:151], a[140:143], a[24:27], v[148:151]
    v_mfma_f32_16x16x32_bf16 v[132:135], a[140:143], a[20:23], v[132:135]
    v_mfma_f32_16x16x32_bf16 v[116:119], a[140:143], a[16:19], v[116:119]
    s_waitcnt vmcnt(12)
    v_mfma_f32_16x16x32_bf16 v[104:107], a[144:147], v[216:219], v[104:107]
    s_add_u32 s13, s92, 1269760
    v_mfma_f32_16x16x32_bf16 v[120:123], a[144:147], v[220:223], v[120:123]
    buffer_load_dwordx4 v[168:171], v7, s[28:31], s13 offen offset:0 sc1
    v_mfma_f32_16x16x32_bf16 v[136:139], a[144:147], v[224:227], v[136:139]
    v_mfma_f32_16x16x32_bf16 v[152:155], a[144:147], v[228:231], v[152:155]
    v_mfma_f32_16x16x32_bf16 v[156:159], a[148:151], v[228:231], v[156:159]
    buffer_load_dwordx4 v[172:175], v7, s[28:31], s13 offen offset:1024 sc1
    v_mfma_f32_16x16x32_bf16 v[140:143], a[148:151], v[224:227], v[140:143]
    v_mfma_f32_16x16x32_bf16 v[124:127], a[148:151], v[220:223], v[124:127]
    v_mfma_f32_16x16x32_bf16 v[108:111], a[148:151], v[216:219], v[108:111]
    buffer_load_dwordx4 v[176:179], v7, s[28:31], s13 offen offset:2048 sc1
    v_mfma_f32_16x16x32_bf16 v[112:115], a[152:155], v[216:219], v[112:115]
    v_mfma_f32_16x16x32_bf16 v[128:131], a[152:155], v[220:223], v[128:131]
    v_mfma_f32_16x16x32_bf16 v[144:147], a[152:155], v[224:227], v[144:147]
    buffer_load_dwordx4 v[180:183], v7, s[28:31], s13 offen offset:3072 sc1
    v_mfma_f32_16x16x32_bf16 v[160:163], a[152:155], v[228:231], v[160:163]
    v_mfma_f32_16x16x32_bf16 v[164:167], a[156:159], v[228:231], v[164:167]
    v_mfma_f32_16x16x32_bf16 v[148:151], a[156:159], v[224:227], v[148:151]
    v_mfma_f32_16x16x32_bf16 v[132:135], a[156:159], v[220:223], v[132:135]
    v_mfma_f32_16x16x32_bf16 v[116:119], a[156:159], v[216:219], v[116:119]
    s_waitcnt vmcnt(12)
    v_mfma_f32_16x16x32_bf16 v[104:107], a[160:163], a[32:35], v[104:107]
    s_waitcnt lgkmcnt(0)
    s_add_u32 s100, s1, 3
    v_mfma_f32_16x16x32_bf16 v[120:123], a[160:163], a[36:39], v[120:123]
    s_sub_u32 s56, s56, s100
    s_sub_u32 s57, s57, s100
    v_mfma_f32_16x16x32_bf16 v[136:139], a[160:163], a[40:43], v[136:139]
    s_sub_u32 s58, s58, s100
    s_sub_u32 s59, s59, s100
    v_mfma_f32_16x16x32_bf16 v[152:155], a[160:163], a[44:47], v[152:155]
    s_max_u32 s56, s56, s57
    s_max_u32 s58, s58, s59
    v_mfma_f32_16x16x32_bf16 v[156:159], a[164:167], a[44:47], v[156:159]
    s_max_u32 s56, s56, s58
    v_mfma_f32_16x16x32_bf16 v[140:143], a[164:167], a[40:43], v[140:143]
    s_cmp_gt_u32 s56, 0
    s_cbranch_scc1 P2ffn_f13_spin
P2ffn_f13_ok:
    v_mfma_f32_16x16x32_bf16 v[124:127], a[164:167], a[36:39], v[124:127]
    s_add_u32 s13, s77, 98304
    v_mfma_f32_16x16x32_bf16 v[108:111], a[164:167], a[32:35], v[108:111]
    buffer_load_dwordx4 v[44:47], v4, s[28:31], s13 offen sc1
    v_mfma_f32_16x16x32_bf16 v[112:115], a[168:171], a[32:35], v[112:115]
    s_add_u32 s13, s77, 102400
    v_mfma_f32_16x16x32_bf16 v[128:131], a[168:171], a[36:39], v[128:131]
    v_mfma_f32_16x16x32_bf16 v[144:147], a[168:171], a[40:43], v[144:147]
    buffer_load_dwordx4 v[60:63], v4, s[28:31], s13 offen sc1
    v_mfma_f32_16x16x32_bf16 v[160:163], a[168:171], a[44:47], v[160:163]
    s_add_u32 s13, s77, 122880
    v_mfma_f32_16x16x32_bf16 v[164:167], a[172:175], a[44:47], v[164:167]
    v_mfma_f32_16x16x32_bf16 v[148:151], a[172:175], a[40:43], v[148:151]
    buffer_load_dwordx4 v[76:79], v4, s[28:31], s13 offen sc1
    v_mfma_f32_16x16x32_bf16 v[132:135], a[172:175], a[36:39], v[132:135]
    s_add_u32 s13, s77, 126976
    v_mfma_f32_16x16x32_bf16 v[116:119], a[172:175], a[32:35], v[116:119]
    buffer_load_dwordx4 v[92:95], v4, s[28:31], s13 offen sc1
    s_add_u32 s13, s77, 98304
    buffer_load_dwordx4 v[48:51], v5, s[28:31], s13 offen sc1
    s_add_u32 s13, s77, 102400
    buffer_load_dwordx4 v[64:67], v5, s[28:31], s13 offen sc1
    s_add_u32 s13, s77, 122880
    buffer_load_dwordx4 v[80:83], v5, s[28:31], s13 offen sc1
    s_add_u32 s13, s77, 126976
    buffer_load_dwordx4 v[96:99], v5, s[28:31], s13 offen sc1
    v_and_b32 v9, 0xf0, v7
    v_mul_u32_u24 v9, 80, v9
    v_lshrrev_b32 v8, 8, v7
    v_lshl_add_u32 v8, v8, 4, v9
    buffer_load_dwordx4 v[216:219], v8, s[16:19], s3 offen offset:0
    buffer_load_dwordx4 v[220:223], v8, s[16:19], s3 offen offset:64
    s_waitcnt vmcnt(18)
    v_mfma_f32_16x16x32_bf16 v[104:107], a[176:179], v[24:27], v[104:107]
    s_add_u32 s13, s77, 98304
    v_mfma_f32_16x16x32_bf16 v[120:123], a[176:179], v[28:31], v[120:123]
    buffer_load_dwordx4 v[52:55], v6, s[28:31], s13 offen sc1
    v_mfma_f32_16x16x32_bf16 v[136:139], a[176:179], v[32:35], v[136:139]
    s_add_u32 s13, s77, 102400
    v_mfma_f32_16x16x32_bf16 v[152:155], a[176:179], v[36:39], v[152:155]
    v_mfma_f32_16x16x32_bf16 v[156:159], a[180:183], v[36:39], v[156:159]
    buffer_load_dwordx4 v[68:71], v6, s[28:31], s13 offen sc1
    v_mfma_f32_16x16x32_bf16 v[140:143], a[180:183], v[32:35], v[140:143]
    s_add_u32 s13, s77, 122880
    v_mfma_f32_16x16x32_bf16 v[124:127], a[180:183], v[28:31], v[124:127]
    v_mfma_f32_16x16x32_bf16 v[108:111], a[180:183], v[24:27], v[108:111]
    buffer_load_dwordx4 v[84:87], v6, s[28:31], s13 offen sc1
    v_mfma_f32_16x16x32_bf16 v[112:115], a[184:187], v[24:27], v[112:115]
    s_add_u32 s13, s77, 126976
    v_mfma_f32_16x16x32_bf16 v[128:131], a[184:187], v[28:31], v[128:131]
    v_mfma_f32_16x16x32_bf16 v[144:147], a[184:187], v[32:35], v[144:147]
    buffer_load_dwordx4 v[100:103], v6, s[28:31], s13 offen sc1
    v_mfma_f32_16x16x32_bf16 v[160:163], a[184:187], v[36:39], v[160:163]
    v_mfma_f32_16x16x32_bf16 v[164:167], a[188:191], v[36:39], v[164:167]
    v_mfma_f32_16x16x32_bf16 v[148:151], a[188:191], v[32:35], v[148:151]
    v_mfma_f32_16x16x32_bf16 v[132:135], a[188:191], v[28:31], v[132:135]
    v_mfma_f32_16x16x32_bf16 v[116:119], a[188:191], v[24:27], v[116:119]
    s_waitcnt vmcnt(18)
    v_mfma_f32_16x16x32_bf16 v[104:107], a[192:195], a[48:51], v[104:107]
    s_add_u32 s13, s77, 98304
    s_mov_b32 s20, s98
    v_mfma_f32_16x16x32_bf16 v[120:123], a[192:195], a[52:55], v[120:123]
    buffer_load_dwordx4 v[40:43], v3, s[28:31], s13 offen sc1
    v_mfma_f32_16x16x32_bf16 v[136:139], a[192:195], a[56:59], v[136:139]
    s_add_u32 s13, s77, 102400
    s_and_b32 s21, s99, 0xffff
    v_mfma_f32_16x16x32_bf16 v[152:155], a[192:195], a[60:63], v[152:155]
    s_mov_b32 s22, 0x280000
    s_mov_b32 s23, 0x00020000
    v_mfma_f32_16x16x32_bf16 v[156:159], a[196:199], a[60:63], v[156:159]
    buffer_load_dwordx4 v[56:59], v3, s[28:31], s13 offen sc1
    v_mfma_f32_16x16x32_bf16 v[140:143], a[196:199], a[56:59], v[140:143]
    s_add_u32 s13, s77, 122880
    s_add_u32 s14, s32, 1
    v_mfma_f32_16x16x32_bf16 v[124:127], a[196:199], a[52:55], v[124:127]
    s_and_b32 s14, s14, 3
    s_mul_i32 s14, s14, 12288
    v_mfma_f32_16x16x32_bf16 v[108:111], a[196:199], a[48:51], v[108:111]
    buffer_load_dwordx4 v[72:75], v3, s[28:31], s13 offen sc1
    v_mfma_f32_16x16x32_bf16 v[112:115], a[200:203], a[48:51], v[112:115]
    s_add_u32 s13, s77, 126976
    v_add_u32 v10, s14, v7
    v_mfma_f32_16x16x32_bf16 v[128:131], a[200:203], a[52:55], v[128:131]
    s_add_u32 s14, s32, 2
    s_and_b32 s14, s14, 3
    v_mfma_f32_16x16x32_bf16 v[144:147], a[200:203], a[56:59], v[144:147]
    buffer_load_dwordx4 v[88:91], v3, s[28:31], s13 offen sc1
    v_mfma_f32_16x16x32_bf16 v[160:163], a[200:203], a[60:63], v[160:163]
    s_mul_i32 s14, s14, 12288
    v_add_u32 v11, s14, v7
    v_mfma_f32_16x16x32_bf16 v[164:167], a[204:207], a[60:63], v[164:167]
    s_add_u32 s14, s32, 3
    s_and_b32 s14, s14, 3
    v_mfma_f32_16x16x32_bf16 v[148:151], a[204:207], a[56:59], v[148:151]
    s_mul_i32 s14, s14, 12288
    v_add_u32 v12, s14, v7
    v_mfma_f32_16x16x32_bf16 v[132:135], a[204:207], a[52:55], v[132:135]
    v_mfma_f32_16x16x32_bf16 v[116:119], a[204:207], a[48:51], v[116:119]
    s_waitcnt vmcnt(14)
    v_mfma_f32_16x16x32_bf16 v[120:123], a[208:211], v[44:47], v[120:123]
    s_barrier
    v_mfma_f32_16x16x32_bf16 v[124:127], a[212:215], v[44:47], v[124:127]
    v_mfma_f32_16x16x32_bf16 v[128:131], a[216:219], v[44:47], v[128:131]
    v_mfma_f32_16x16x32_bf16 v[132:135], a[220:223], v[44:47], v[132:135]
    v_mfma_f32_16x16x32_bf16 v[120:123], a[224:227], v[60:63], v[120:123]
    v_mfma_f32_16x16x32_bf16 v[124:127], a[228:231], v[60:63], v[124:127]
    v_mfma_f32_16x16x32_bf16 v[128:131], a[232:235], v[60:63], v[128:131]
    v_mfma_f32_16x16x32_bf16 v[132:135], a[236:239], v[60:63], v[132:135]
    v_mfma_f32_16x16x32_bf16 v[120:123], a[240:243], v[76:79], v[120:123]
    v_mfma_f32_16x16x32_bf16 v[124:127], a[244:247], v[76:79], v[124:127]
    v_mfma_f32_16x16x32_bf16 v[128:131], a[248:251], v[76:79], v[128:131]
    v_mfma_f32_16x16x32_bf16 v[132:135], a[252:255], v[76:79], v[132:135]
    v_mfma_f32_16x16x32_bf16 v[120:123], v[168:171], v[92:95], v[120:123]
    v_mfma_f32_16x16x32_bf16 v[124:127], v[172:175], v[92:95], v[124:127]
    v_mfma_f32_16x16x32_bf16 v[128:131], v[176:179], v[92:95], v[128:131]
    v_mfma_f32_16x16x32_bf16 v[132:135], v[180:183], v[92:95], v[132:135]
    s_waitcnt vmcnt(10)
    v_mfma_f32_16x16x32_bf16 v[136:139], a[208:211], v[48:51], v[136:139]
    v_mfma_f32_16x16x32_bf16 v[140:143], a[212:215], v[48:51], v[140:143]
    v_mfma_f32_16x16x32_bf16 v[144:147], a[216:219], v[48:51], v[144:147]
    v_mfma_f32_16x16x32_bf16 v[148:151], a[220:223], v[48:51], v[148:151]
    v_mfma_f32_16x16x32_bf16 v[136:139], a[224:227], v[64:67], v[136:139]
    ds_write_b128 v10, v[120:123] offset:0
    v_mfma_f32_16x16x32_bf16 v[140:143], a[228:231], v[64:67], v[140:143]
    v_mfma_f32_16x16x32_bf16 v[144:147], a[232:235], v[64:67], v[144:147]
    v_mfma_f32_16x16x32_bf16 v[148:151], a[236:239], v[64:67], v[148:151]
    ds_write_b128 v10, v[124:127] offset:1024
    v_mfma_f32_16x16x32_bf16 v[136:139], a[240:243], v[80:83], v[136:139]
    v_mfma_f32_16x16x32_bf16 v[140:143], a[244:247], v[80:83], v[140:143]
    v_mfma_f32_16x16x32_bf16 v[144:147], a[248:251], v[80:83], v[144:147]
    ds_write_b128 v10, v[128:131] offset:2048
    v_mfma_f32_16x16x32_bf16 v[148:151], a[252:255], v[80:83], v[148:151]
    v_mfma_f32_16x16x32_bf16 v[136:139], v[168:171], v[96:99], v[136:139]
    v_mfma_f32_16x16x32_bf16 v[140:143], v[172:175], v[96:99], v[140:143]
    ds_write_b128 v10, v[132:135] offset:3072
    v_mfma_f32_16x16x32_bf16 v[144:147], v[176:179], v[96:99], v[144:147]
    v_mfma_f32_16x16x32_bf16 v[148:151], v[180:183], v[96:99], v[148:151]
    s_waitcnt vmcnt(4)
    v_mfma_f32_16x16x32_bf16 v[152:155], a[208:211], v[52:55], v[152:155]
    s_mul_i32 s14, s32, 12288
    v_add_u32 v9, s14, v7
    v_mfma_f32_16x16x32_bf16 v[156:159], a[212:215], v[52:55], v[156:159]
    v_mfma_f32_16x16x32_bf16 v[160:163], a[216:219], v[52:55], v[160:163]
    v_mfma_f32_16x16x32_bf16 v[164:167], a[220:223], v[52:55], v[164:167]
    v_mfma_f32_16x16x32_bf16 v[152:155], a[224:227], v[68:71], v[152:155]
    ds_write_b128 v11, v[136:139] offset:4096
    v_mfma_f32_16x16x32_bf16 v[156:159], a[228:231], v[68:71], v[156:159]
    v_mfma_f32_16x16x32_bf16 v[160:163], a[232:235], v[68:71], v[160:163]
    v_mfma_f32_16x16x32_bf16 v[164:167], a[236:239], v[68:71], v[164:167]
    ds_write_b128 v11, v[140:143] offset:5120
    v_mfma_f32_16x16x32_bf16 v[152:155], a[240:243], v[84:87], v[152:155]
    v_mfma_f32_16x16x32_bf16 v[156:159], a[244:247], v[84:87], v[156:159]
    v_mfma_f32_16x16x32_bf16 v[160:163], a[248:251], v[84:87], v[160:163]
    ds_write_b128 v11, v[144:147] offset:6144
    v_mfma_f32_16x16x32_bf16 v[164:167], a[252:255], v[84:87], v[164:167]
    v_mfma_f32_16x16x32_bf16 v[152:155], v[168:171], v[100:103], v[152:155]
    v_mfma_f32_16x16x32_bf16 v[156:159], v[172:175], v[100:103], v[156:159]
    ds_write_b128 v11, v[148:151] offset:7168
    v_mfma_f32_16x16x32_bf16 v[160:163], v[176:179], v[100:103], v[160:163]
    v_mfma_f32_16x16x32_bf16 v[164:167], v[180:183], v[100:103], v[164:167]
    s_waitcnt vmcnt(0)
    v_mfma_f32_16x16x32_bf16 v[104:107], a[208:211], v[40:43], v[104:107]
    v_and_b32 v201, 0xffff0000, v216
    v_mfma_f32_16x16x32_bf16 v[108:111], a[212:215], v[40:43], v[108:111]
    v_lshlrev_b32 v200, 16, v216
    v_and_b32 v203, 0xffff0000, v217
    v_mfma_f32_16x16x32_bf16 v[112:115], a[216:219], v[40:43], v[112:115]
    v_lshlrev_b32 v202, 16, v217
    v_and_b32 v205, 0xffff0000, v218
    v_mfma_f32_16x16x32_bf16 v[116:119], a[220:223], v[40:43], v[116:119]
    v_lshlrev_b32 v204, 16, v218
    v_and_b32 v207, 0xffff0000, v219
    v_mfma_f32_16x16x32_bf16 v[104:107], a[224:227], v[56:59], v[104:107]
    ds_write_b128 v12, v[152:155] offset:8192
    v_mfma_f32_16x16x32_bf16 v[108:111], a[228:231], v[56:59], v[108:111]
    v_lshlrev_b32 v206, 16, v219
    v_and_b32 v209, 0xffff0000, v220
    v_mfma_f32_16x16x32_bf16 v[112:115], a[232:235], v[56:59], v[112:115]
    v_lshlrev_b32 v208, 16, v220
    v_and_b32 v211, 0xffff0000, v221
    v_mfma_f32_16x16x32_bf16 v[116:119], a[236:239], v[56:59], v[116:119]
    ds_write_b128 v12, v[156:159] offset:9216
    v_mfma_f32_16x16x32_bf16 v[104:107], a[240:243], v[72:75], v[104:107]
    v_lshlrev_b32 v210, 16, v221
    v_and_b32 v213, 0xffff0000, v222
    v_mfma_f32_16x16x32_bf16 v[108:111], a[244:247], v[72:75], v[108:111]
    v_lshlrev_b32 v212, 16, v222
    v_and_b32 v215, 0xffff0000, v223
    v_mfma_f32_16x16x32_bf16 v[112:115], a[248:251], v[72:75], v[112:115]
    ds_write_b128 v12, v[160:163] offset:10240
    v_mfma_f32_16x16x32_bf16 v[116:119], a[252:255], v[72:75], v[116:119]
    v_lshlrev_b32 v214, 16, v223
    v_mfma_f32_16x16x32_bf16 v[104:107], v[168:171], v[88:91], v[104:107]
    v_mfma_f32_16x16x32_bf16 v[108:111], v[172:175], v[88:91], v[108:111]
    ds_write_b128 v12, v[164:167] offset:11264
    v_mfma_f32_16x16x32_bf16 v[112:115], v[176:179], v[88:91], v[112:115]
    v_mfma_f32_16x16x32_bf16 v[116:119], v[180:183], v[88:91], v[116:119]
    s_waitcnt lgkmcnt(0)
    s_barrier
    ds_read_b128 v[40:43], v9 offset:0
    ds_read_b128 v[44:47], v9 offset:4096
    ds_read_b128 v[48:51], v9 offset:8192
    ds_read_b128 v[52:55], v9 offset:1024
    ds_read_b128 v[56:59], v9 offset:5120
    ds_read_b128 v[60:63], v9 offset:9216
    ds_read_b128 v[64:67], v9 offset:2048
    ds_read_b128 v[68:71], v9 offset:6144
    ds_read_b128 v[72:75], v9 offset:10240
    ds_read_b128 v[76:79], v9 offset:3072
    ds_read_b128 v[80:83], v9 offset:7168
    ds_read_b128 v[84:87], v9 offset:11264
    v_pk_add_f32 v[104:105], v[104:105], v[200:201]
    v_pk_add_f32 v[106:107], v[106:107], v[202:203]
    v_pk_add_f32 v[108:109], v[108:109], v[204:205]
    v_pk_add_f32 v[110:111], v[110:111], v[206:207]
    v_pk_add_f32 v[112:113], v[112:113], v[208:209]
    v_pk_add_f32 v[114:115], v[114:115], v[210:211]
    v_pk_add_f32 v[116:117], v[116:117], v[212:213]
    v_pk_add_f32 v[118:119], v[118:119], v[214:215]
    s_waitcnt lgkmcnt(9)
    v_pk_add_f32 v[104:105], v[104:105], v[40:41]
    v_pk_add_f32 v[106:107], v[106:107], v[42:43]
    v_pk_add_f32 v[104:105], v[104:105], v[44:45]
    v_pk_add_f32 v[106:107], v[106:107], v[46:47]
    v_pk_add_f32 v[104:105], v[104:105], v[48:49]
    v_pk_add_f32 v[106:107], v[106:107], v[50:51]
    v_cvt_pk_bf16_f32 v200, v104, v105
    v_cvt_pk_bf16_f32 v201, v106, v107
    s_waitcnt lgkmcnt(6)
    v_pk_add_f32 v[108:109], v[108:109], v[52:53]
    v_pk_add_f32 v[110:111], v[110:111], v[54:55]
    v_pk_add_f32 v[108:109], v[108:109], v[56:57]
    v_pk_add_f32 v[110:111], v[110:111], v[58:59]
    v_pk_add_f32 v[108:109], v[108:109], v[60:61]
    v_pk_add_f32 v[110:111], v[110:111], v[62:63]
    v_cvt_pk_bf16_f32 v202, v108, v109
    v_cvt_pk_bf16_f32 v203, v110, v111
    buffer_store_dwordx4 v[200:203], v8, s[20:23], s3 offen offset:0
    s_waitcnt lgkmcnt(3)
    v_pk_add_f32 v[112:113], v[112:113], v[64:65]
    v_pk_add_f32 v[114:115], v[114:115], v[66:67]
    v_pk_add_f32 v[112:113], v[112:113], v[68:69]
    v_pk_add_f32 v[114:115], v[114:115], v[70:71]
    v_pk_add_f32 v[112:113], v[112:113], v[72:73]
    v_pk_add_f32 v[114:115], v[114:115], v[74:75]
    v_cvt_pk_bf16_f32 v204, v112, v113
    v_cvt_pk_bf16_f32 v205, v114, v115
    s_waitcnt lgkmcnt(0)
    v_pk_add_f32 v[116:117], v[116:117], v[76:77]
    v_pk_add_f32 v[118:119], v[118:119], v[78:79]
    v_pk_add_f32 v[116:117], v[116:117], v[80:81]
    v_pk_add_f32 v[118:119], v[118:119], v[82:83]
    v_pk_add_f32 v[116:117], v[116:117], v[84:85]
    v_pk_add_f32 v[118:119], v[118:119], v[86:87]
    v_cvt_pk_bf16_f32 v206, v116, v117
    v_cvt_pk_bf16_f32 v207, v118, v119
    buffer_store_dwordx4 v[204:207], v8, s[20:23], s3 offen offset:64
    s_endpgm
K_att:
    v_lshrrev_b32 v16, 3, v2
    v_mul_u32_u24 v16, 1280, v16
    v_and_b32 v17, 7, v2
    v_lshrrev_b32 v18, 4, v2
    v_xor_b32 v17, v17, v18
    v_lshl_add_u32 v24, v17, 4, v16
    v_xor_b32 v25, 64, v24
    s_lshl_b32 s68, s36, 3
    s_add_u32 s68, s68, s32
    s_mul_i32 s68, s68, 20480
    v_add_u32 v11, s68, v24
    s_add_u32 s68, s68, 9216
    v_add_u32 v12, s68, v25
    s_lshl_b32 s66, s32, 12
    s_lshl_b32 s65, s32, 11
    s_add_u32 s65, s65, 76800
    s_mov_b32 s20, s6
    s_and_b32 s21, s7, 0xffff
    s_mov_b32 s22, 0x258000
    s_mov_b32 s23, 0x00020000
    s_add_u32 m0, s65, 0
    s_add_u32 s69, s50, 0
    buffer_load_dwordx4 v11, s[16:19], s69 offen offset:0 lds
    buffer_load_dwordx4 v12, s[16:19], s69 offen offset:1024 lds
    s_add_u32 m0, s65, 8192
    s_add_u32 s69, s50, 81920
    buffer_load_dwordx4 v11, s[16:19], s69 offen offset:0 lds
    buffer_load_dwordx4 v12, s[16:19], s69 offen offset:1024 lds
    s_lshl_b32 s68, s32, 8
    s_add_u32 s68, s68, 0
    v_add_u32 v16, s68, v2
    v_mul_u32_u24 v17, 2185, v16
    v_lshrrev_b32 v17, 16, v17
    v_mul_u32_u24 v18, 30, v17
    v_sub_u32 v18, v16, v18
    v_mul_u32_u24 v19, 205, v18
    v_lshrrev_b32 v19, 11, v19
    v_mul_u32_u24 v19, 1120, v19
    v_lshl_add_u32 v19, v18, 4, v19
    v_bfe_u32 v20, v17, 2, 2
    v_lshlrev_b32 v20, 3, v20
    v_bfe_u32 v18, v17, 4, 1
    v_lshl_add_u32 v20, v18, 2, v20
    v_and_b32 v18, 3, v17
    v_add_u32 v20, v20, v18
    v_mul_u32_u24 v20, 3840, v20
    s_mul_i32 s68, s37, 160
    s_sub_u32 s68, s68, 0
    v_add3_u32 v3, v20, v19, s68
    s_lshl_b32 s68, s32, 8
    s_add_u32 s68, s68, 64
    v_add_u32 v16, s68, v2
    v_mul_u32_u24 v17, 2185, v16
    v_lshrrev_b32 v17, 16, v17
    v_mul_u32_u24 v18, 30, v17
    v_sub_u32 v18, v16, v18
    v_mul_u32_u24 v19, 205, v18
    v_lshrrev_b32 v19, 11, v19
    v_mul_u32_u24 v19, 1120, v19
    v_lshl_add_u32 v19, v18, 4, v19
    v_bfe_u32 v20, v17, 2, 2
    v_lshlrev_b32 v20, 3, v20
    v_bfe_u32 v18, v17, 4, 1
    v_lshl_add_u32 v20, v18, 2, v20
    v_and_b32 v18, 3, v17
    v_add_u32 v20, v20, v18
    v_mul_u32_u24 v20, 3840, v20
    s_mul_i32 s68, s37, 160
    s_sub_u32 s68, s68, 1024
    v_add3_u32 v4, v20, v19, s68
    s_lshl_b32 s68, s32, 8
    s_add_u32 s68, s68, 128
    v_add_u32 v16, s68, v2
    v_mul_u32_u24 v17, 2185, v16
    v_lshrrev_b32 v17, 16, v17
    v_mul_u32_u24 v18, 30, v17
    v_sub_u32 v18, v16, v18
    v_mul_u32_u24 v19, 205, v18
    v_lshrrev_b32 v19, 11, v19
    v_mul_u32_u24 v19, 1120, v19
    v_lshl_add_u32 v19, v18, 4, v19
    v_bfe_u32 v20, v17, 2, 2
    v_lshlrev_b32 v20, 3, v20
    v_bfe_u32 v18, v17, 4, 1
    v_lshl_add_u32 v20, v18, 2, v20
    v_and_b32 v18, 3, v17
    v_add_u32 v20, v20, v18
    v_mul_u32_u24 v20, 3840, v20
    s_mul_i32 s68, s37, 160
    s_sub_u32 s68, s68, 2048
    v_add3_u32 v5, v20, v19, s68
    s_lshl_b32 s68, s32, 8
    s_add_u32 s68, s68, 192
    v_add_u32 v16, s68, v2
    v_mul_u32_u24 v17, 2185, v16
    v_lshrrev_b32 v17, 16, v17
    v_mul_u32_u24 v18, 30, v17
    v_sub_u32 v18, v16, v18
    v_mul_u32_u24 v19, 205, v18
    v_lshrrev_b32 v19, 11, v19
    v_mul_u32_u24 v19, 1120, v19
    v_lshl_add_u32 v19, v18, 4, v19
    v_bfe_u32 v20, v17, 2, 2
    v_lshlrev_b32 v20, 3, v20
    v_bfe_u32 v18, v17, 4, 1
    v_lshl_add_u32 v20, v18, 2, v20
    v_and_b32 v18, 3, v17
    v_add_u32 v20, v20, v18
    v_mul_u32_u24 v20, 3840, v20
    s_mul_i32 s68, s37, 160
    s_sub_u32 s68, s68, 0
    v_add3_u32 v6, v20, v19, s68
    s_mul_i32 s68, s36, 163840
    s_sub_u32 s68, s68, 20480
    s_cmp_eq_u32 s36, 0
    s_cselect_b32 s68, 0x7ff00000, s68
    v_add_u32 v24, s68, v24
    s_add_u32 s68, s68, 10240
    v_add_u32 v25, s68, v25
    s_cmp_eq_u32 s32, 3
    s_cselect_b32 s72, s16, s20
    s_cselect_b32 s73, s17, s21
    s_cselect_b32 s74, s18, s22
    s_mov_b32 s75, 0x00020000
    s_cselect_b64 vcc, -1, 0
    v_cndmask_b32 v13, v6, v25, vcc
    v_cndmask_b32 v6, v6, v24, vcc
    s_add_u32 m0, s66, 0
    s_add_u32 s68, s40, 0
    buffer_load_dwordx4 v3, s[20:23], s68 offen offset:0 lds
    buffer_load_dwordx4 v4, s[20:23], s68 offen offset:1024 lds
    buffer_load_dwordx4 v5, s[20:23], s68 offen offset:2048 lds
    s_add_u32 s69, m0, 3072
    s_cmp_eq_u32 s32, 3
    s_cselect_b32 m0, 93184, s69
    s_cmp_eq_u32 s32, 3
    s_cselect_b32 s68, s50, s68
    buffer_load_dwordx4 v6, s[72:75], s68 offen lds
    s_add_u32 m0, s66, 15360
    s_add_u32 s68, s40, 122880
    buffer_load_dwordx4 v3, s[20:23], s68 offen offset:0 lds
    buffer_load_dwordx4 v4, s[20:23], s68 offen offset:1024 lds
    buffer_load_dwordx4 v5, s[20:23], s68 offen offset:2048 lds
    s_add_u32 s69, m0, 3072
    s_cmp_eq_u32 s32, 3
    s_cselect_b32 m0, 94208, s69
    s_cmp_eq_u32 s32, 3
    s_cselect_b32 s68, s50, s68
    buffer_load_dwordx4 v13, s[72:75], s68 offen lds
    s_add_u32 m0, s65, 18432
    s_add_u32 s69, s51, 0
    buffer_load_dwordx4 v11, s[16:19], s69 offen offset:0 lds
    buffer_load_dwordx4 v12, s[16:19], s69 offen offset:1024 lds
    s_add_u32 m0, s66, 30720
    s_add_u32 s68, s41, 0
    buffer_load_dwordx4 v3, s[20:23], s68 offen offset:0 lds
    buffer_load_dwordx4 v4, s[20:23], s68 offen offset:1024 lds
    buffer_load_dwordx4 v5, s[20:23], s68 offen offset:2048 lds
    s_add_u32 s69, m0, 3072
    s_cmp_eq_u32 s32, 3
    s_cselect_b32 m0, 111616, s69
    s_cmp_eq_u32 s32, 3
    s_cselect_b32 s68, s51, s68
    buffer_load_dwordx4 v6, s[72:75], s68 offen lds
    v_lshrrev_b32 v16, 2, v2
    v_mul_u32_u24 v16, 480, v16
    v_and_b32 v17, 3, v2
    v_lshl_add_u32 v16, v17, 3, v16
    s_lshl_b32 s60, s32, 7
    v_add_u32 v7, s60, v16
    v_add_u32 v8, 46080, v7
    v_bfe_u32 v16, v2, 1, 3
    v_lshrrev_b32 v17, 4, v2
    v_xor_b32 v16, v16, v17
    v_lshlrev_b32 v16, 4, v16
    v_and_b32 v17, 15, v2
    v_lshl_add_u32 v16, v17, 7, v16
    v_add_u32 v9, 76800, v16
    v_xor_b32 v10, 64, v9
    v_lshlrev_b32 v15, 3, v17
    s_xor_b32 s71, s32, 0
    s_sub_u32 s4, s2, 128
    s_mul_i32 s4, s4, 3
    s_mul_i32 s5, s71, 1
    s_add_u32 s4, s4, s5
    s_cmp_lt_u32 s71, 3
    s_cselect_b32 s4, s4, 500
    s_lshr_b32 s5, s4, 2
    s_sub_u32 s6, s5, 20
    s_cmp_lt_u32 s5, 20
    s_cselect_b32 s6, s5, s6
    s_cselect_b32 s8, s14, s96
    s_cselect_b32 s9, s15, s97
    s_cselect_b32 s10, 0, 0x118000
    s_cselect_b32 s13, 2, 1
    s_cselect_b32 s14, 1, 4
    s_add_u32 s10, s10, 819200
    s_and_b32 s9, s9, 0xffff
    s_mov_b32 s11, 0x00020000
    s_mul_i32 s6, s6, 40960
    s_and_b32 s7, s4, 3
    s_mul_i32 s12, s7, s13
    s_mul_i32 s12, s12, 5120
    s_add_u32 s6, s6, s12
    s_mul_i32 s14, s14, 5120
    s_add_u32 s14, s14, s6
    s_mul_i32 s5, s5, 40960
    s_lshl_b32 s7, s7, 8
    s_add_u32 s5, s5, s7
    s_add_u32 s5, s5, 16777216
    s_cmp_lt_u32 s4, 272
    s_cselect_b32 s4, s5, 0x7ff00000
    s_mul_i32 s7, s71, 10240
    s_add_u32 s7, s7, 132096
    s_cmp_lt_u32 s71, 3
    s_cselect_b32 s7, s7, 0x30000
    s_mov_b32 s15, 348160
    s_lshl_b32 s61, s36, 1
    s_lshr_b32 s69, s32, 1
    s_add_u32 s61, s61, s69
    s_mul_i32 s61, s61, 278528
    s_and_b32 s69, s32, 1
    s_lshl_b32 s69, s69, 11
    s_add_u32 s61, s61, s69
    s_mov_b32 s39, 0x3ea52b5c
    s_mul_i32 s62, s32, 15872
    s_mul_i32 s63, s32, 5120
    s_add_u32 s63, s63, 73728
    s_mul_i32 s64, s37, 10
    s_mov_b32 s94, 0xfffefffe
    s_mov_b32 s95, 0xfffefffe
    s_lshr_b32 s0, s76, 3
    s_mul_i32 s0, s0, 20
    s_lshl_b32 s68, s34, 3
    s_lshr_b32 s68, 0x0e080400, s68
    s_and_b32 s68, s68, 255
    s_add_u32 s0, s0, s68
    s_lshl_b32 s70, s36, 1
    s_bfe_u32 s71, s76, 0x10002
    s_add_u32 s70, s70, s71
    s_lshl_b32 s69, s0, 10
    s_add_u32 s69, s69, 16777216
    s_mul_i32 s68, s32, 204800
    s_add_u32 s93, s69, s68
    s_mul_i32 s68, s32, 491520
    s_add_u32 s92, s69, s68
    s_mul_i32 s69, s70, 278528
    s_mul_i32 s68, s32, 20480
    s_add_u32 s78, s69, s68
    s_mul_i32 s68, s32, 49152
    s_add_u32 s77, s69, s68
    s_mul_i32 s3, s70, 81920
    s_lshl_b32 s69, s0, 5
    s_add_u32 s3, s3, s69
    s_mul_i32 s69, s32, 20480
    s_add_u32 s3, s3, s69
    s_lshr_b32 s35, s70, 1
    s_lshl_b32 s35, s35, 14
    s_and_b32 s71, s70, 1
    s_lshl_b32 s71, s71, 5
    s_add_u32 s35, s35, s71
    s_lshl_b32 s71, s32, 7
    s_add_u32 s71, s71, 29361152
    s_add_u32 s35, s35, s71
    s_lshl_b32 s79, s36, 14
    s_add_u32 s79, s79, 29360128
    s_lshr_b32 s69, s76, 2
    s_lshl_b32 s69, s69, 7
    s_add_u32 s68, s79, s69
    s_lshl_b32 s34, s34, 3
    s_add_u32 s34, s34, s68
    s_add_u32 s34, s34, 1024
    s_lshr_b32 s68, s32, 1
    s_and_b32 s69, s32, 1
    s_lshl_b32 s68, s68, 5
    s_lshl_b32 s69, s69, 2
    s_add_u32 s34, s34, s68
    s_add_u32 s34, s34, s69
    s_sub_u32 s38, s79, 15488
    s_cmp_eq_u32 s36, 0
    s_cselect_b32 s38, s79, s38
    v_mov_b32 v176, 0x3f803f80
    v_mov_b32 v176, 0x3f803f80
    v_accvgpr_write_b32 a220, v176
    v_mov_b32 v177, 0x3f803f80
    v_accvgpr_write_b32 a221, v176
    v_mov_b32 v178, 0x3f803f80
    v_accvgpr_write_b32 a222, v176
    v_mov_b32 v179, 0x3f803f80
    v_accvgpr_write_b32 a223, v176
    s_mov_b32 s33, 0x3f803f80
    v_mov_b32 v252, 0
    v_lshrrev_b32 v254, 5, v0
    s_lshl_b32 s68, s76, 3
    v_add_lshl_u32 v254, v254, s68, 3
    v_and_b32 v253, 31, v2
    v_cmp_eq_u32 vcc, 31, v253
    v_mov_b32 v253, 0x7ff00000
    s_nop 0
    v_cndmask_b32 v254, v253, v254, vcc
    v_mov_b32 v253, 0
    s_waitcnt vmcnt(18)
    s_buffer_load_dword s1, s[24:27], 0
    v_dot2c_f32_bf16 v252, s33, v112
    v_dot2c_f32_bf16 v253, v112, v112
    v_dot2c_f32_bf16 v252, s33, v113
    v_dot2c_f32_bf16 v253, v113, v113
    v_dot2c_f32_bf16 v252, s33, v114
    v_dot2c_f32_bf16 v253, v114, v114
    v_dot2c_f32_bf16 v252, s33, v115
    v_dot2c_f32_bf16 v253, v115, v115
    v_dot2c_f32_bf16 v252, s33, v116
    v_dot2c_f32_bf16 v253, v116, v116
    v_dot2c_f32_bf16 v252, s33, v117
    v_dot2c_f32_bf16 v253, v117, v117
    v_dot2c_f32_bf16 v252, s33, v118
    v_dot2c_f32_bf16 v253, v118, v118
    v_dot2c_f32_bf16 v252, s33, v119
    v_dot2c_f32_bf16 v253, v119, v119
    v_dot2c_f32_bf16 v252, s33, v120
    v_dot2c_f32_bf16 v253, v120, v120
    v_dot2c_f32_bf16 v252, s33, v121
    v_dot2c_f32_bf16 v253, v121, v121
    v_dot2c_f32_bf16 v252, s33, v122
    v_dot2c_f32_bf16 v253, v122, v122
    v_dot2c_f32_bf16 v252, s33, v123
    v_dot2c_f32_bf16 v253, v123, v123
    s_nop 0
    s_nop 1
    v_add_f32_dpp v252, v252, v252 quad_perm:[1,0,3,2] row_mask:0xf bank_mask:0xf
    v_add_f32_dpp v253, v253, v253 quad_perm:[1,0,3,2] row_mask:0xf bank_mask:0xf
    s_nop 1
    v_add_f32_dpp v252, v252, v252 quad_perm:[2,3,0,1] row_mask:0xf bank_mask:0xf
    v_add_f32_dpp v253, v253, v253 quad_perm:[2,3,0,1] row_mask:0xf bank_mask:0xf
    s_nop 1
    v_add_f32_dpp v252, v252, v252 row_half_mirror row_mask:0xf bank_mask:0xf
    v_add_f32_dpp v253, v253, v253 row_half_mirror row_mask:0xf bank_mask:0xf
    s_nop 1
    v_add_f32_dpp v252, v252, v252 row_mirror row_mask:0xf bank_mask:0xf
    v_add_f32_dpp v253, v253, v253 row_mirror row_mask:0xf bank_mask:0xf
    s_nop 1
    v_add_f32_dpp v252, v252, v252 row_bcast:15 row_mask:0xa bank_mask:0xf
    v_add_f32_dpp v253, v253, v253 row_bcast:15 row_mask:0xa bank_mask:0xf
    v_mul_f32 v252, 0xbacccccd, v252
    v_mul_f32 v253, 0x3acccccd, v253
    v_fma_f32 v253, -v252, v252, v253
    v_max_f32 v253, 0, v253
    v_cvt_pk_bf16_f32 v253, v253, v253
    v_lshlrev_b32 v253, 16, v253
    v_add_f32 v253, 0x3727c5ac, v253
    v_cvt_pk_bf16_f32 v253, v253, v253
    v_lshlrev_b32 v253, 16, v253
    v_sqrt_f32 v253, v253
    s_waitcnt lgkmcnt(0)
    v_cvt_pk_bf16_f32 v252, v252, v253
    s_cmp_eq_u32 s1, 0
    s_cbranch_scc1 NON_att_spin
NON_att_ok:
    v_mov_b32 v253, s1
    v_add_u32 v255, s1, v2
    buffer_store_dwordx2 v[252:253], v254, s[28:31], s79 offen sc1
    s_cmp_eq_u32 s32, 3
    s_cselect_b32 s68, 0x30000, 0
    v_add_u32 v252, s68, v7
    v_add_u32 v253, s68, v8
    s_add_u32 m0, s65, 26624
    s_add_u32 s69, s51, 81920
    buffer_load_dwordx4 v11, s[16:19], s69 offen offset:0 lds
    buffer_load_dwordx4 v12, s[16:19], s69 offen offset:1024 lds
    s_add_u32 m0, s66, 46080
    s_add_u32 s68, s41, 122880
    buffer_load_dwordx4 v3, s[20:23], s68 offen offset:0 lds
    buffer_load_dwordx4 v4, s[20:23], s68 offen offset:1024 lds
    buffer_load_dwordx4 v5, s[20:23], s68 offen offset:2048 lds
    s_add_u32 s69, m0, 3072
    s_cmp_eq_u32 s32, 3
    s_cselect_b32 m0, 112640, s69
    s_cmp_eq_u32 s32, 3
    s_cselect_b32 s68, s51, s68
    buffer_load_dwordx4 v13, s[72:75], s68 offen lds
    s_waitcnt vmcnt(13)
    s_barrier
    ds_read_b64_tr_b16 v[160:161], v7 offset:0
    ds_read_b64_tr_b16 v[162:163], v7 offset:7680
    s_mov_b64 exec, s[94:95]
    ds_read_b128 v[176:179], v9 offset:16384
    s_mov_b64 exec, -1
    ds_read_b128 v[180:183], v9 offset:0
    ds_read_b128 v[184:187], v9 offset:2048
    ds_read_b128 v[188:191], v9 offset:4096
    ds_read_b128 v[192:195], v9 offset:6144
    ds_read_b128 v[196:199], v9 offset:8192
    ds_read_b128 v[200:203], v9 offset:10240
    ds_read_b128 v[204:207], v9 offset:12288
    ds_read_b128 v[208:211], v9 offset:14336
    ds_read_b64_tr_b16 v[164:165], v7 offset:32
    ds_read_b64_tr_b16 v[166:167], v7 offset:7712
    ds_read_b64_tr_b16 v[168:169], v7 offset:64
    ds_read_b64_tr_b16 v[170:171], v7 offset:7744
    ds_read_b64_tr_b16 v[172:173], v252 offset:96
    ds_read_b64_tr_b16 v[174:175], v252 offset:7776
    s_waitcnt lgkmcnt(0)
    v_mfma_f32_16x16x32_bf16 v[16:19], v[160:163], v[176:179], 0
    s_barrier
    v_mfma_f32_16x16x32_bf16 v[20:23], v[160:163], v[180:183], 0
    ds_read_b64_tr_b16 a[204:205], v7 offset:15360
    s_add_u32 m0, s65, 36864
    v_mfma_f32_16x16x32_bf16 v[24:27], v[160:163], v[184:187], 0
    ds_read_b64_tr_b16 a[206:207], v7 offset:23040
    s_add_u32 s69, s52, 0
    v_mfma_f32_16x16x32_bf16 v[28:31], v[160:163], v[188:191], 0
    buffer_load_dwordx4 v11, s[16:19], s69 offen offset:0 lds
    v_mfma_f32_16x16x32_bf16 v[32:35], v[160:163], v[192:195], 0
    s_mov_b64 exec, s[94:95]
    ds_read_b128 a[220:223], v10 offset:16384
    s_mov_b64 exec, -1
    v_mfma_f32_16x16x32_bf16 v[36:39], v[160:163], v[196:199], 0
    ds_read_b128 a[224:227], v10 offset:0
    v_mfma_f32_16x16x32_bf16 v[40:43], v[160:163], v[200:203], 0
    buffer_load_dwordx4 v12, s[16:19], s69 offen offset:1024 lds
    v_mfma_f32_16x16x32_bf16 v[44:47], v[160:163], v[204:207], 0
    ds_read_b128 a[228:231], v10 offset:2048
    s_add_u32 m0, s66, 61440
    v_mfma_f32_16x16x32_bf16 v[48:51], v[160:163], v[208:211], 0
    ds_read_b128 a[232:235], v10 offset:4096
    s_add_u32 s68, s42, 0
    v_mfma_f32_16x16x32_bf16 v[84:87], v[164:167], v[208:211], 0
    buffer_load_dwordx4 v3, s[20:23], s68 offen offset:0 lds
    v_mfma_f32_16x16x32_bf16 v[80:83], v[164:167], v[204:207], 0
    ds_read_b128 a[236:239], v10 offset:6144
    v_mfma_f32_16x16x32_bf16 v[76:79], v[164:167], v[200:203], 0
    ds_read_b128 a[240:243], v10 offset:8192
    v_mfma_f32_16x16x32_bf16 v[72:75], v[164:167], v[196:199], 0
    buffer_load_dwordx4 v4, s[20:23], s68 offen offset:1024 lds
    v_mfma_f32_16x16x32_bf16 v[68:71], v[164:167], v[192:195], 0
    ds_read_b128 a[244:247], v10 offset:10240
    v_mfma_f32_16x16x32_bf16 v[64:67], v[164:167], v[188:191], 0
    ds_read_b128 a[248:251], v10 offset:12288
    v_mfma_f32_16x16x32_bf16 v[60:63], v[164:167], v[184:187], 0
    buffer_load_dwordx4 v5, s[20:23], s68 offen offset:2048 lds
    v_mfma_f32_16x16x32_bf16 v[56:59], v[164:167], v[180:183], 0
    ds_read_b128 a[252:255], v10 offset:14336
    s_add_u32 s69, m0, 3072
    v_mfma_f32_16x16x32_bf16 v[52:55], v[164:167], v[176:179], 0
    ds_read_b64_tr_b16 a[208:209], v7 offset:15392
    v_mfma_f32_16x16x32_bf16 v[88:91], v[168:171], v[176:179], 0
    s_cmp_eq_u32 s32, 3
    s_cselect_b32 m0, 130048, s69
    v_mfma_f32_16x16x32_bf16 v[92:95], v[168:171], v[180:183], 0
    ds_read_b64_tr_b16 a[210:211], v7 offset:23072
    v_mfma_f32_16x16x32_bf16 v[96:99], v[168:171], v[184:187], 0
    ds_read_b64_tr_b16 a[212:213], v7 offset:15424
    v_mfma_f32_16x16x32_bf16 v[100:103], v[168:171], v[188:191], 0
    s_cmp_eq_u32 s32, 3
    s_cselect_b32 s68, s52, s68
    v_mfma_f32_16x16x32_bf16 v[104:107], v[168:171], v[192:195], 0
    ds_read_b64_tr_b16 a[214:215], v7 offset:23104
    v_mfma_f32_16x16x32_bf16 v[108:111], v[168:171], v[196:199], 0
    ds_read_b64_tr_b16 a[216:217], v252 offset:15456
    v_mfma_f32_16x16x32_bf16 v[112:115], v[168:171], v[200:203], 0
    buffer_load_dwordx4 v6, s[72:75], s68 offen lds
    v_mfma_f32_16x16x32_bf16 v[116:119], v[168:171], v[204:207], 0
    ds_read_b64_tr_b16 a[218:219], v252 offset:23136
    s_add_u32 m0, s65, 45056
    v_mfma_f32_16x16x32_bf16 v[120:123], v[168:171], v[208:211], 0
    s_add_u32 s69, s52, 81920
    v_mfma_f32_16x16x32_bf16 v[156:159], v[172:175], v[208:211], 0
    buffer_load_dwordx4 v11, s[16:19], s69 offen offset:0 lds
    v_mfma_f32_16x16x32_bf16 v[152:155], v[172:175], v[204:207], 0
    v_mfma_f32_16x16x32_bf16 v[148:151], v[172:175], v[200:203], 0
    buffer_load_dwordx4 v12, s[16:19], s69 offen offset:1024 lds
    v_mfma_f32_16x16x32_bf16 v[144:147], v[172:175], v[196:199], 0
    s_add_u32 m0, s66, 0
    s_add_u32 s68, s42, 122880
    v_mfma_f32_16x16x32_bf16 v[140:143], v[172:175], v[192:195], 0
    buffer_load_dwordx4 v3, s[20:23], s68 offen offset:0 lds
    v_mfma_f32_16x16x32_bf16 v[136:139], v[172:175], v[188:191], 0
    v_mfma_f32_16x16x32_bf16 v[132:135], v[172:175], v[184:187], 0
    buffer_load_dwordx4 v4, s[20:23], s68 offen offset:1024 lds
    v_mfma_f32_16x16x32_bf16 v[128:131], v[172:175], v[180:183], 0
    v_mfma_f32_16x16x32_bf16 v[124:127], v[172:175], v[176:179], 0
    buffer_load_dwordx4 v5, s[20:23], s68 offen offset:2048 lds
    s_add_u32 s69, m0, 3072
    s_cmp_eq_u32 s32, 3
    s_cselect_b32 m0, 131072, s69
    s_cmp_eq_u32 s32, 3
    s_cselect_b32 s68, s52, s68
    buffer_load_dwordx4 v13, s[72:75], s68 offen lds
    s_add_u32 m0, s7, 0
    s_add_u32 s12, s6, 0
    buffer_load_dwordx4 v14, s[8:11], s12 offen offset:0 nt lds
    buffer_load_dwordx4 v14, s[8:11], s12 offen offset:1024 nt lds
    buffer_load_dwordx4 v14, s[8:11], s12 offen offset:2048 nt lds
    buffer_load_dwordx4 v14, s[8:11], s12 offen offset:3072 nt lds
    s_add_u32 m0, s7, 4096
    s_add_u32 s12, s6, 4096
    buffer_load_dwordx4 v14, s[8:11], s12 offen offset:0 nt lds
    s_add_u32 m0, s7, 5120
    s_add_u32 s12, s14, 0
    buffer_load_dwordx4 v14, s[8:11], s12 offen offset:0 nt lds
    buffer_load_dwordx4 v14, s[8:11], s12 offen offset:1024 nt lds
    buffer_load_dwordx4 v14, s[8:11], s12 offen offset:2048 nt lds
    buffer_load_dwordx4 v14, s[8:11], s12 offen offset:3072 nt lds
    s_add_u32 m0, s7, 9216
    s_add_u32 s12, s14, 4096
    buffer_load_dwordx4 v14, s[8:11], s12 offen offset:0 nt lds
    s_waitcnt lgkmcnt(0)
    v_mfma_f32_16x16x32_bf16 v[16:19], a[204:207], a[220:223], v[16:19]
    s_waitcnt vmcnt(22)
    s_barrier
    v_mfma_f32_16x16x32_bf16 v[20:23], a[204:207], a[224:227], v[20:23]
    ds_read_b64_tr_b16 v[160:161], v7 offset:30720
    s_add_u32 m0, s65, 0
    v_mfma_f32_16x16x32_bf16 v[24:27], a[204:207], a[228:231], v[24:27]
    ds_read_b64_tr_b16 v[162:163], v7 offset:38400
    s_add_u32 s69, s53, 0
    v_mfma_f32_16x16x32_bf16 v[28:31], a[204:207], a[232:235], v[28:31]
    v_mfma_f32_16x16x32_bf16 v[32:35], a[204:207], a[236:239], v[32:35]
    s_mov_b64 exec, s[94:95]
    ds_read_b128 v[176:179], v9 offset:34816
    s_mov_b64 exec, -1
    v_mfma_f32_16x16x32_bf16 v[36:39], a[204:207], a[240:243], v[36:39]
    ds_read_b128 v[180:183], v9 offset:18432
    v_mfma_f32_16x16x32_bf16 v[40:43], a[204:207], a[244:247], v[40:43]
    buffer_load_dwordx4 v11, s[16:19], s69 offen offset:0 lds
    v_mfma_f32_16x16x32_bf16 v[44:47], a[204:207], a[248:251], v[44:47]
    ds_read_b128 v[184:187], v9 offset:20480
    v_mfma_f32_16x16x32_bf16 v[48:51], a[204:207], a[252:255], v[48:51]
    ds_read_b128 v[188:191], v9 offset:22528
    v_mfma_f32_16x16x32_bf16 v[84:87], a[208:211], a[252:255], v[84:87]
    v_mfma_f32_16x16x32_bf16 v[80:83], a[208:211], a[248:251], v[80:83]
    ds_read_b128 v[192:195], v9 offset:24576
    v_mfma_f32_16x16x32_bf16 v[76:79], a[208:211], a[244:247], v[76:79]
    ds_read_b128 v[196:199], v9 offset:26624
    v_mfma_f32_16x16x32_bf16 v[72:75], a[208:211], a[240:243], v[72:75]
    buffer_load_dwordx4 v12, s[16:19], s69 offen offset:1024 lds
    v_mfma_f32_16x16x32_bf16 v[68:71], a[208:211], a[236:239], v[68:71]
    ds_read_b128 v[200:203], v9 offset:28672
    s_add_u32 m0, s66, 15360
    v_mfma_f32_16x16x32_bf16 v[64:67], a[208:211], a[232:235], v[64:67]
    ds_read_b128 v[204:207], v9 offset:30720
    s_add_u32 s68, s43, 0
    v_mfma_f32_16x16x32_bf16 v[60:63], a[208:211], a[228:231], v[60:63]
    v_mfma_f32_16x16x32_bf16 v[56:59], a[208:211], a[224:227], v[56:59]
    ds_read_b128 v[208:211], v9 offset:32768
    v_mfma_f32_16x16x32_bf16 v[52:55], a[208:211], a[220:223], v[52:55]
    ds_read_b64_tr_b16 v[164:165], v7 offset:30752
    v_mfma_f32_16x16x32_bf16 v[88:91], a[212:215], a[220:223], v[88:91]
    buffer_load_dwordx4 v3, s[20:23], s68 offen offset:0 lds
    v_mfma_f32_16x16x32_bf16 v[92:95], a[212:215], a[224:227], v[92:95]
    ds_read_b64_tr_b16 v[166:167], v7 offset:38432
    v_mfma_f32_16x16x32_bf16 v[96:99], a[212:215], a[228:231], v[96:99]
    ds_read_b64_tr_b16 v[168:169], v7 offset:30784
    v_mfma_f32_16x16x32_bf16 v[100:103], a[212:215], a[232:235], v[100:103]
    v_mfma_f32_16x16x32_bf16 v[104:107], a[212:215], a[236:239], v[104:107]
    ds_read_b64_tr_b16 v[170:171], v7 offset:38464
    v_mfma_f32_16x16x32_bf16 v[108:111], a[212:215], a[240:243], v[108:111]
    ds_read_b64_tr_b16 v[172:173], v252 offset:30816
    v_mfma_f32_16x16x32_bf16 v[112:115], a[212:215], a[244:247], v[112:115]
    buffer_load_dwordx4 v4, s[20:23], s68 offen offset:1024 lds
    v_mfma_f32_16x16x32_bf16 v[116:119], a[212:215], a[248:251], v[116:119]
    ds_read_b64_tr_b16 v[174:175], v252 offset:38496
    v_mfma_f32_16x16x32_bf16 v[120:123], a[212:215], a[252:255], v[120:123]
    v_mfma_f32_16x16x32_bf16 v[156:159], a[216:219], a[252:255], v[156:159]
    v_mfma_f32_16x16x32_bf16 v[152:155], a[216:219], a[248:251], v[152:155]
    v_mfma_f32_16x16x32_bf16 v[148:151], a[216:219], a[244:247], v[148:151]
    buffer_load_dwordx4 v5, s[20:23], s68 offen offset:2048 lds
    v_mfma_f32_16x16x32_bf16 v[144:147], a[216:219], a[240:243], v[144:147]
    s_add_u32 s69, m0, 3072
    v_mfma_f32_16x16x32_bf16 v[140:143], a[216:219], a[236:239], v[140:143]
    s_cmp_eq_u32 s32, 3
    s_cselect_b32 m0, 93184, s69
    v_mfma_f32_16x16x32_bf16 v[136:139], a[216:219], a[232:235], v[136:139]
    s_cmp_eq_u32 s32, 3
    s_cselect_b32 s68, s53, s68
    v_mfma_f32_16x16x32_bf16 v[132:135], a[216:219], a[228:231], v[132:135]
    v_mfma_f32_16x16x32_bf16 v[128:131], a[216:219], a[224:227], v[128:131]
    buffer_load_dwordx4 v6, s[72:75], s68 offen lds
    v_mfma_f32_16x16x32_bf16 v[124:127], a[216:219], a[220:223], v[124:127]
    s_waitcnt lgkmcnt(0)
    v_mfma_f32_16x16x32_bf16 v[16:19], v[160:163], v[176:179], v[16:19]
    s_barrier
    v_mfma_f32_16x16x32_bf16 v[20:23], v[160:163], v[180:183], v[20:23]
    ds_read_b64_tr_b16 a[204:205], v8 offset:0
    s_add_u32 m0, s65, 8192
    v_mfma_f32_16x16x32_bf16 v[24:27], v[160:163], v[184:187], v[24:27]
    ds_read_b64_tr_b16 a[206:207], v8 offset:7680
    s_add_u32 s69, s53, 81920
    v_mfma_f32_16x16x32_bf16 v[28:31], v[160:163], v[188:191], v[28:31]
    buffer_load_dwordx4 v11, s[16:19], s69 offen offset:0 lds
    v_mfma_f32_16x16x32_bf16 v[32:35], v[160:163], v[192:195], v[32:35]
    s_mov_b64 exec, s[94:95]
    ds_read_b128 a[220:223], v10 offset:34816
    s_mov_b64 exec, -1
    v_mfma_f32_16x16x32_bf16 v[36:39], v[160:163], v[196:199], v[36:39]
    ds_read_b128 a[224:227], v10 offset:18432
    v_lshrrev_b32 v212, 5, v2
    v_mfma_f32_16x16x32_bf16 v[40:43], v[160:163], v[200:203], v[40:43]
    v_lshlrev_b32 v212, 6, v212
    v_bfe_u32 v214, v2, 4, 1
    v_mfma_f32_16x16x32_bf16 v[44:47], v[160:163], v[204:207], v[44:47]
    ds_read_b128 a[228:231], v10 offset:20480
    v_lshl_add_u32 v212, v214, 3, v212
    v_mfma_f32_16x16x32_bf16 v[48:51], v[160:163], v[208:211], v[48:51]
    ds_read_b128 a[232:235], v10 offset:22528
    v_bfe_u32 v214, v2, 2, 2
    v_mfma_f32_16x16x32_bf16 v[84:87], v[164:167], v[208:211], v[84:87]
    buffer_load_dwordx4 v12, s[16:19], s69 offen offset:1024 lds
    v_mfma_f32_16x16x32_bf16 v[80:83], v[164:167], v[204:207], v[80:83]
    ds_read_b128 a[236:239], v10 offset:24576
    s_add_u32 m0, s66, 30720
    v_mfma_f32_16x16x32_bf16 v[76:79], v[164:167], v[200:203], v[76:79]
    ds_read_b128 a[240:243], v10 offset:26624
    s_add_u32 s68, s43, 122880
    v_mfma_f32_16x16x32_bf16 v[72:75], v[164:167], v[196:199], v[72:75]
    v_mul_u32_u24 v214, 1280, v214
    v_add_u32 v212, v212, v214
    v_mfma_f32_16x16x32_bf16 v[68:71], v[164:167], v[192:195], v[68:71]
    ds_read_b128 a[244:247], v10 offset:28672
    v_and_b32 v214, 3, v2
    v_mfma_f32_16x16x32_bf16 v[64:67], v[164:167], v[188:191], v[64:67]
    ds_read_b128 a[248:251], v10 offset:30720
    v_lshlrev_b32 v214, 4, v214
    v_mfma_f32_16x16x32_bf16 v[60:63], v[164:167], v[184:187], v[60:63]
    buffer_load_dwordx4 v3, s[20:23], s68 offen offset:0 lds
    v_mfma_f32_16x16x32_bf16 v[56:59], v[164:167], v[180:183], v[56:59]
    ds_read_b128 a[252:255], v10 offset:32768
    v_add3_u32 v212, v212, v214, s7
    v_mfma_f32_16x16x32_bf16 v[52:55], v[164:167], v[176:179], v[52:55]
    ds_read_b64_tr_b16 a[208:209], v8 offset:32
    v_lshrrev_b32 v213, 4, v2
    v_mfma_f32_16x16x32_bf16 v[88:91], v[168:171], v[176:179], v[88:91]
    v_lshlrev_b32 v213, 10, v213
    v_and_b32 v214, 0xf0, v14
    v_mfma_f32_16x16x32_bf16 v[92:95], v[168:171], v[180:183], v[92:95]
    ds_read_b64_tr_b16 a[210:211], v8 offset:7712
    v_add_u32 v213, v213, v214
    v_mfma_f32_16x16x32_bf16 v[96:99], v[168:171], v[184:187], v[96:99]
    ds_read_b64_tr_b16 a[212:213], v8 offset:64
    v_mfma_f32_16x16x32_bf16 v[100:103], v[168:171], v[188:191], v[100:103]
    buffer_load_dwordx4 v4, s[20:23], s68 offen offset:1024 lds
    v_mfma_f32_16x16x32_bf16 v[104:107], v[168:171], v[192:195], v[104:107]
    ds_read_b64_tr_b16 a[214:215], v8 offset:7744
    v_mfma_f32_16x16x32_bf16 v[108:111], v[168:171], v[196:199], v[108:111]
    ds_read_b64_tr_b16 a[216:217], v253 offset:96
    v_mfma_f32_16x16x32_bf16 v[112:115], v[168:171], v[200:203], v[112:115]
    v_mfma_f32_16x16x32_bf16 v[116:119], v[168:171], v[204:207], v[116:119]
    ds_read_b64_tr_b16 a[218:219], v253 offset:7776
    v_mfma_f32_16x16x32_bf16 v[120:123], v[168:171], v[208:211], v[120:123]
    buffer_load_dwordx4 v5, s[20:23], s68 offen offset:2048 lds
    v_mfma_f32_16x16x32_bf16 v[156:159], v[172:175], v[208:211], v[156:159]
    s_add_u32 s69, m0, 3072
    v_mfma_f32_16x16x32_bf16 v[152:155], v[172:175], v[204:207], v[152:155]
    s_cmp_eq_u32 s32, 3
    s_cselect_b32 m0, 94208, s69
    v_mfma_f32_16x16x32_bf16 v[148:151], v[172:175], v[200:203], v[148:151]
    s_cmp_eq_u32 s32, 3
    s_cselect_b32 s68, s53, s68
    v_mfma_f32_16x16x32_bf16 v[144:147], v[172:175], v[196:199], v[144:147]
    v_mfma_f32_16x16x32_bf16 v[140:143], v[172:175], v[192:195], v[140:143]
    buffer_load_dwordx4 v13, s[72:75], s68 offen lds
    v_mfma_f32_16x16x32_bf16 v[136:139], v[172:175], v[188:191], v[136:139]
    v_mfma_f32_16x16x32_bf16 v[132:135], v[172:175], v[184:187], v[132:135]
    v_mfma_f32_16x16x32_bf16 v[128:131], v[172:175], v[180:183], v[128:131]
    v_mfma_f32_16x16x32_bf16 v[124:127], v[172:175], v[176:179], v[124:127]
    s_waitcnt lgkmcnt(0)
    v_mfma_f32_16x16x32_bf16 v[16:19], a[204:207], a[220:223], v[16:19]
    s_waitcnt vmcnt(22)
    s_barrier
    v_mfma_f32_16x16x32_bf16 v[20:23], a[204:207], a[224:227], v[20:23]
    ds_read_b64_tr_b16 v[160:161], v8 offset:15360
    s_add_u32 m0, s65, 18432
    v_mfma_f32_16x16x32_bf16 v[24:27], a[204:207], a[228:231], v[24:27]
    ds_read_b64_tr_b16 v[162:163], v8 offset:23040
    s_add_u32 s69, s54, 0
    v_mfma_f32_16x16x32_bf16 v[28:31], a[204:207], a[232:235], v[28:31]
    buffer_load_dwordx4 v11, s[16:19], s69 offen offset:0 lds
    v_mfma_f32_16x16x32_bf16 v[32:35], a[204:207], a[236:239], v[32:35]
    s_mov_b64 exec, s[94:95]
    ds_read_b128 v[176:179], v9 offset:53248
    s_mov_b64 exec, -1
    v_mfma_f32_16x16x32_bf16 v[36:39], a[204:207], a[240:243], v[36:39]
    ds_read_b128 v[180:183], v9 offset:36864
    s_waitcnt vmcnt(13)
    v_mfma_f32_16x16x32_bf16 v[40:43], a[204:207], a[244:247], v[40:43]
    ds_read_b64_tr_b16 v[216:217], v212 offset:0
    v_mfma_f32_16x16x32_bf16 v[44:47], a[204:207], a[248:251], v[44:47]
    ds_read_b128 v[184:187], v9 offset:38912
    v_mfma_f32_16x16x32_bf16 v[48:51], a[204:207], a[252:255], v[48:51]
    ds_read_b128 v[188:191], v9 offset:40960
    v_mfma_f32_16x16x32_bf16 v[84:87], a[208:211], a[252:255], v[84:87]
    buffer_load_dwordx4 v12, s[16:19], s69 offen offset:1024 lds
    v_mfma_f32_16x16x32_bf16 v[80:83], a[208:211], a[248:251], v[80:83]
    ds_read_b128 v[192:195], v9 offset:43008
    s_add_u32 m0, s66, 46080
    v_mfma_f32_16x16x32_bf16 v[76:79], a[208:211], a[244:247], v[76:79]
    ds_read_b128 v[196:199], v9 offset:45056
    s_add_u32 s68, s44, 0
    v_mfma_f32_16x16x32_bf16 v[72:75], a[208:211], a[240:243], v[72:75]
    ds_read_b64_tr_b16 v[218:219], v212 offset:5120
    v_mfma_f32_16x16x32_bf16 v[68:71], a[208:211], a[236:239], v[68:71]
    ds_read_b128 v[200:203], v9 offset:47104
    v_mfma_f32_16x16x32_bf16 v[64:67], a[208:211], a[232:235], v[64:67]
    ds_read_b128 v[204:207], v9 offset:49152
    v_mfma_f32_16x16x32_bf16 v[60:63], a[208:211], a[228:231], v[60:63]
    buffer_load_dwordx4 v3, s[20:23], s68 offen offset:0 lds
    v_mfma_f32_16x16x32_bf16 v[56:59], a[208:211], a[224:227], v[56:59]
    ds_read_b128 v[208:211], v9 offset:51200
    v_mfma_f32_16x16x32_bf16 v[52:55], a[208:211], a[220:223], v[52:55]
    ds_read_b64_tr_b16 v[164:165], v8 offset:15392
    v_mfma_f32_16x16x32_bf16 v[88:91], a[212:215], a[220:223], v[88:91]
    ds_read_b64_tr_b16 v[220:221], v212 offset:128
    v_mfma_f32_16x16x32_bf16 v[92:95], a[212:215], a[224:227], v[92:95]
    ds_read_b64_tr_b16 v[166:167], v8 offset:23072
    v_mfma_f32_16x16x32_bf16 v[96:99], a[212:215], a[228:231], v[96:99]
    ds_read_b64_tr_b16 v[168:169], v8 offset:15424
    v_mfma_f32_16x16x32_bf16 v[100:103], a[212:215], a[232:235], v[100:103]
    buffer_load_dwordx4 v4, s[20:23], s68 offen offset:1024 lds
    v_mfma_f32_16x16x32_bf16 v[104:107], a[212:215], a[236:239], v[104:107]
    ds_read_b64_tr_b16 v[170:171], v8 offset:23104
    v_mfma_f32_16x16x32_bf16 v[108:111], a[212:215], a[240:243], v[108:111]
    ds_read_b64_tr_b16 v[172:173], v253 offset:15456
    v_mfma_f32_16x16x32_bf16 v[112:115], a[212:215], a[244:247], v[112:115]
    ds_read_b64_tr_b16 v[222:223], v212 offset:5248
    v_mfma_f32_16x16x32_bf16 v[116:119], a[212:215], a[248:251], v[116:119]
    ds_read_b64_tr_b16 v[174:175], v253 offset:23136
    v_mfma_f32_16x16x32_bf16 v[120:123], a[212:215], a[252:255], v[120:123]
    buffer_load_dwordx4 v5, s[20:23], s68 offen offset:2048 lds
    v_mfma_f32_16x16x32_bf16 v[156:159], a[216:219], a[252:255], v[156:159]
    s_add_u32 s69, m0, 3072
    v_mfma_f32_16x16x32_bf16 v[152:155], a[216:219], a[248:251], v[152:155]
    s_cmp_eq_u32 s32, 3
    s_cselect_b32 m0, 111616, s69
    v_mfma_f32_16x16x32_bf16 v[148:151], a[216:219], a[244:247], v[148:151]
    s_cmp_eq_u32 s32, 3
    s_cselect_b32 s68, s54, s68
    v_mfma_f32_16x16x32_bf16 v[144:147], a[216:219], a[240:243], v[144:147]
    ds_read_b64_tr_b16 v[224:225], v212 offset:256
    v_mfma_f32_16x16x32_bf16 v[140:143], a[216:219], a[236:239], v[140:143]
    buffer_load_dwordx4 v6, s[72:75], s68 offen lds
    v_mfma_f32_16x16x32_bf16 v[136:139], a[216:219], a[232:235], v[136:139]
    ds_read_b64_tr_b16 v[226:227], v212 offset:5376
    v_mfma_f32_16x16x32_bf16 v[132:135], a[216:219], a[228:231], v[132:135]
    ds_read_b64_tr_b16 v[228:229], v212 offset:384
    v_mfma_f32_16x16x32_bf16 v[128:131], a[216:219], a[224:227], v[128:131]
    ds_read_b64_tr_b16 v[230:231], v212 offset:5504
    v_mfma_f32_16x16x32_bf16 v[124:127], a[216:219], a[220:223], v[124:127]
    ds_read_b64_tr_b16 v[232:233], v212 offset:512
    ds_read_b64_tr_b16 v[234:235], v212 offset:5632
    s_waitcnt lgkmcnt(0)
    v_mfma_f32_16x16x32_bf16 v[16:19], v[160:163], v[176:179], v[16:19]
    s_barrier
    v_mfma_f32_16x16x32_bf16 v[20:23], v[160:163], v[180:183], v[20:23]
    ds_read_b64_tr_b16 a[204:205], v7 offset:0
    s_add_u32 m0, s65, 26624
    v_mfma_f32_16x16x32_bf16 v[24:27], v[160:163], v[184:187], v[24:27]
    ds_read_b64_tr_b16 a[206:207], v7 offset:7680
    s_add_u32 s69, s54, 81920
    v_mfma_f32_16x16x32_bf16 v[28:31], v[160:163], v[188:191], v[28:31]
    buffer_load_dwordx4 v11, s[16:19], s69 offen offset:0 lds
    v_mfma_f32_16x16x32_bf16 v[32:35], v[160:163], v[192:195], v[32:35]
    s_mov_b64 exec, s[94:95]
    ds_read_b128 a[220:223], v10 offset:53248
    s_mov_b64 exec, -1
    v_mfma_f32_16x16x32_bf16 v[36:39], v[160:163], v[196:199], v[36:39]
    ds_read_b128 a[224:227], v10 offset:36864
    s_add_u32 s5, s4, 0
    v_mfma_f32_16x16x32_bf16 v[40:43], v[160:163], v[200:203], v[40:43]
    buffer_store_dwordx4 v[216:219], v213, s[28:31], s5 offen sc1
    v_mfma_f32_16x16x32_bf16 v[44:47], v[160:163], v[204:207], v[44:47]
    ds_read_b128 a[228:231], v10 offset:38912
    s_add_u32 s5, s4, 4096
    v_mfma_f32_16x16x32_bf16 v[48:51], v[160:163], v[208:211], v[48:51]
    ds_read_b128 a[232:235], v10 offset:40960
    v_mfma_f32_16x16x32_bf16 v[84:87], v[164:167], v[208:211], v[84:87]
    buffer_load_dwordx4 v12, s[16:19], s69 offen offset:1024 lds
    v_mfma_f32_16x16x32_bf16 v[80:83], v[164:167], v[204:207], v[80:83]
    ds_read_b128 a[236:239], v10 offset:43008
    s_add_u32 m0, s66, 61440
    v_mfma_f32_16x16x32_bf16 v[76:79], v[164:167], v[200:203], v[76:79]
    ds_read_b128 a[240:243], v10 offset:45056
    s_add_u32 s68, s44, 122880
    v_mfma_f32_16x16x32_bf16 v[72:75], v[164:167], v[196:199], v[72:75]
    buffer_store_dwordx4 v[220:223], v213, s[28:31], s5 offen sc1
    v_mfma_f32_16x16x32_bf16 v[68:71], v[164:167], v[192:195], v[68:71]
    ds_read_b128 a[244:247], v10 offset:47104
    s_add_u32 s5, s4, 8192
    v_mfma_f32_16x16x32_bf16 v[64:67], v[164:167], v[188:191], v[64:67]
    ds_read_b128 a[248:251], v10 offset:49152
    v_mfma_f32_16x16x32_bf16 v[60:63], v[164:167], v[184:187], v[60:63]
    buffer_load_dwordx4 v3, s[20:23], s68 offen offset:0 lds
    v_mfma_f32_16x16x32_bf16 v[56:59], v[164:167], v[180:183], v[56:59]
    ds_read_b128 a[252:255], v10 offset:51200
    v_mfma_f32_16x16x32_bf16 v[52:55], v[164:167], v[176:179], v[52:55]
    ds_read_b64_tr_b16 a[208:209], v7 offset:32
    v_mfma_f32_16x16x32_bf16 v[88:91], v[168:171], v[176:179], v[88:91]
    buffer_store_dwordx4 v[224:227], v213, s[28:31], s5 offen sc1
    v_mfma_f32_16x16x32_bf16 v[92:95], v[168:171], v[180:183], v[92:95]
    ds_read_b64_tr_b16 a[210:211], v7 offset:7712
    s_add_u32 s5, s4, 12288
    v_mfma_f32_16x16x32_bf16 v[96:99], v[168:171], v[184:187], v[96:99]
    ds_read_b64_tr_b16 a[212:213], v7 offset:64
    v_mfma_f32_16x16x32_bf16 v[100:103], v[168:171], v[188:191], v[100:103]
    buffer_load_dwordx4 v4, s[20:23], s68 offen offset:1024 lds
    v_mfma_f32_16x16x32_bf16 v[104:107], v[168:171], v[192:195], v[104:107]
    ds_read_b64_tr_b16 a[214:215], v7 offset:7744
    v_mfma_f32_16x16x32_bf16 v[108:111], v[168:171], v[196:199], v[108:111]
    ds_read_b64_tr_b16 a[216:217], v252 offset:96
    v_mfma_f32_16x16x32_bf16 v[112:115], v[168:171], v[200:203], v[112:115]
    buffer_store_dwordx4 v[228:231], v213, s[28:31], s5 offen sc1
    v_mfma_f32_16x16x32_bf16 v[116:119], v[168:171], v[204:207], v[116:119]
    ds_read_b64_tr_b16 a[218:219], v252 offset:7776
    s_add_u32 s5, s4, 16384
    v_mfma_f32_16x16x32_bf16 v[120:123], v[168:171], v[208:211], v[120:123]
    buffer_load_dwordx4 v5, s[20:23], s68 offen offset:2048 lds
    v_mfma_f32_16x16x32_bf16 v[156:159], v[172:175], v[208:211], v[156:159]
    s_add_u32 s69, m0, 3072
    v_mfma_f32_16x16x32_bf16 v[152:155], v[172:175], v[204:207], v[152:155]
    s_cmp_eq_u32 s32, 3
    s_cselect_b32 m0, 112640, s69
    v_mfma_f32_16x16x32_bf16 v[148:151], v[172:175], v[200:203], v[148:151]
    s_cmp_eq_u32 s32, 3
    s_cselect_b32 s68, s54, s68
    v_mfma_f32_16x16x32_bf16 v[144:147], v[172:175], v[196:199], v[144:147]
    buffer_store_dwordx4 v[232:235], v213, s[28:31], s5 offen sc1
    v_mfma_f32_16x16x32_bf16 v[140:143], v[172:175], v[192:195], v[140:143]
    buffer_load_dwordx4 v13, s[72:75], s68 offen lds
    v_mfma_f32_16x16x32_bf16 v[136:139], v[172:175], v[188:191], v[136:139]
    ds_read_b64_tr_b16 v[216:217], v212 offset:640
    v_mfma_f32_16x16x32_bf16 v[132:135], v[172:175], v[184:187], v[132:135]
    ds_read_b64_tr_b16 v[218:219], v212 offset:5760
    v_mfma_f32_16x16x32_bf16 v[128:131], v[172:175], v[180:183], v[128:131]
    ds_read_b64_tr_b16 v[220:221], v212 offset:768
    v_mfma_f32_16x16x32_bf16 v[124:127], v[172:175], v[176:179], v[124:127]
    ds_read_b64_tr_b16 v[222:223], v212 offset:5888
    ds_read_b64_tr_b16 v[224:225], v212 offset:896
    ds_read_b64_tr_b16 v[226:227], v212 offset:6016
    ds_read_b64_tr_b16 v[228:229], v212 offset:1024
    ds_read_b64_tr_b16 v[230:231], v212 offset:6144
    ds_read_b64_tr_b16 v[232:233], v212 offset:1152
    ds_read_b64_tr_b16 v[234:235], v212 offset:6272
    s_waitcnt lgkmcnt(0)
    v_mfma_f32_16x16x32_bf16 v[16:19], a[204:207], a[220:223], v[16:19]
    s_waitcnt vmcnt(17)
    s_barrier
    v_mfma_f32_16x16x32_bf16 v[20:23], a[204:207], a[224:227], v[20:23]
    ds_read_b64_tr_b16 v[160:161], v7 offset:15360
    s_add_u32 m0, s65, 36864
    v_mfma_f32_16x16x32_bf16 v[24:27], a[204:207], a[228:231], v[24:27]
    ds_read_b64_tr_b16 v[162:163], v7 offset:23040
    s_add_u32 s69, s55, 0
    v_mfma_f32_16x16x32_bf16 v[28:31], a[204:207], a[232:235], v[28:31]
    buffer_load_dwordx4 v11, s[16:19], s69 offen offset:0 lds
    v_mfma_f32_16x16x32_bf16 v[32:35], a[204:207], a[236:239], v[32:35]
    s_mov_b64 exec, s[94:95]
    ds_read_b128 v[176:179], v9 offset:16384
    s_mov_b64 exec, -1
    v_mfma_f32_16x16x32_bf16 v[36:39], a[204:207], a[240:243], v[36:39]
    ds_read_b128 v[180:183], v9 offset:0
    s_add_u32 s5, s4, 20480
    v_mfma_f32_16x16x32_bf16 v[40:43], a[204:207], a[244:247], v[40:43]
    buffer_store_dwordx4 v[216:219], v213, s[28:31], s5 offen sc1
    v_mfma_f32_16x16x32_bf16 v[44:47], a[204:207], a[248:251], v[44:47]
    ds_read_b128 v[184:187], v9 offset:2048
    s_add_u32 s5, s4, 24576
    v_mfma_f32_16x16x32_bf16 v[48:51], a[204:207], a[252:255], v[48:51]
    ds_read_b128 v[188:191], v9 offset:4096
    v_mfma_f32_16x16x32_bf16 v[84:87], a[208:211], a[252:255], v[84:87]
    buffer_load_dwordx4 v12, s[16:19], s69 offen offset:1024 lds
    v_mfma_f32_16x16x32_bf16 v[80:83], a[208:211], a[248:251], v[80:83]
    ds_read_b128 v[192:195], v9 offset:6144
    s_add_u32 m0, s66, 0
    v_mfma_f32_16x16x32_bf16 v[76:79], a[208:211], a[244:247], v[76:79]
    ds_read_b128 v[196:199], v9 offset:8192
    s_add_u32 s68, s45, 0
    v_mfma_f32_16x16x32_bf16 v[72:75], a[208:211], a[240:243], v[72:75]
    buffer_store_dwordx4 v[220:223], v213, s[28:31], s5 offen sc1
    v_mfma_f32_16x16x32_bf16 v[68:71], a[208:211], a[236:239], v[68:71]
    ds_read_b128 v[200:203], v9 offset:10240
    s_add_u32 s5, s4, 28672
    v_mfma_f32_16x16x32_bf16 v[64:67], a[208:211], a[232:235], v[64:67]
    ds_read_b128 v[204:207], v9 offset:12288
    v_mfma_f32_16x16x32_bf16 v[60:63], a[208:211], a[228:231], v[60:63]
    buffer_load_dwordx4 v3, s[20:23], s68 offen offset:0 lds
    v_mfma_f32_16x16x32_bf16 v[56:59], a[208:211], a[224:227], v[56:59]
    ds_read_b128 v[208:211], v9 offset:14336
    v_mfma_f32_16x16x32_bf16 v[52:55], a[208:211], a[220:223], v[52:55]
    ds_read_b64_tr_b16 v[164:165], v7 offset:15392
    v_mfma_f32_16x16x32_bf16 v[88:91], a[212:215], a[220:223], v[88:91]
    buffer_store_dwordx4 v[224:227], v213, s[28:31], s5 offen sc1
    v_mfma_f32_16x16x32_bf16 v[92:95], a[212:215], a[224:227], v[92:95]
    ds_read_b64_tr_b16 v[166:167], v7 offset:23072
    s_add_u32 s5, s4, 32768
    v_mfma_f32_16x16x32_bf16 v[96:99], a[212:215], a[228:231], v[96:99]
    ds_read_b64_tr_b16 v[168:169], v7 offset:15424
    v_mfma_f32_16x16x32_bf16 v[100:103], a[212:215], a[232:235], v[100:103]
    buffer_load_dwordx4 v4, s[20:23], s68 offen offset:1024 lds
    v_mfma_f32_16x16x32_bf16 v[104:107], a[212:215], a[236:239], v[104:107]
    ds_read_b64_tr_b16 v[170:171], v7 offset:23104
    v_mfma_f32_16x16x32_bf16 v[108:111], a[212:215], a[240:243], v[108:111]
    ds_read_b64_tr_b16 v[172:173], v252 offset:15456
    v_mfma_f32_16x16x32_bf16 v[112:115], a[212:215], a[244:247], v[112:115]
    buffer_store_dwordx4 v[228:231], v213, s[28:31], s5 offen sc1
    v_mfma_f32_16x16x32_bf16 v[116:119], a[212:215], a[248:251], v[116:119]
    ds_read_b64_tr_b16 v[174:175], v252 offset:23136
    s_add_u32 s5, s4, 36864
    v_mfma_f32_16x16x32_bf16 v[120:123], a[212:215], a[252:255], v[120:123]
    buffer_load_dwordx4 v5, s[20:23], s68 offen offset:2048 lds
    v_mfma_f32_16x16x32_bf16 v[156:159], a[216:219], a[252:255], v[156:159]
    s_add_u32 s69, m0, 3072
    v_mfma_f32_16x16x32_bf16 v[152:155], a[216:219], a[248:251], v[152:155]
    s_cmp_eq_u32 s32, 3
    s_cselect_b32 m0, 130048, s69
    v_mfma_f32_16x16x32_bf16 v[148:151], a[216:219], a[244:247], v[148:151]
    s_cmp_eq_u32 s32, 3
    s_cselect_b32 s68, s55, s68
    v_mfma_f32_16x16x32_bf16 v[144:147], a[216:219], a[240:243], v[144:147]
    buffer_store_dwordx4 v[232:235], v213, s[28:31], s5 offen sc1
    v_mfma_f32_16x16x32_bf16 v[140:143], a[216:219], a[236:239], v[140:143]
    buffer_load_dwordx4 v6, s[72:75], s68 offen lds
    v_mfma_f32_16x16x32_bf16 v[136:139], a[216:219], a[232:235], v[136:139]
    v_mfma_f32_16x16x32_bf16 v[132:135], a[216:219], a[228:231], v[132:135]
    v_mfma_f32_16x16x32_bf16 v[128:131], a[216:219], a[224:227], v[128:131]
    v_mfma_f32_16x16x32_bf16 v[124:127], a[216:219], a[220:223], v[124:127]
    s_waitcnt lgkmcnt(0)
    v_mfma_f32_16x16x32_bf16 v[16:19], v[160:163], v[176:179], v[16:19]
    s_barrier
    v_mfma_f32_16x16x32_bf16 v[20:23], v[160:163], v[180:183], v[20:23]
    ds_read_b64_tr_b16 a[204:205], v7 offset:30720
    s_add_u32 m0, s65, 45056
    v_mfma_f32_16x16x32_bf16 v[24:27], v[160:163], v[184:187], v[24:27]
    ds_read_b64_tr_b16 a[206:207], v7 offset:38400
    s_add_u32 s69, s55, 81920
    v_mfma_f32_16x16x32_bf16 v[28:31], v[160:163], v[188:191], v[28:31]
    buffer_load_dwordx4 v11, s[16:19], s69 offen offset:0 lds
    v_mfma_f32_16x16x32_bf16 v[32:35], v[160:163], v[192:195], v[32:35]
    s_mov_b64 exec, s[94:95]
    ds_read_b128 a[220:223], v10 offset:16384
    s_mov_b64 exec, -1
    v_mfma_f32_16x16x32_bf16 v[36:39], v[160:163], v[196:199], v[36:39]
    ds_read_b128 a[224:227], v10 offset:0
    v_mfma_f32_16x16x32_bf16 v[40:43], v[160:163], v[200:203], v[40:43]
    v_mfma_f32_16x16x32_bf16 v[44:47], v[160:163], v[204:207], v[44:47]
    ds_read_b128 a[228:231], v10 offset:2048
    v_mfma_f32_16x16x32_bf16 v[48:51], v[160:163], v[208:211], v[48:51]
    ds_read_b128 a[232:235], v10 offset:4096
    v_mfma_f32_16x16x32_bf16 v[84:87], v[164:167], v[208:211], v[84:87]
    buffer_load_dwordx4 v12, s[16:19], s69 offen offset:1024 lds
    v_mfma_f32_16x16x32_bf16 v[80:83], v[164:167], v[204:207], v[80:83]
    ds_read_b128 a[236:239], v10 offset:6144
    s_add_u32 m0, s66, 15360
    v_mfma_f32_16x16x32_bf16 v[76:79], v[164:167], v[200:203], v[76:79]
    ds_read_b128 a[240:243], v10 offset:8192
    s_add_u32 s68, s45, 122880
    v_mfma_f32_16x16x32_bf16 v[72:75], v[164:167], v[196:199], v[72:75]
    v_mfma_f32_16x16x32_bf16 v[68:71], v[164:167], v[192:195], v[68:71]
    ds_read_b128 a[244:247], v10 offset:10240
    v_mfma_f32_16x16x32_bf16 v[64:67], v[164:167], v[188:191], v[64:67]
    ds_read_b128 a[248:251], v10 offset:12288
    v_mfma_f32_16x16x32_bf16 v[60:63], v[164:167], v[184:187], v[60:63]
    buffer_load_dwordx4 v3, s[20:23], s68 offen offset:0 lds
    v_mfma_f32_16x16x32_bf16 v[56:59], v[164:167], v[180:183], v[56:59]
    ds_read_b128 a[252:255], v10 offset:14336
    v_mfma_f32_16x16x32_bf16 v[52:55], v[164:167], v[176:179], v[52:55]
    ds_read_b64_tr_b16 a[208:209], v7 offset:30752
    v_mfma_f32_16x16x32_bf16 v[88:91], v[168:171], v[176:179], v[88:91]
    v_mfma_f32_16x16x32_bf16 v[92:95], v[168:171], v[180:183], v[92:95]
    ds_read_b64_tr_b16 a[210:211], v7 offset:38432
    v_mfma_f32_16x16x32_bf16 v[96:99], v[168:171], v[184:187], v[96:99]
    ds_read_b64_tr_b16 a[212:213], v7 offset:30784
    v_mfma_f32_16x16x32_bf16 v[100:103], v[168:171], v[188:191], v[100:103]
    buffer_load_dwordx4 v4, s[20:23], s68 offen offset:1024 lds
    v_mfma_f32_16x16x32_bf16 v[104:107], v[168:171], v[192:195], v[104:107]
    ds_read_b64_tr_b16 a[214:215], v7 offset:38464
    v_mfma_f32_16x16x32_bf16 v[108:111], v[168:171], v[196:199], v[108:111]
    ds_read_b64_tr_b16 a[216:217], v252 offset:30816
    v_mfma_f32_16x16x32_bf16 v[112:115], v[168:171], v[200:203], v[112:115]
    v_mfma_f32_16x16x32_bf16 v[116:119], v[168:171], v[204:207], v[116:119]
    ds_read_b64_tr_b16 a[218:219], v252 offset:38496
    v_mfma_f32_16x16x32_bf16 v[120:123], v[168:171], v[208:211], v[120:123]
    buffer_load_dwordx4 v5, s[20:23], s68 offen offset:2048 lds
    v_mfma_f32_16x16x32_bf16 v[156:159], v[172:175], v[208:211], v[156:159]
    s_add_u32 s69, m0, 3072
    v_mfma_f32_16x16x32_bf16 v[152:155], v[172:175], v[204:207], v[152:155]
    s_cmp_eq_u32 s32, 3
    s_cselect_b32 m0, 131072, s69
    v_mfma_f32_16x16x32_bf16 v[148:151], v[172:175], v[200:203], v[148:151]
    s_cmp_eq_u32 s32, 3
    s_cselect_b32 s68, s55, s68
    v_mfma_f32_16x16x32_bf16 v[144:147], v[172:175], v[196:199], v[144:147]
    v_mfma_f32_16x16x32_bf16 v[140:143], v[172:175], v[192:195], v[140:143]
    buffer_load_dwordx4 v13, s[72:75], s68 offen lds
    v_mfma_f32_16x16x32_bf16 v[136:139], v[172:175], v[188:191], v[136:139]
    v_mfma_f32_16x16x32_bf16 v[132:135], v[172:175], v[184:187], v[132:135]
    v_mfma_f32_16x16x32_bf16 v[128:131], v[172:175], v[180:183], v[128:131]
    v_mfma_f32_16x16x32_bf16 v[124:127], v[172:175], v[176:179], v[124:127]
    s_waitcnt lgkmcnt(0)
    v_mfma_f32_16x16x32_bf16 v[16:19], a[204:207], a[220:223], v[16:19]
    s_waitcnt vmcnt(7)
    s_barrier
    v_mfma_f32_16x16x32_bf16 v[20:23], a[204:207], a[224:227], v[20:23]
    ds_read_b64_tr_b16 v[160:161], v8 offset:0
    s_add_u32 m0, s65, 0
    v_mfma_f32_16x16x32_bf16 v[24:27], a[204:207], a[228:231], v[24:27]
    ds_read_b64_tr_b16 v[162:163], v8 offset:7680
    s_add_u32 s69, s56, 0
    v_mfma_f32_16x16x32_bf16 v[28:31], a[204:207], a[232:235], v[28:31]
    buffer_load_dwordx4 v11, s[16:19], s69 offen offset:0 lds
    v_mfma_f32_16x16x32_bf16 v[32:35], a[204:207], a[236:239], v[32:35]
    s_mov_b64 exec, s[94:95]
    ds_read_b128 v[176:179], v9 offset:34816
    s_mov_b64 exec, -1
    v_mfma_f32_16x16x32_bf16 v[36:39], a[204:207], a[240:243], v[36:39]
    ds_read_b128 v[180:183], v9 offset:18432
    v_mfma_f32_16x16x32_bf16 v[40:43], a[204:207], a[244:247], v[40:43]
    v_mov_b32 v212, 1
    s_lshl_b32 s13, s32, 12
    v_mfma_f32_16x16x32_bf16 v[44:47], a[204:207], a[248:251], v[44:47]
    ds_read_b128 v[184:187], v9 offset:20480
    v_mfma_f32_16x16x32_bf16 v[48:51], a[204:207], a[252:255], v[48:51]
    ds_read_b128 v[188:191], v9 offset:22528
    v_mfma_f32_16x16x32_bf16 v[84:87], a[208:211], a[252:255], v[84:87]
    buffer_load_dwordx4 v12, s[16:19], s69 offen offset:1024 lds
    v_mfma_f32_16x16x32_bf16 v[80:83], a[208:211], a[248:251], v[80:83]
    ds_read_b128 v[192:195], v9 offset:24576
    s_add_u32 m0, s66, 30720
    v_mfma_f32_16x16x32_bf16 v[76:79], a[208:211], a[244:247], v[76:79]
    ds_read_b128 v[196:199], v9 offset:26624
    s_add_u32 s68, s46, 0
    v_mfma_f32_16x16x32_bf16 v[72:75], a[208:211], a[240:243], v[72:75]
    s_mov_b64 exec, 1
    buffer_atomic_add v212, off, s[24:27], s13 offset:128 sc0 sc1
    s_mov_b64 exec, -1
    v_mfma_f32_16x16x32_bf16 v[68:71], a[208:211], a[236:239], v[68:71]
    ds_read_b128 v[200:203], v9 offset:28672
    v_mfma_f32_16x16x32_bf16 v[64:67], a[208:211], a[232:235], v[64:67]
    ds_read_b128 v[204:207], v9 offset:30720
    v_mfma_f32_16x16x32_bf16 v[60:63], a[208:211], a[228:231], v[60:63]
    buffer_load_dwordx4 v3, s[20:23], s68 offen offset:0 lds
    v_mfma_f32_16x16x32_bf16 v[56:59], a[208:211], a[224:227], v[56:59]
    ds_read_b128 v[208:211], v9 offset:32768
    v_mfma_f32_16x16x32_bf16 v[52:55], a[208:211], a[220:223], v[52:55]
    ds_read_b64_tr_b16 v[164:165], v8 offset:32
    v_mfma_f32_16x16x32_bf16 v[88:91], a[212:215], a[220:223], v[88:91]
    v_mfma_f32_16x16x32_bf16 v[92:95], a[212:215], a[224:227], v[92:95]
    ds_read_b64_tr_b16 v[166:167], v8 offset:7712
    v_mfma_f32_16x16x32_bf16 v[96:99], a[212:215], a[228:231], v[96:99]
    ds_read_b64_tr_b16 v[168:169], v8 offset:64
    v_mfma_f32_16x16x32_bf16 v[100:103], a[212:215], a[232:235], v[100:103]
    buffer_load_dwordx4 v4, s[20:23], s68 offen offset:1024 lds
    v_mfma_f32_16x16x32_bf16 v[104:107], a[212:215], a[236:239], v[104:107]
    ds_read_b64_tr_b16 v[170:171], v8 offset:7744
    v_mfma_f32_16x16x32_bf16 v[108:111], a[212:215], a[240:243], v[108:111]
    ds_read_b64_tr_b16 v[172:173], v253 offset:96
    v_mfma_f32_16x16x32_bf16 v[112:115], a[212:215], a[244:247], v[112:115]
    v_mfma_f32_16x16x32_bf16 v[116:119], a[212:215], a[248:251], v[116:119]
    ds_read_b64_tr_b16 v[174:175], v253 offset:7776
    v_mfma_f32_16x16x32_bf16 v[120:123], a[212:215], a[252:255], v[120:123]
    buffer_load_dwordx4 v5, s[20:23], s68 offen offset:2048 lds
    v_mfma_f32_16x16x32_bf16 v[156:159], a[216:219], a[252:255], v[156:159]
    s_add_u32 s69, m0, 3072
    v_mfma_f32_16x16x32_bf16 v[152:155], a[216:219], a[248:251], v[152:155]
    s_cmp_eq_u32 s32, 3
    s_cselect_b32 m0, 93184, s69
    v_mfma_f32_16x16x32_bf16 v[148:151], a[216:219], a[244:247], v[148:151]
    s_cmp_eq_u32 s32, 3
    s_cselect_b32 s68, s56, s68
    v_mfma_f32_16x16x32_bf16 v[144:147], a[216:219], a[240:243], v[144:147]
    v_mfma_f32_16x16x32_bf16 v[140:143], a[216:219], a[236:239], v[140:143]
    buffer_load_dwordx4 v6, s[72:75], s68 offen lds
    v_mfma_f32_16x16x32_bf16 v[136:139], a[216:219], a[232:235], v[136:139]
    v_mfma_f32_16x16x32_bf16 v[132:135], a[216:219], a[228:231], v[132:135]
    v_mfma_f32_16x16x32_bf16 v[128:131], a[216:219], a[224:227], v[128:131]
    v_mfma_f32_16x16x32_bf16 v[124:127], a[216:219], a[220:223], v[124:127]
    s_waitcnt lgkmcnt(0)
    v_mfma_f32_16x16x32_bf16 v[16:19], v[160:163], v[176:179], v[16:19]
    s_barrier
    v_mfma_f32_16x16x32_bf16 v[20:23], v[160:163], v[180:183], v[20:23]
    ds_read_b64_tr_b16 a[204:205], v8 offset:15360
    s_add_u32 m0, s65, 8192
    v_mfma_f32_16x16x32_bf16 v[24:27], v[160:163], v[184:187], v[24:27]
    ds_read_b64_tr_b16 a[206:207], v8 offset:23040
    s_add_u32 s69, s56, 81920
    v_mfma_f32_16x16x32_bf16 v[28:31], v[160:163], v[188:191], v[28:31]
    buffer_load_dwordx4 v11, s[16:19], s69 offen offset:0 lds
    v_mfma_f32_16x16x32_bf16 v[32:35], v[160:163], v[192:195], v[32:35]
    s_mov_b64 exec, s[94:95]
    ds_read_b128 a[220:223], v10 offset:34816
    s_mov_b64 exec, -1
    v_mfma_f32_16x16x32_bf16 v[36:39], v[160:163], v[196:199], v[36:39]
    ds_read_b128 a[224:227], v10 offset:18432
    v_mfma_f32_16x16x32_bf16 v[40:43], v[160:163], v[200:203], v[40:43]
    v_mfma_f32_16x16x32_bf16 v[44:47], v[160:163], v[204:207], v[44:47]
    ds_read_b128 a[228:231], v10 offset:20480
    v_mfma_f32_16x16x32_bf16 v[48:51], v[160:163], v[208:211], v[48:51]
    ds_read_b128 a[232:235], v10 offset:22528
    v_mfma_f32_16x16x32_bf16 v[84:87], v[164:167], v[208:211], v[84:87]
    buffer_load_dwordx4 v12, s[16:19], s69 offen offset:1024 lds
    v_mfma_f32_16x16x32_bf16 v[80:83], v[164:167], v[204:207], v[80:83]
    ds_read_b128 a[236:239], v10 offset:24576
    s_add_u32 m0, s66, 46080
    v_mfma_f32_16x16x32_bf16 v[76:79], v[164:167], v[200:203], v[76:79]
    ds_read_b128 a[240:243], v10 offset:26624
    s_add_u32 s68, s46, 122880
    v_mfma_f32_16x16x32_bf16 v[72:75], v[164:167], v[196:199], v[72:75]
    v_mfma_f32_16x16x32_bf16 v[68:71], v[164:167], v[192:195], v[68:71]
    ds_read_b128 a[244:247], v10 offset:28672
    v_mfma_f32_16x16x32_bf16 v[64:67], v[164:167], v[188:191], v[64:67]
    ds_read_b128 a[248:251], v10 offset:30720
    v_mfma_f32_16x16x32_bf16 v[60:63], v[164:167], v[184:187], v[60:63]
    buffer_load_dwordx4 v3, s[20:23], s68 offen offset:0 lds
    v_mfma_f32_16x16x32_bf16 v[56:59], v[164:167], v[180:183], v[56:59]
    ds_read_b128 a[252:255], v10 offset:32768
    v_mfma_f32_16x16x32_bf16 v[52:55], v[164:167], v[176:179], v[52:55]
    ds_read_b64_tr_b16 a[208:209], v8 offset:15392
    v_mfma_f32_16x16x32_bf16 v[88:91], v[168:171], v[176:179], v[88:91]
    v_mfma_f32_16x16x32_bf16 v[92:95], v[168:171], v[180:183], v[92:95]
    ds_read_b64_tr_b16 a[210:211], v8 offset:23072
    v_mfma_f32_16x16x32_bf16 v[96:99], v[168:171], v[184:187], v[96:99]
    ds_read_b64_tr_b16 a[212:213], v8 offset:15424
    v_mfma_f32_16x16x32_bf16 v[100:103], v[168:171], v[188:191], v[100:103]
    buffer_load_dwordx4 v4, s[20:23], s68 offen offset:1024 lds
    v_mfma_f32_16x16x32_bf16 v[104:107], v[168:171], v[192:195], v[104:107]
    ds_read_b64_tr_b16 a[214:215], v8 offset:23104
    v_mfma_f32_16x16x32_bf16 v[108:111], v[168:171], v[196:199], v[108:111]
    ds_read_b64_tr_b16 a[216:217], v253 offset:15456
    v_mfma_f32_16x16x32_bf16 v[112:115], v[168:171], v[200:203], v[112:115]
    v_mfma_f32_16x16x32_bf16 v[116:119], v[168:171], v[204:207], v[116:119]
    ds_read_b64_tr_b16 a[218:219], v253 offset:23136
    v_mfma_f32_16x16x32_bf16 v[120:123], v[168:171], v[208:211], v[120:123]
    buffer_load_dwordx4 v5, s[20:23], s68 offen offset:2048 lds
    v_mfma_f32_16x16x32_bf16 v[156:159], v[172:175], v[208:211], v[156:159]
    s_add_u32 s69, m0, 3072
    v_mfma_f32_16x16x32_bf16 v[152:155], v[172:175], v[204:207], v[152:155]
    s_cmp_eq_u32 s32, 3
    s_cselect_b32 m0, 94208, s69
    v_mfma_f32_16x16x32_bf16 v[148:151], v[172:175], v[200:203], v[148:151]
    s_cmp_eq_u32 s32, 3
    s_cselect_b32 s68, s56, s68
    v_mfma_f32_16x16x32_bf16 v[144:147], v[172:175], v[196:199], v[144:147]
    v_mfma_f32_16x16x32_bf16 v[140:143], v[172:175], v[192:195], v[140:143]
    buffer_load_dwordx4 v13, s[72:75], s68 offen lds
    v_mfma_f32_16x16x32_bf16 v[136:139], v[172:175], v[188:191], v[136:139]
    v_mfma_f32_16x16x32_bf16 v[132:135], v[172:175], v[184:187], v[132:135]
    v_mfma_f32_16x16x32_bf16 v[128:131], v[172:175], v[180:183], v[128:131]
    v_mfma_f32_16x16x32_bf16 v[124:127], v[172:175], v[176:179], v[124:127]
    s_waitcnt lgkmcnt(0)
    v_mfma_f32_16x16x32_bf16 v[16:19], a[204:207], a[220:223], v[16:19]
    s_waitcnt vmcnt(13)
    s_barrier
    v_mfma_f32_16x16x32_bf16 v[20:23], a[204:207], a[224:227], v[20:23]
    ds_read_b64_tr_b16 v[160:161], v7 offset:0
    s_add_u32 m0, s65, 18432
    v_mfma_f32_16x16x32_bf16 v[24:27], a[204:207], a[228:231], v[24:27]
    ds_read_b64_tr_b16 v[162:163], v7 offset:7680
    s_add_u32 s69, s57, 0
    v_mfma_f32_16x16x32_bf16 v[28:31], a[204:207], a[232:235], v[28:31]
    buffer_load_dwordx4 v11, s[16:19], s69 offen offset:0 lds
    v_mfma_f32_16x16x32_bf16 v[32:35], a[204:207], a[236:239], v[32:35]
    s_mov_b64 exec, s[94:95]
    ds_read_b128 v[176:179], v9 offset:53248
    s_mov_b64 exec, -1
    v_mfma_f32_16x16x32_bf16 v[36:39], a[204:207], a[240:243], v[36:39]
    ds_read_b128 v[180:183], v9 offset:36864
    s_waitcnt vmcnt(11)
    v_mfma_f32_16x16x32_bf16 v[40:43], a[204:207], a[244:247], v[40:43]
    v_readfirstlane_b32 s100, v212
    s_and_b32 s100, s100, 127
    s_cmp_eq_u32 s100, 127
    s_cbranch_scc1 ATT_bcast
ATT_bcast_ok:
    v_mfma_f32_16x16x32_bf16 v[44:47], a[204:207], a[248:251], v[44:47]
    ds_read_b128 v[184:187], v9 offset:38912
    v_bfe_u32 v236, v2, 4, 1
    v_mfma_f32_16x16x32_bf16 v[48:51], a[204:207], a[252:255], v[48:51]
    ds_read_b128 v[188:191], v9 offset:40960
    v_lshlrev_b32 v236, 3, v236
    v_mfma_f32_16x16x32_bf16 v[84:87], a[208:211], a[252:255], v[84:87]
    buffer_load_dwordx4 v12, s[16:19], s69 offen offset:1024 lds
    v_mfma_f32_16x16x32_bf16 v[80:83], a[208:211], a[248:251], v[80:83]
    ds_read_b128 v[192:195], v9 offset:43008
    s_add_u32 m0, s66, 61440
    v_mfma_f32_16x16x32_bf16 v[76:79], a[208:211], a[244:247], v[76:79]
    ds_read_b128 v[196:199], v9 offset:45056
    s_add_u32 s68, s47, 0
    v_mfma_f32_16x16x32_bf16 v[72:75], a[208:211], a[240:243], v[72:75]
    v_bfe_u32 v248, v2, 5, 1
    v_add_u32 v236, v236, v248
    v_mfma_f32_16x16x32_bf16 v[68:71], a[208:211], a[236:239], v[68:71]
    ds_read_b128 v[200:203], v9 offset:47104
    v_bfe_u32 v248, v2, 2, 2
    v_mfma_f32_16x16x32_bf16 v[64:67], a[208:211], a[232:235], v[64:67]
    ds_read_b128 v[204:207], v9 offset:49152
    v_lshl_add_u32 v236, v248, 1, v236
    v_mfma_f32_16x16x32_bf16 v[60:63], a[208:211], a[228:231], v[60:63]
    buffer_load_dwordx4 v3, s[20:23], s68 offen offset:0 lds
    v_mfma_f32_16x16x32_bf16 v[56:59], a[208:211], a[224:227], v[56:59]
    ds_read_b128 v[208:211], v9 offset:51200
    v_mul_u32_u24 v249, 496, v236
    v_mfma_f32_16x16x32_bf16 v[52:55], a[208:211], a[220:223], v[52:55]
    ds_read_b64_tr_b16 v[164:165], v7 offset:32
    v_bfe_u32 v248, v2, 0, 2
    v_mfma_f32_16x16x32_bf16 v[88:91], a[212:215], a[220:223], v[88:91]
    v_mul_u32_u24 v248, 40, v248
    v_add3_u32 v233, v249, v248, s62
    v_mfma_f32_16x16x32_bf16 v[92:95], a[212:215], a[224:227], v[92:95]
    ds_read_b64_tr_b16 v[166:167], v7 offset:7712
    v_bfe_u32 v236, v2, 4, 1
    v_mfma_f32_16x16x32_bf16 v[96:99], a[212:215], a[228:231], v[96:99]
    ds_read_b64_tr_b16 v[168:169], v7 offset:64
    v_lshlrev_b32 v236, 3, v236
    v_mfma_f32_16x16x32_bf16 v[100:103], a[212:215], a[232:235], v[100:103]
    buffer_load_dwordx4 v4, s[20:23], s68 offen offset:1024 lds
    v_mfma_f32_16x16x32_bf16 v[104:107], a[212:215], a[236:239], v[104:107]
    ds_read_b64_tr_b16 v[170:171], v7 offset:7744
    v_bfe_u32 v248, v2, 5, 1
    v_mfma_f32_16x16x32_bf16 v[108:111], a[212:215], a[240:243], v[108:111]
    ds_read_b64_tr_b16 v[172:173], v252 offset:96
    v_add_u32 v236, v236, v248
    v_mfma_f32_16x16x32_bf16 v[112:115], a[212:215], a[244:247], v[112:115]
    v_bfe_u32 v248, v2, 0, 2
    v_lshl_add_u32 v236, v248, 1, v236
    v_mfma_f32_16x16x32_bf16 v[116:119], a[212:215], a[248:251], v[116:119]
    ds_read_b64_tr_b16 v[174:175], v252 offset:7776
    v_mul_u32_u24 v249, 496, v236
    v_mfma_f32_16x16x32_bf16 v[120:123], a[212:215], a[252:255], v[120:123]
    buffer_load_dwordx4 v5, s[20:23], s68 offen offset:2048 lds
    v_mfma_f32_16x16x32_bf16 v[156:159], a[216:219], a[252:255], v[156:159]
    s_add_u32 s69, m0, 3072
    v_bfe_u32 v248, v2, 2, 2
    v_mfma_f32_16x16x32_bf16 v[152:155], a[216:219], a[248:251], v[152:155]
    s_cmp_eq_u32 s32, 3
    s_cselect_b32 m0, 111616, s69
    v_mfma_f32_16x16x32_bf16 v[148:151], a[216:219], a[244:247], v[148:151]
    s_cmp_eq_u32 s32, 3
    s_cselect_b32 s68, s57, s68
    v_mfma_f32_16x16x32_bf16 v[144:147], a[216:219], a[240:243], v[144:147]
    v_mul_u32_u24 v248, 40, v248
    v_add3_u32 v232, v249, v248, s62
    v_mfma_f32_16x16x32_bf16 v[140:143], a[216:219], a[236:239], v[140:143]
    buffer_load_dwordx4 v6, s[72:75], s68 offen lds
    v_mfma_f32_16x16x32_bf16 v[136:139], a[216:219], a[232:235], v[136:139]
    v_and_b32 v234, 3, v2
    v_lshrrev_b32 v248, 3, v248
    v_mfma_f32_16x16x32_bf16 v[132:135], a[216:219], a[228:231], v[132:135]
    v_lshl_add_u32 v250, v236, 4, s63
    v_add_u32 v237, s63, v14
    v_mfma_f32_16x16x32_bf16 v[128:131], a[216:219], a[224:227], v[128:131]
    v_add_u32 v249, 0, v248
    v_lshrrev_b32 v238, 1, v249
    v_mfma_f32_16x16x32_bf16 v[124:127], a[216:219], a[220:223], v[124:127]
    v_lshl_add_u32 v238, v238, 8, v250
    s_waitcnt lgkmcnt(0)
    v_mfma_f32_16x16x32_bf16 v[16:19], v[160:163], v[176:179], v[16:19]
    s_barrier
    v_mfma_f32_16x16x32_bf16 v[20:23], v[160:163], v[180:183], v[20:23]
    ds_read_b64_tr_b16 a[204:205], v7 offset:15360
    s_add_u32 m0, s65, 26624
    v_mfma_f32_16x16x32_bf16 v[24:27], v[160:163], v[184:187], v[24:27]
    ds_read_b64_tr_b16 a[206:207], v7 offset:23040
    s_add_u32 s69, s57, 81920
    v_mfma_f32_16x16x32_bf16 v[28:31], v[160:163], v[188:191], v[28:31]
    buffer_load_dwordx4 v11, s[16:19], s69 offen offset:0 lds
    v_mfma_f32_16x16x32_bf16 v[32:35], v[160:163], v[192:195], v[32:35]
    s_mov_b64 exec, s[94:95]
    ds_read_b128 a[220:223], v10 offset:53248
    s_mov_b64 exec, -1
    v_mfma_f32_16x16x32_bf16 v[36:39], v[160:163], v[196:199], v[36:39]
    ds_read_b128 a[224:227], v10 offset:36864
    v_and_b32 v249, 1, v249
    v_mfma_f32_16x16x32_bf16 v[40:43], v[160:163], v[200:203], v[40:43]
    v_lshl_add_u32 v238, v249, 3, v238
    v_add_u32 v249, 1, v248
    v_mfma_f32_16x16x32_bf16 v[44:47], v[160:163], v[204:207], v[44:47]
    ds_read_b128 a[228:231], v10 offset:38912
    v_lshrrev_b32 v239, 1, v249
    v_mfma_f32_16x16x32_bf16 v[48:51], v[160:163], v[208:211], v[48:51]
    ds_read_b128 a[232:235], v10 offset:40960
    v_lshl_add_u32 v239, v239, 8, v250
    v_mfma_f32_16x16x32_bf16 v[84:87], v[164:167], v[208:211], v[84:87]
    buffer_load_dwordx4 v12, s[16:19], s69 offen offset:1024 lds
    v_mfma_f32_16x16x32_bf16 v[80:83], v[164:167], v[204:207], v[80:83]
    ds_read_b128 a[236:239], v10 offset:43008
    s_add_u32 m0, s66, 0
    v_mfma_f32_16x16x32_bf16 v[76:79], v[164:167], v[200:203], v[76:79]
    ds_read_b128 a[240:243], v10 offset:45056
    s_add_u32 s68, s47, 122880
    v_mfma_f32_16x16x32_bf16 v[72:75], v[164:167], v[196:199], v[72:75]
    v_and_b32 v249, 1, v249
    v_lshl_add_u32 v239, v249, 3, v239
    v_mfma_f32_16x16x32_bf16 v[68:71], v[164:167], v[192:195], v[68:71]
    ds_read_b128 a[244:247], v10 offset:47104
    v_add_u32 v249, 2, v248
    v_mfma_f32_16x16x32_bf16 v[64:67], v[164:167], v[188:191], v[64:67]
    ds_read_b128 a[248:251], v10 offset:49152
    v_lshrrev_b32 v240, 1, v249
    v_mfma_f32_16x16x32_bf16 v[60:63], v[164:167], v[184:187], v[60:63]
    buffer_load_dwordx4 v3, s[20:23], s68 offen offset:0 lds
    v_mfma_f32_16x16x32_bf16 v[56:59], v[164:167], v[180:183], v[56:59]
    ds_read_b128 a[252:255], v10 offset:51200
    v_lshl_add_u32 v240, v240, 8, v250
    v_mfma_f32_16x16x32_bf16 v[52:55], v[164:167], v[176:179], v[52:55]
    ds_read_b64_tr_b16 a[208:209], v7 offset:15392
    v_and_b32 v249, 1, v249
    v_mfma_f32_16x16x32_bf16 v[88:91], v[168:171], v[176:179], v[88:91]
    v_lshl_add_u32 v240, v249, 3, v240
    v_add_u32 v249, 3, v248
    v_mfma_f32_16x16x32_bf16 v[92:95], v[168:171], v[180:183], v[92:95]
    ds_read_b64_tr_b16 a[210:211], v7 offset:23072
    v_lshrrev_b32 v241, 1, v249
    v_mfma_f32_16x16x32_bf16 v[96:99], v[168:171], v[184:187], v[96:99]
    ds_read_b64_tr_b16 a[212:213], v7 offset:15424
    v_lshl_add_u32 v241, v241, 8, v250
    v_mfma_f32_16x16x32_bf16 v[100:103], v[168:171], v[188:191], v[100:103]
    buffer_load_dwordx4 v4, s[20:23], s68 offen offset:1024 lds
    v_mfma_f32_16x16x32_bf16 v[104:107], v[168:171], v[192:195], v[104:107]
    ds_read_b64_tr_b16 a[214:215], v7 offset:23104
    v_and_b32 v249, 1, v249
    v_mfma_f32_16x16x32_bf16 v[108:111], v[168:171], v[196:199], v[108:111]
    ds_read_b64_tr_b16 a[216:217], v252 offset:15456
    v_lshl_add_u32 v241, v249, 3, v241
    v_mfma_f32_16x16x32_bf16 v[112:115], v[168:171], v[200:203], v[112:115]
    v_add_u32 v249, 4, v248
    v_lshrrev_b32 v242, 1, v249
    v_mfma_f32_16x16x32_bf16 v[116:119], v[168:171], v[204:207], v[116:119]
    ds_read_b64_tr_b16 a[218:219], v252 offset:23136
    v_lshl_add_u32 v242, v242, 8, v250
    v_mfma_f32_16x16x32_bf16 v[120:123], v[168:171], v[208:211], v[120:123]
    buffer_load_dwordx4 v5, s[20:23], s68 offen offset:2048 lds
    v_mfma_f32_16x16x32_bf16 v[156:159], v[172:175], v[208:211], v[156:159]
    s_add_u32 s69, m0, 3072
    v_and_b32 v249, 1, v249
    v_mfma_f32_16x16x32_bf16 v[152:155], v[172:175], v[204:207], v[152:155]
    s_cmp_eq_u32 s32, 3
    s_cselect_b32 m0, 112640, s69
    v_mfma_f32_16x16x32_bf16 v[148:151], v[172:175], v[200:203], v[148:151]
    s_cmp_eq_u32 s32, 3
    s_cselect_b32 s68, s57, s68
    v_mfma_f32_16x16x32_bf16 v[144:147], v[172:175], v[196:199], v[144:147]
    v_lshl_add_u32 v242, v249, 3, v242
    v_lshrrev_b32 v248, 4, v2
    v_mfma_f32_16x16x32_bf16 v[140:143], v[172:175], v[192:195], v[140:143]
    buffer_load_dwordx4 v13, s[72:75], s68 offen lds
    v_mfma_f32_16x16x32_bf16 v[136:139], v[172:175], v[188:191], v[136:139]
    v_and_b32 v250, 15, v2
    v_mul_u32_u24 v235, 496, v250
    v_mfma_f32_16x16x32_bf16 v[132:135], v[172:175], v[184:187], v[132:135]
    v_lshl_add_u32 v235, v248, 3, v235
    v_add_u32 v235, s60, v235
    v_mfma_f32_16x16x32_bf16 v[128:131], v[172:175], v[180:183], v[128:131]
    v_lshlrev_b32 v250, 4, v250
    v_add_u32 v249, 0, v248
    v_mfma_f32_16x16x32_bf16 v[124:127], v[172:175], v[176:179], v[124:127]
    v_mul_u32_u24 v251, 13, v249
    s_waitcnt lgkmcnt(0)
    v_mfma_f32_16x16x32_bf16 v[16:19], a[204:207], a[220:223], v[16:19]
    s_waitcnt vmcnt(12)
    s_barrier
    v_mfma_f32_16x16x32_bf16 v[20:23], a[204:207], a[224:227], v[20:23]
    ds_read_b64_tr_b16 v[160:161], v7 offset:30720
    s_add_u32 m0, s65, 36864
    v_mfma_f32_16x16x32_bf16 v[24:27], a[204:207], a[228:231], v[24:27]
    ds_read_b64_tr_b16 v[162:163], v7 offset:38400
    s_add_u32 s69, s58, 0
    v_mfma_f32_16x16x32_bf16 v[28:31], a[204:207], a[232:235], v[28:31]
    buffer_load_dwordx4 v11, s[16:19], s69 offen offset:0 lds
    v_mfma_f32_16x16x32_bf16 v[32:35], a[204:207], a[236:239], v[32:35]
    s_mov_b64 exec, s[94:95]
    ds_read_b128 v[176:179], v9 offset:16384
    s_mov_b64 exec, -1
    v_mfma_f32_16x16x32_bf16 v[36:39], a[204:207], a[240:243], v[36:39]
    ds_read_b128 v[180:183], v9 offset:0
    v_lshrrev_b32 v251, 7, v251
    v_mfma_f32_16x16x32_bf16 v[40:43], a[204:207], a[244:247], v[40:43]
    v_lshl_add_u32 v243, v251, 10, v250
    v_mul_u32_u24 v251, 10, v251
    v_mfma_f32_16x16x32_bf16 v[44:47], a[204:207], a[248:251], v[44:47]
    ds_read_b128 v[184:187], v9 offset:2048
    v_sub_u32 v249, v249, v251
    v_mfma_f32_16x16x32_bf16 v[48:51], a[204:207], a[252:255], v[48:51]
    ds_read_b128 v[188:191], v9 offset:4096
    v_add_u32 v249, s64, v249
    v_mfma_f32_16x16x32_bf16 v[84:87], a[208:211], a[252:255], v[84:87]
    buffer_load_dwordx4 v12, s[16:19], s69 offen offset:1024 lds
    v_mfma_f32_16x16x32_bf16 v[80:83], a[208:211], a[248:251], v[80:83]
    ds_read_b128 v[192:195], v9 offset:6144
    s_add_u32 m0, s66, 15360
    v_mfma_f32_16x16x32_bf16 v[76:79], a[208:211], a[244:247], v[76:79]
    ds_read_b128 v[196:199], v9 offset:8192
    s_add_u32 s68, s48, 0
    v_mfma_f32_16x16x32_bf16 v[72:75], a[208:211], a[240:243], v[72:75]
    v_lshrrev_b32 v251, 2, v249
    v_lshl_add_u32 v243, v251, 12, v243
    v_mfma_f32_16x16x32_bf16 v[68:71], a[208:211], a[236:239], v[68:71]
    ds_read_b128 v[200:203], v9 offset:10240
    v_and_b32 v251, 3, v249
    v_mfma_f32_16x16x32_bf16 v[64:67], a[208:211], a[232:235], v[64:67]
    ds_read_b128 v[204:207], v9 offset:12288
    v_lshl_add_u32 v243, v251, 8, v243
    v_mfma_f32_16x16x32_bf16 v[60:63], a[208:211], a[228:231], v[60:63]
    buffer_load_dwordx4 v3, s[20:23], s68 offen offset:0 lds
    v_mfma_f32_16x16x32_bf16 v[56:59], a[208:211], a[224:227], v[56:59]
    ds_read_b128 v[208:211], v9 offset:14336
    v_add_u32 v249, 4, v248
    v_mfma_f32_16x16x32_bf16 v[52:55], a[208:211], a[220:223], v[52:55]
    ds_read_b64_tr_b16 v[164:165], v7 offset:30752
    v_mul_u32_u24 v251, 13, v249
    v_mfma_f32_16x16x32_bf16 v[88:91], a[212:215], a[220:223], v[88:91]
    v_lshrrev_b32 v251, 7, v251
    v_lshl_add_u32 v244, v251, 10, v250
    v_mfma_f32_16x16x32_bf16 v[92:95], a[212:215], a[224:227], v[92:95]
    ds_read_b64_tr_b16 v[166:167], v7 offset:38432
    v_mul_u32_u24 v251, 10, v251
    v_mfma_f32_16x16x32_bf16 v[96:99], a[212:215], a[228:231], v[96:99]
    ds_read_b64_tr_b16 v[168:169], v7 offset:30784
    v_sub_u32 v249, v249, v251
    v_mfma_f32_16x16x32_bf16 v[100:103], a[212:215], a[232:235], v[100:103]
    buffer_load_dwordx4 v4, s[20:23], s68 offen offset:1024 lds
    v_mfma_f32_16x16x32_bf16 v[104:107], a[212:215], a[236:239], v[104:107]
    ds_read_b64_tr_b16 v[170:171], v7 offset:38464
    v_add_u32 v249, s64, v249
    v_mfma_f32_16x16x32_bf16 v[108:111], a[212:215], a[240:243], v[108:111]
    ds_read_b64_tr_b16 v[172:173], v252 offset:30816
    v_lshrrev_b32 v251, 2, v249
    v_mfma_f32_16x16x32_bf16 v[112:115], a[212:215], a[244:247], v[112:115]
    v_lshl_add_u32 v244, v251, 12, v244
    v_and_b32 v251, 3, v249
    v_mfma_f32_16x16x32_bf16 v[116:119], a[212:215], a[248:251], v[116:119]
    ds_read_b64_tr_b16 v[174:175], v252 offset:38496
    v_lshl_add_u32 v244, v251, 8, v244
    v_mfma_f32_16x16x32_bf16 v[120:123], a[212:215], a[252:255], v[120:123]
    buffer_load_dwordx4 v5, s[20:23], s68 offen offset:2048 lds
    v_mfma_f32_16x16x32_bf16 v[156:159], a[216:219], a[252:255], v[156:159]
    s_add_u32 s69, m0, 3072
    v_add_u32 v249, 8, v248
    v_mfma_f32_16x16x32_bf16 v[152:155], a[216:219], a[248:251], v[152:155]
    s_cmp_eq_u32 s32, 3
    s_cselect_b32 m0, 130048, s69
    v_mfma_f32_16x16x32_bf16 v[148:151], a[216:219], a[244:247], v[148:151]
    s_cmp_eq_u32 s32, 3
    s_cselect_b32 s68, s58, s68
    v_mfma_f32_16x16x32_bf16 v[144:147], a[216:219], a[240:243], v[144:147]
    v_mul_u32_u24 v251, 13, v249
    v_lshrrev_b32 v251, 7, v251
    v_mfma_f32_16x16x32_bf16 v[140:143], a[216:219], a[236:239], v[140:143]
    buffer_load_dwordx4 v6, s[72:75], s68 offen lds
    v_mfma_f32_16x16x32_bf16 v[136:139], a[216:219], a[232:235], v[136:139]
    v_lshl_add_u32 v245, v251, 10, v250
    v_mul_u32_u24 v251, 10, v251
    v_mfma_f32_16x16x32_bf16 v[132:135], a[216:219], a[228:231], v[132:135]
    v_sub_u32 v249, v249, v251
    v_add_u32 v249, s64, v249
    v_mfma_f32_16x16x32_bf16 v[128:131], a[216:219], a[224:227], v[128:131]
    v_lshrrev_b32 v251, 2, v249
    v_lshl_add_u32 v245, v251, 12, v245
    v_mfma_f32_16x16x32_bf16 v[124:127], a[216:219], a[220:223], v[124:127]
    v_and_b32 v251, 3, v249
    s_waitcnt lgkmcnt(0)
    v_mfma_f32_16x16x32_bf16 v[16:19], v[160:163], v[176:179], v[16:19]
    s_barrier
    v_mfma_f32_16x16x32_bf16 v[20:23], v[160:163], v[180:183], v[20:23]
    ds_read_b64_tr_b16 a[204:205], v8 offset:0
    s_add_u32 m0, s65, 45056
    v_mfma_f32_16x16x32_bf16 v[24:27], v[160:163], v[184:187], v[24:27]
    ds_read_b64_tr_b16 a[206:207], v8 offset:7680
    s_add_u32 s69, s58, 81920
    v_mfma_f32_16x16x32_bf16 v[28:31], v[160:163], v[188:191], v[28:31]
    buffer_load_dwordx4 v11, s[16:19], s69 offen offset:0 lds
    v_mfma_f32_16x16x32_bf16 v[32:35], v[160:163], v[192:195], v[32:35]
    s_mov_b64 exec, s[94:95]
    ds_read_b128 a[220:223], v10 offset:16384
    s_mov_b64 exec, -1
    v_mfma_f32_16x16x32_bf16 v[36:39], v[160:163], v[196:199], v[36:39]
    ds_read_b128 a[224:227], v10 offset:0
    v_lshl_add_u32 v245, v251, 8, v245
    v_mfma_f32_16x16x32_bf16 v[40:43], v[160:163], v[200:203], v[40:43]
    v_add_u32 v249, 12, v248
    v_mul_u32_u24 v251, 13, v249
    v_mfma_f32_16x16x32_bf16 v[44:47], v[160:163], v[204:207], v[44:47]
    ds_read_b128 a[228:231], v10 offset:2048
    v_lshrrev_b32 v251, 7, v251
    v_mfma_f32_16x16x32_bf16 v[48:51], v[160:163], v[208:211], v[48:51]
    ds_read_b128 a[232:235], v10 offset:4096
    v_lshl_add_u32 v246, v251, 10, v250
    v_mfma_f32_16x16x32_bf16 v[84:87], v[164:167], v[208:211], v[84:87]
    buffer_load_dwordx4 v12, s[16:19], s69 offen offset:1024 lds
    v_mfma_f32_16x16x32_bf16 v[80:83], v[164:167], v[204:207], v[80:83]
    ds_read_b128 a[236:239], v10 offset:6144
    s_add_u32 m0, s66, 30720
    v_mfma_f32_16x16x32_bf16 v[76:79], v[164:167], v[200:203], v[76:79]
    ds_read_b128 a[240:243], v10 offset:8192
    s_add_u32 s68, s48, 122880
    v_mfma_f32_16x16x32_bf16 v[72:75], v[164:167], v[196:199], v[72:75]
    v_mul_u32_u24 v251, 10, v251
    v_sub_u32 v249, v249, v251
    v_mfma_f32_16x16x32_bf16 v[68:71], v[164:167], v[192:195], v[68:71]
    ds_read_b128 a[244:247], v10 offset:10240
    v_add_u32 v249, s64, v249
    v_mfma_f32_16x16x32_bf16 v[64:67], v[164:167], v[188:191], v[64:67]
    ds_read_b128 a[248:251], v10 offset:12288
    v_lshrrev_b32 v251, 2, v249
    v_mfma_f32_16x16x32_bf16 v[60:63], v[164:167], v[184:187], v[60:63]
    buffer_load_dwordx4 v3, s[20:23], s68 offen offset:0 lds
    v_mfma_f32_16x16x32_bf16 v[56:59], v[164:167], v[180:183], v[56:59]
    ds_read_b128 a[252:255], v10 offset:14336
    v_lshl_add_u32 v246, v251, 12, v246
    v_mfma_f32_16x16x32_bf16 v[52:55], v[164:167], v[176:179], v[52:55]
    ds_read_b64_tr_b16 a[208:209], v8 offset:32
    v_and_b32 v251, 3, v249
    v_mfma_f32_16x16x32_bf16 v[88:91], v[168:171], v[176:179], v[88:91]
    v_lshl_add_u32 v246, v251, 8, v246
    v_add_u32 v249, 16, v248
    v_mfma_f32_16x16x32_bf16 v[92:95], v[168:171], v[180:183], v[92:95]
    ds_read_b64_tr_b16 a[210:211], v8 offset:7712
    v_mul_u32_u24 v251, 13, v249
    v_mfma_f32_16x16x32_bf16 v[96:99], v[168:171], v[184:187], v[96:99]
    ds_read_b64_tr_b16 a[212:213], v8 offset:64
    v_lshrrev_b32 v251, 7, v251
    v_mfma_f32_16x16x32_bf16 v[100:103], v[168:171], v[188:191], v[100:103]
    buffer_load_dwordx4 v4, s[20:23], s68 offen offset:1024 lds
    v_mfma_f32_16x16x32_bf16 v[104:107], v[168:171], v[192:195], v[104:107]
    ds_read_b64_tr_b16 a[214:215], v8 offset:7744
    v_lshl_add_u32 v247, v251, 10, v250
    v_mfma_f32_16x16x32_bf16 v[108:111], v[168:171], v[196:199], v[108:111]
    ds_read_b64_tr_b16 a[216:217], v253 offset:96
    v_mul_u32_u24 v251, 10, v251
    v_mfma_f32_16x16x32_bf16 v[112:115], v[168:171], v[200:203], v[112:115]
    v_sub_u32 v249, v249, v251
    v_add_u32 v249, s64, v249
    v_mfma_f32_16x16x32_bf16 v[116:119], v[168:171], v[204:207], v[116:119]
    ds_read_b64_tr_b16 a[218:219], v253 offset:7776
    v_lshrrev_b32 v251, 2, v249
    v_mfma_f32_16x16x32_bf16 v[120:123], v[168:171], v[208:211], v[120:123]
    buffer_load_dwordx4 v5, s[20:23], s68 offen offset:2048 lds
    v_mfma_f32_16x16x32_bf16 v[156:159], v[172:175], v[208:211], v[156:159]
    s_add_u32 s69, m0, 3072
    v_lshl_add_u32 v247, v251, 12, v247
    v_mfma_f32_16x16x32_bf16 v[152:155], v[172:175], v[204:207], v[152:155]
    s_cmp_eq_u32 s32, 3
    s_cselect_b32 m0, 131072, s69
    v_mfma_f32_16x16x32_bf16 v[148:151], v[172:175], v[200:203], v[148:151]
    s_cmp_eq_u32 s32, 3
    s_cselect_b32 s68, s58, s68
    v_mfma_f32_16x16x32_bf16 v[144:147], v[172:175], v[196:199], v[144:147]
    v_and_b32 v251, 3, v249
    v_lshl_add_u32 v247, v251, 8, v247
    v_mfma_f32_16x16x32_bf16 v[140:143], v[172:175], v[192:195], v[140:143]
    buffer_load_dwordx4 v13, s[72:75], s68 offen lds
    v_mfma_f32_16x16x32_bf16 v[136:139], v[172:175], v[188:191], v[136:139]
    v_cmp_gt_u32 s[6:7], 1, v234
    v_cmp_gt_u32 s[8:9], 2, v234
    v_mfma_f32_16x16x32_bf16 v[132:135], v[172:175], v[184:187], v[132:135]
    v_cmp_gt_u32 s[10:11], 3, v234
    v_mfma_f32_16x16x32_bf16 v[128:131], v[172:175], v[180:183], v[128:131]
    v_mfma_f32_16x16x32_bf16 v[124:127], v[172:175], v[176:179], v[124:127]
    s_waitcnt lgkmcnt(0)
    v_mfma_f32_16x16x32_bf16 v[16:19], a[204:207], a[220:223], v[16:19]
    s_waitcnt vmcnt(12)
    s_barrier
    v_mfma_f32_16x16x32_bf16 v[20:23], a[204:207], a[224:227], v[20:23]
    ds_read_b64_tr_b16 v[160:161], v8 offset:15360
    s_add_u32 m0, s65, 0
    v_mfma_f32_16x16x32_bf16 v[24:27], a[204:207], a[228:231], v[24:27]
    ds_read_b64_tr_b16 v[162:163], v8 offset:23040
    s_add_u32 s69, s59, 0
    v_mfma_f32_16x16x32_bf16 v[28:31], a[204:207], a[232:235], v[28:31]
    buffer_load_dwordx4 v11, s[16:19], s69 offen offset:0 lds
    v_mfma_f32_16x16x32_bf16 v[32:35], a[204:207], a[236:239], v[32:35]
    s_mov_b64 exec, s[94:95]
    ds_read_b128 v[176:179], v9 offset:34816
    s_mov_b64 exec, -1
    v_mfma_f32_16x16x32_bf16 v[36:39], a[204:207], a[240:243], v[36:39]
    ds_read_b128 v[180:183], v9 offset:18432
    v_mfma_f32_16x16x32_bf16 v[40:43], a[204:207], a[244:247], v[40:43]
    buffer_load_dwordx4 v12, s[16:19], s69 offen offset:1024 lds
    v_mfma_f32_16x16x32_bf16 v[44:47], a[204:207], a[248:251], v[44:47]
    ds_read_b128 v[184:187], v9 offset:20480
    s_add_u32 m0, s66, 46080
    v_mfma_f32_16x16x32_bf16 v[48:51], a[204:207], a[252:255], v[48:51]
    ds_read_b128 v[188:191], v9 offset:22528
    s_add_u32 s68, s49, 0
    v_mfma_f32_16x16x32_bf16 v[84:87], a[208:211], a[252:255], v[84:87]
    buffer_load_dwordx4 v3, s[20:23], s68 offen offset:0 lds
    v_mfma_f32_16x16x32_bf16 v[80:83], a[208:211], a[248:251], v[80:83]
    ds_read_b128 v[192:195], v9 offset:24576
    v_mfma_f32_16x16x32_bf16 v[76:79], a[208:211], a[244:247], v[76:79]
    ds_read_b128 v[196:199], v9 offset:26624
    v_mfma_f32_16x16x32_bf16 v[72:75], a[208:211], a[240:243], v[72:75]
    buffer_load_dwordx4 v4, s[20:23], s68 offen offset:1024 lds
    v_mfma_f32_16x16x32_bf16 v[68:71], a[208:211], a[236:239], v[68:71]
    ds_read_b128 v[200:203], v9 offset:28672
    v_mfma_f32_16x16x32_bf16 v[64:67], a[208:211], a[232:235], v[64:67]
    ds_read_b128 v[204:207], v9 offset:30720
    v_mfma_f32_16x16x32_bf16 v[60:63], a[208:211], a[228:231], v[60:63]
    buffer_load_dwordx4 v5, s[20:23], s68 offen offset:2048 lds
    v_mfma_f32_16x16x32_bf16 v[56:59], a[208:211], a[224:227], v[56:59]
    ds_read_b128 v[208:211], v9 offset:32768
    s_add_u32 s69, m0, 3072
    v_mfma_f32_16x16x32_bf16 v[52:55], a[208:211], a[220:223], v[52:55]
    ds_read_b64_tr_b16 v[164:165], v8 offset:15392
    v_mfma_f32_16x16x32_bf16 v[88:91], a[212:215], a[220:223], v[88:91]
    s_cmp_eq_u32 s32, 3
    s_cselect_b32 m0, 93184, s69
    v_mfma_f32_16x16x32_bf16 v[92:95], a[212:215], a[224:227], v[92:95]
    ds_read_b64_tr_b16 v[166:167], v8 offset:23072
    v_mfma_f32_16x16x32_bf16 v[96:99], a[212:215], a[228:231], v[96:99]
    ds_read_b64_tr_b16 v[168:169], v8 offset:15424
    v_mfma_f32_16x16x32_bf16 v[100:103], a[212:215], a[232:235], v[100:103]
    s_cmp_eq_u32 s32, 3
    s_cselect_b32 s68, s59, s68
    v_mfma_f32_16x16x32_bf16 v[104:107], a[212:215], a[236:239], v[104:107]
    ds_read_b64_tr_b16 v[170:171], v8 offset:23104
    v_mfma_f32_16x16x32_bf16 v[108:111], a[212:215], a[240:243], v[108:111]
    ds_read_b64_tr_b16 v[172:173], v253 offset:15456
    v_mfma_f32_16x16x32_bf16 v[112:115], a[212:215], a[244:247], v[112:115]
    buffer_load_dwordx4 v6, s[72:75], s68 offen lds
    v_mfma_f32_16x16x32_bf16 v[116:119], a[212:215], a[248:251], v[116:119]
    ds_read_b64_tr_b16 v[174:175], v253 offset:23136
    v_mfma_f32_16x16x32_bf16 v[120:123], a[212:215], a[252:255], v[120:123]
    v_mfma_f32_16x16x32_bf16 v[156:159], a[216:219], a[252:255], v[156:159]
    buffer_load_dwordx2 v[212:213], v15, s[28:31], s38 offen offset:0 sc1
    v_mfma_f32_16x16x32_bf16 v[152:155], a[216:219], a[248:251], v[152:155]
    v_mfma_f32_16x16x32_bf16 v[148:151], a[216:219], a[244:247], v[148:151]
    v_mfma_f32_16x16x32_bf16 v[144:147], a[216:219], a[240:243], v[144:147]
    buffer_load_dwordx2 v[214:215], v15, s[28:31], s79 offen offset:0 sc1
    v_mfma_f32_16x16x32_bf16 v[140:143], a[216:219], a[236:239], v[140:143]
    v_mfma_f32_16x16x32_bf16 v[136:139], a[216:219], a[232:235], v[136:139]
    v_mfma_f32_16x16x32_bf16 v[132:135], a[216:219], a[228:231], v[132:135]
    buffer_load_dwordx2 v[216:217], v15, s[28:31], s79 offen offset:128 sc1
    v_mfma_f32_16x16x32_bf16 v[128:131], a[216:219], a[224:227], v[128:131]
    v_mfma_f32_16x16x32_bf16 v[124:127], a[216:219], a[220:223], v[124:127]
    buffer_load_dword v1, off, s[28:31], s35 offset:64 sc1
    s_waitcnt lgkmcnt(0)
    v_mfma_f32_16x16x32_bf16 v[16:19], v[160:163], v[176:179], v[16:19]
    s_barrier
    v_mfma_f32_16x16x32_bf16 v[20:23], v[160:163], v[180:183], v[20:23]
    ds_read_b64_tr_b16 a[204:205], v7 offset:0
    s_add_u32 m0, s65, 8192
    v_mfma_f32_16x16x32_bf16 v[24:27], v[160:163], v[184:187], v[24:27]
    ds_read_b64_tr_b16 a[206:207], v7 offset:7680
    s_add_u32 s69, s59, 81920
    v_mfma_f32_16x16x32_bf16 v[28:31], v[160:163], v[188:191], v[28:31]
    buffer_load_dwordx4 v11, s[16:19], s69 offen offset:0 lds
    v_mfma_f32_16x16x32_bf16 v[32:35], v[160:163], v[192:195], v[32:35]
    s_mov_b64 exec, s[94:95]
    ds_read_b128 a[220:223], v10 offset:34816
    s_mov_b64 exec, -1
    v_mfma_f32_16x16x32_bf16 v[36:39], v[160:163], v[196:199], v[36:39]
    ds_read_b128 a[224:227], v10 offset:18432
    v_mfma_f32_16x16x32_bf16 v[40:43], v[160:163], v[200:203], v[40:43]
    buffer_load_dwordx4 v12, s[16:19], s69 offen offset:1024 lds
    v_mfma_f32_16x16x32_bf16 v[44:47], v[160:163], v[204:207], v[44:47]
    ds_read_b128 a[228:231], v10 offset:20480
    s_add_u32 m0, s66, 61440
    v_mfma_f32_16x16x32_bf16 v[48:51], v[160:163], v[208:211], v[48:51]
    ds_read_b128 a[232:235], v10 offset:22528
    s_add_u32 s68, s49, 122880
    v_mfma_f32_16x16x32_bf16 v[84:87], v[164:167], v[208:211], v[84:87]
    buffer_load_dwordx4 v3, s[20:23], s68 offen offset:0 lds
    v_mfma_f32_16x16x32_bf16 v[80:83], v[164:167], v[204:207], v[80:83]
    ds_read_b128 a[236:239], v10 offset:24576
    v_mfma_f32_16x16x32_bf16 v[76:79], v[164:167], v[200:203], v[76:79]
    ds_read_b128 a[240:243], v10 offset:26624
    v_mfma_f32_16x16x32_bf16 v[72:75], v[164:167], v[196:199], v[72:75]
    buffer_load_dwordx4 v4, s[20:23], s68 offen offset:1024 lds
    v_mfma_f32_16x16x32_bf16 v[68:71], v[164:167], v[192:195], v[68:71]
    ds_read_b128 a[244:247], v10 offset:28672
    v_mfma_f32_16x16x32_bf16 v[64:67], v[164:167], v[188:191], v[64:67]
    ds_read_b128 a[248:251], v10 offset:30720
    v_mfma_f32_16x16x32_bf16 v[60:63], v[164:167], v[184:187], v[60:63]
    buffer_load_dwordx4 v5, s[20:23], s68 offen offset:2048 lds
    v_mfma_f32_16x16x32_bf16 v[56:59], v[164:167], v[180:183], v[56:59]
    ds_read_b128 a[252:255], v10 offset:32768
    s_add_u32 s69, m0, 3072
    v_mfma_f32_16x16x32_bf16 v[52:55], v[164:167], v[176:179], v[52:55]
    ds_read_b64_tr_b16 a[208:209], v7 offset:32
    v_mfma_f32_16x16x32_bf16 v[88:91], v[168:171], v[176:179], v[88:91]
    s_cmp_eq_u32 s32, 3
    s_cselect_b32 m0, 94208, s69
    v_mfma_f32_16x16x32_bf16 v[92:95], v[168:171], v[180:183], v[92:95]
    ds_read_b64_tr_b16 a[210:211], v7 offset:7712
    v_mfma_f32_16x16x32_bf16 v[96:99], v[168:171], v[184:187], v[96:99]
    ds_read_b64_tr_b16 a[212:213], v7 offset:64
    v_mfma_f32_16x16x32_bf16 v[100:103], v[168:171], v[188:191], v[100:103]
    s_cmp_eq_u32 s32, 3
    s_cselect_b32 s68, s59, s68
    v_mfma_f32_16x16x32_bf16 v[104:107], v[168:171], v[192:195], v[104:107]
    ds_read_b64_tr_b16 a[214:215], v7 offset:7744
    v_mfma_f32_16x16x32_bf16 v[108:111], v[168:171], v[196:199], v[108:111]
    ds_read_b64_tr_b16 a[216:217], v252 offset:96
    v_mfma_f32_16x16x32_bf16 v[112:115], v[168:171], v[200:203], v[112:115]
    buffer_load_dwordx4 v13, s[72:75], s68 offen lds
    v_mfma_f32_16x16x32_bf16 v[116:119], v[168:171], v[204:207], v[116:119]
    ds_read_b64_tr_b16 a[218:219], v252 offset:7776
    v_mfma_f32_16x16x32_bf16 v[120:123], v[168:171], v[208:211], v[120:123]
    v_mfma_f32_16x16x32_bf16 v[156:159], v[172:175], v[208:211], v[156:159]
    buffer_load_dwordx2 v[218:219], v15, s[28:31], s79 offen offset:256 sc1
    v_mfma_f32_16x16x32_bf16 v[152:155], v[172:175], v[204:207], v[152:155]
    v_mfma_f32_16x16x32_bf16 v[148:151], v[172:175], v[200:203], v[148:151]
    v_mfma_f32_16x16x32_bf16 v[144:147], v[172:175], v[196:199], v[144:147]
    buffer_load_dwordx2 v[220:221], v15, s[28:31], s79 offen offset:384 sc1
    v_mfma_f32_16x16x32_bf16 v[140:143], v[172:175], v[192:195], v[140:143]
    v_mfma_f32_16x16x32_bf16 v[136:139], v[172:175], v[188:191], v[136:139]
    v_mfma_f32_16x16x32_bf16 v[132:135], v[172:175], v[184:187], v[132:135]
    buffer_load_dwordx2 v[222:223], v15, s[28:31], s79 offen offset:512 sc1
    v_mfma_f32_16x16x32_bf16 v[128:131], v[172:175], v[180:183], v[128:131]
    v_mfma_f32_16x16x32_bf16 v[124:127], v[172:175], v[176:179], v[124:127]
    s_waitcnt lgkmcnt(0)
    v_mfma_f32_16x16x32_bf16 v[16:19], a[204:207], a[220:223], v[16:19]
    s_waitcnt vmcnt(19)
    s_barrier
    v_mfma_f32_16x16x32_bf16 v[20:23], a[204:207], a[224:227], v[20:23]
    ds_read_b64_tr_b16 v[160:161], v7 offset:15360
    v_mfma_f32_16x16x32_bf16 v[24:27], a[204:207], a[228:231], v[24:27]
    ds_read_b64_tr_b16 v[162:163], v7 offset:23040
    v_mfma_f32_16x16x32_bf16 v[28:31], a[204:207], a[232:235], v[28:31]
    buffer_load_dwordx2 v[224:225], v15, s[28:31], s79 offen offset:640 sc1
    v_mfma_f32_16x16x32_bf16 v[32:35], a[204:207], a[236:239], v[32:35]
    s_mov_b64 exec, s[94:95]
    ds_read_b128 v[176:179], v9 offset:53248
    s_mov_b64 exec, -1
    v_mfma_f32_16x16x32_bf16 v[36:39], a[204:207], a[240:243], v[36:39]
    ds_read_b128 v[180:183], v9 offset:36864
    v_mfma_f32_16x16x32_bf16 v[40:43], a[204:207], a[244:247], v[40:43]
    v_mfma_f32_16x16x32_bf16 v[44:47], a[204:207], a[248:251], v[44:47]
    ds_read_b128 v[184:187], v9 offset:38912
    v_mfma_f32_16x16x32_bf16 v[48:51], a[204:207], a[252:255], v[48:51]
    ds_read_b128 v[188:191], v9 offset:40960
    v_mfma_f32_16x16x32_bf16 v[84:87], a[208:211], a[252:255], v[84:87]
    buffer_load_dwordx2 v[226:227], v15, s[28:31], s79 offen offset:768 sc1
    v_mfma_f32_16x16x32_bf16 v[80:83], a[208:211], a[248:251], v[80:83]
    ds_read_b128 v[192:195], v9 offset:43008
    v_mfma_f32_16x16x32_bf16 v[76:79], a[208:211], a[244:247], v[76:79]
    ds_read_b128 v[196:199], v9 offset:45056
    v_mfma_f32_16x16x32_bf16 v[72:75], a[208:211], a[240:243], v[72:75]
    v_mfma_f32_16x16x32_bf16 v[68:71], a[208:211], a[236:239], v[68:71]
    ds_read_b128 v[200:203], v9 offset:47104
    v_mfma_f32_16x16x32_bf16 v[64:67], a[208:211], a[232:235], v[64:67]
    ds_read_b128 v[204:207], v9 offset:49152
    v_mfma_f32_16x16x32_bf16 v[60:63], a[208:211], a[228:231], v[60:63]
    buffer_load_dwordx2 v[228:229], v15, s[28:31], s79 offen offset:896 sc1
    v_mfma_f32_16x16x32_bf16 v[56:59], a[208:211], a[224:227], v[56:59]
    ds_read_b128 v[208:211], v9 offset:51200
    s_waitcnt vmcnt(12)
    v_mfma_f32_16x16x32_bf16 v[52:55], a[208:211], a[220:223], v[52:55]
    ds_read_b64_tr_b16 v[164:165], v7 offset:15392
    v_mfma_f32_16x16x32_bf16 v[88:91], a[212:215], a[220:223], v[88:91]
    s_add_u32 s100, s1, 0
    v_subrev_u32 v1, s100, v1
    v_cmp_lt_u32 vcc, 3, v1
    s_cmp_lg_u64 vcc, 0
    s_cbranch_scc1 ATT_pf_spin
ATT_pf_ok:
    v_mfma_f32_16x16x32_bf16 v[92:95], a[212:215], a[224:227], v[92:95]
    ds_read_b64_tr_b16 v[166:167], v7 offset:23072
    s_add_u32 s13, s92, 819200
    v_mfma_f32_16x16x32_bf16 v[96:99], a[212:215], a[228:231], v[96:99]
    ds_read_b64_tr_b16 v[168:169], v7 offset:15424
    v_mfma_f32_16x16x32_bf16 v[100:103], a[212:215], a[232:235], v[100:103]
    buffer_load_dwordx4 a[0:3], v14, s[28:31], s13 offen offset:0 sc1
    v_mfma_f32_16x16x32_bf16 v[104:107], a[212:215], a[236:239], v[104:107]
    ds_read_b64_tr_b16 v[170:171], v7 offset:23104
    v_mfma_f32_16x16x32_bf16 v[108:111], a[212:215], a[240:243], v[108:111]
    ds_read_b64_tr_b16 v[172:173], v252 offset:15456
    v_mfma_f32_16x16x32_bf16 v[112:115], a[212:215], a[244:247], v[112:115]
    v_mfma_f32_16x16x32_bf16 v[116:119], a[212:215], a[248:251], v[116:119]
    ds_read_b64_tr_b16 v[174:175], v252 offset:23136
    v_mfma_f32_16x16x32_bf16 v[120:123], a[212:215], a[252:255], v[120:123]
    buffer_load_dwordx4 a[4:7], v14, s[28:31], s13 offen offset:1024 sc1
    v_mfma_f32_16x16x32_bf16 v[156:159], a[216:219], a[252:255], v[156:159]
    v_mfma_f32_16x16x32_bf16 v[152:155], a[216:219], a[248:251], v[152:155]
    v_mfma_f32_16x16x32_bf16 v[148:151], a[216:219], a[244:247], v[148:151]
    v_mfma_f32_16x16x32_bf16 v[144:147], a[216:219], a[240:243], v[144:147]
    buffer_load_dwordx4 a[8:11], v14, s[28:31], s13 offen offset:2048 sc1
    v_mfma_f32_16x16x32_bf16 v[140:143], a[216:219], a[236:239], v[140:143]
    s_add_u32 s13, s92, 822272
    v_mfma_f32_16x16x32_bf16 v[136:139], a[216:219], a[232:235], v[136:139]
    v_mfma_f32_16x16x32_bf16 v[132:135], a[216:219], a[228:231], v[132:135]
    v_mfma_f32_16x16x32_bf16 v[128:131], a[216:219], a[224:227], v[128:131]
    buffer_load_dwordx4 a[12:15], v14, s[28:31], s13 offen offset:0 sc1
    v_mfma_f32_16x16x32_bf16 v[124:127], a[216:219], a[220:223], v[124:127]
    s_waitcnt lgkmcnt(0)
    v_mfma_f32_16x16x32_bf16 v[16:19], v[160:163], v[176:179], v[16:19]
    s_barrier
    v_mfma_f32_16x16x32_bf16 v[20:23], v[160:163], v[180:183], v[20:23]
    ds_read_b64_tr_b16 a[204:205], v7 offset:30720
    s_waitcnt vmcnt(4)
    v_mfma_f32_16x16x32_bf16 v[24:27], v[160:163], v[184:187], v[24:27]
    ds_read_b64_tr_b16 a[206:207], v7 offset:38400
    v_xor_b32 v230, s1, v213
    v_mfma_f32_16x16x32_bf16 v[28:31], v[160:163], v[188:191], v[28:31]
    buffer_load_dwordx4 a[16:19], v14, s[28:31], s13 offen offset:1024 sc1
    v_mfma_f32_16x16x32_bf16 v[32:35], v[160:163], v[192:195], v[32:35]
    s_mov_b64 exec, s[94:95]
    ds_read_b128 a[220:223], v10 offset:53248
    s_mov_b64 exec, -1
    v_mfma_f32_16x16x32_bf16 v[36:39], v[160:163], v[196:199], v[36:39]
    ds_read_b128 a[224:227], v10 offset:36864
    v_bitop3_b32 v230, v215, s1, v230 bitop3:0xbe
    v_mfma_f32_16x16x32_bf16 v[40:43], v[160:163], v[200:203], v[40:43]
    v_bitop3_b32 v230, v217, s1, v230 bitop3:0xbe
    v_bitop3_b32 v230, v219, s1, v230 bitop3:0xbe
    v_mfma_f32_16x16x32_bf16 v[44:47], v[160:163], v[204:207], v[44:47]
    ds_read_b128 a[228:231], v10 offset:38912
    v_bitop3_b32 v230, v221, s1, v230 bitop3:0xbe
    v_mfma_f32_16x16x32_bf16 v[48:51], v[160:163], v[208:211], v[48:51]
    ds_read_b128 a[232:235], v10 offset:40960
    v_bitop3_b32 v230, v223, s1, v230 bitop3:0xbe
    v_mfma_f32_16x16x32_bf16 v[84:87], v[164:167], v[208:211], v[84:87]
    buffer_load_dwordx4 a[20:23], v14, s[28:31], s13 offen offset:2048 sc1
    v_mfma_f32_16x16x32_bf16 v[80:83], v[164:167], v[204:207], v[80:83]
    ds_read_b128 a[236:239], v10 offset:43008
    s_add_u32 s13, s92, 860160
    v_mfma_f32_16x16x32_bf16 v[76:79], v[164:167], v[200:203], v[76:79]
    ds_read_b128 a[240:243], v10 offset:45056
    v_bitop3_b32 v230, v225, s1, v230 bitop3:0xbe
    v_mfma_f32_16x16x32_bf16 v[72:75], v[164:167], v[196:199], v[72:75]
    v_bitop3_b32 v230, v227, s1, v230 bitop3:0xbe
    v_bitop3_b32 v230, v229, s1, v230 bitop3:0xbe
    v_mfma_f32_16x16x32_bf16 v[68:71], v[164:167], v[192:195], v[68:71]
    ds_read_b128 a[244:247], v10 offset:47104
    v_mfma_f32_16x16x32_bf16 v[64:67], v[164:167], v[188:191], v[64:67]
    ds_read_b128 a[248:251], v10 offset:49152
    v_mfma_f32_16x16x32_bf16 v[60:63], v[164:167], v[184:187], v[60:63]
    buffer_load_dwordx4 a[24:27], v14, s[28:31], s13 offen offset:0 sc1
    v_mfma_f32_16x16x32_bf16 v[56:59], v[164:167], v[180:183], v[56:59]
    ds_read_b128 a[252:255], v10 offset:51200
    v_mfma_f32_16x16x32_bf16 v[52:55], v[164:167], v[176:179], v[52:55]
    ds_read_b64_tr_b16 a[208:209], v7 offset:30752
    v_mfma_f32_16x16x32_bf16 v[88:91], v[168:171], v[176:179], v[88:91]
    v_cmp_ne_u32 vcc, 0, v230
    s_cmp_lg_u64 vcc, 0
    s_cbranch_scc1 STA_spin
STA_ok:
    v_mfma_f32_16x16x32_bf16 v[92:95], v[168:171], v[180:183], v[92:95]
    ds_read_b64_tr_b16 a[210:211], v7 offset:38432
    v_and_b32 v213, 0xffff0000, v212
    v_mfma_f32_16x16x32_bf16 v[96:99], v[168:171], v[184:187], v[96:99]
    ds_read_b64_tr_b16 a[212:213], v7 offset:30784
    v_and_b32 v215, 0xffff0000, v214
    v_mfma_f32_16x16x32_bf16 v[100:103], v[168:171], v[188:191], v[100:103]
    buffer_load_dwordx4 a[28:31], v14, s[28:31], s13 offen offset:1024 sc1
    v_mfma_f32_16x16x32_bf16 v[104:107], v[168:171], v[192:195], v[104:107]
    ds_read_b64_tr_b16 a[214:215], v7 offset:38464
    v_and_b32 v217, 0xffff0000, v216
    v_mfma_f32_16x16x32_bf16 v[108:111], v[168:171], v[196:199], v[108:111]
    ds_read_b64_tr_b16 a[216:217], v252 offset:30816
    v_and_b32 v219, 0xffff0000, v218
    v_mfma_f32_16x16x32_bf16 v[112:115], v[168:171], v[200:203], v[112:115]
    v_and_b32 v221, 0xffff0000, v220
    v_and_b32 v223, 0xffff0000, v222
    v_mfma_f32_16x16x32_bf16 v[116:119], v[168:171], v[204:207], v[116:119]
    ds_read_b64_tr_b16 a[218:219], v252 offset:38496
    v_and_b32 v225, 0xffff0000, v224
    v_mfma_f32_16x16x32_bf16 v[120:123], v[168:171], v[208:211], v[120:123]
    buffer_load_dwordx4 a[32:35], v14, s[28:31], s13 offen offset:2048 sc1
    v_mfma_f32_16x16x32_bf16 v[156:159], v[172:175], v[208:211], v[156:159]
    s_add_u32 s13, s92, 863232
    v_and_b32 v227, 0xffff0000, v226
    v_mfma_f32_16x16x32_bf16 v[152:155], v[172:175], v[204:207], v[152:155]
    v_and_b32 v229, 0xffff0000, v228
    v_lshlrev_b32 v212, 16, v212
    v_mfma_f32_16x16x32_bf16 v[148:151], v[172:175], v[200:203], v[148:151]
    v_lshlrev_b32 v214, 16, v214
    v_lshlrev_b32 v216, 16, v216
    v_mfma_f32_16x16x32_bf16 v[144:147], v[172:175], v[196:199], v[144:147]
    buffer_load_dwordx4 a[36:39], v14, s[28:31], s13 offen offset:0 sc1
    v_mfma_f32_16x16x32_bf16 v[140:143], v[172:175], v[192:195], v[140:143]
    v_lshlrev_b32 v218, 16, v218
    v_lshlrev_b32 v220, 16, v220
    v_mfma_f32_16x16x32_bf16 v[136:139], v[172:175], v[188:191], v[136:139]
    v_lshlrev_b32 v222, 16, v222
    v_lshlrev_b32 v224, 16, v224
    v_mfma_f32_16x16x32_bf16 v[132:135], v[172:175], v[184:187], v[132:135]
    v_lshlrev_b32 v226, 16, v226
    v_lshlrev_b32 v228, 16, v228
    v_mfma_f32_16x16x32_bf16 v[128:131], v[172:175], v[180:183], v[128:131]
    buffer_load_dwordx4 a[40:43], v14, s[28:31], s13 offen offset:1024 sc1
    v_mfma_f32_16x16x32_bf16 v[124:127], v[172:175], v[176:179], v[124:127]
    s_waitcnt lgkmcnt(0)
    v_mfma_f32_16x16x32_bf16 v[16:19], a[204:207], a[220:223], v[16:19]
    s_barrier
    v_mfma_f32_16x16x32_bf16 v[20:23], a[204:207], a[224:227], v[20:23]
    ds_read_b64_tr_b16 v[160:161], v8 offset:0
    v_mfma_f32_16x16x32_bf16 v[24:27], a[204:207], a[228:231], v[24:27]
    ds_read_b64_tr_b16 v[162:163], v8 offset:7680
    v_mfma_f32_16x16x32_bf16 v[28:31], a[204:207], a[232:235], v[28:31]
    buffer_load_dwordx4 a[44:47], v14, s[28:31], s13 offen offset:2048 sc1
    v_mfma_f32_16x16x32_bf16 v[32:35], a[204:207], a[236:239], v[32:35]
    s_mov_b64 exec, s[94:95]
    ds_read_b128 v[176:179], v9 offset:16384
    s_mov_b64 exec, -1
    v_mfma_f32_16x16x32_bf16 v[36:39], a[204:207], a[240:243], v[36:39]
    ds_read_b128 v[180:183], v9 offset:0
    s_add_u32 s13, s92, 1064960
    v_mfma_f32_16x16x32_bf16 v[40:43], a[204:207], a[244:247], v[40:43]
    v_rcp_f32 v213, v213
    v_mfma_f32_16x16x32_bf16 v[44:47], a[204:207], a[248:251], v[44:47]
    ds_read_b128 v[184:187], v9 offset:2048
    v_mul_f32 v212, v212, v213
    v_mfma_f32_16x16x32_bf16 v[48:51], a[204:207], a[252:255], v[48:51]
    ds_read_b128 v[188:191], v9 offset:4096
    v_mfma_f32_16x16x32_bf16 v[84:87], a[208:211], a[252:255], v[84:87]
    buffer_load_dwordx4 a[48:51], v14, s[28:31], s13 offen offset:0 sc1
    v_mfma_f32_16x16x32_bf16 v[80:83], a[208:211], a[248:251], v[80:83]
    ds_read_b128 v[192:195], v9 offset:6144
    v_mfma_f32_16x16x32_bf16 v[76:79], a[208:211], a[244:247], v[76:79]
    ds_read_b128 v[196:199], v9 offset:8192
    v_mfma_f32_16x16x32_bf16 v[72:75], a[208:211], a[240:243], v[72:75]
    v_rcp_f32 v215, v215
    v_mfma_f32_16x16x32_bf16 v[68:71], a[208:211], a[236:239], v[68:71]
    ds_read_b128 v[200:203], v9 offset:10240
    v_mul_f32 v214, v214, v215
    v_mfma_f32_16x16x32_bf16 v[64:67], a[208:211], a[232:235], v[64:67]
    ds_read_b128 v[204:207], v9 offset:12288
    v_mfma_f32_16x16x32_bf16 v[60:63], a[208:211], a[228:231], v[60:63]
    buffer_load_dwordx4 a[52:55], v14, s[28:31], s13 offen offset:1024 sc1
    v_mfma_f32_16x16x32_bf16 v[56:59], a[208:211], a[224:227], v[56:59]
    ds_read_b128 v[208:211], v9 offset:14336
    v_mfma_f32_16x16x32_bf16 v[52:55], a[208:211], a[220:223], v[52:55]
    ds_read_b64_tr_b16 v[164:165], v8 offset:32
    v_mfma_f32_16x16x32_bf16 v[88:91], a[212:215], a[220:223], v[88:91]
    v_rcp_f32 v217, v217
    v_mfma_f32_16x16x32_bf16 v[92:95], a[212:215], a[224:227], v[92:95]
    ds_read_b64_tr_b16 v[166:167], v8 offset:7712
    v_mul_f32 v216, v216, v217
    v_mfma_f32_16x16x32_bf16 v[96:99], a[212:215], a[228:231], v[96:99]
    ds_read_b64_tr_b16 v[168:169], v8 offset:64
    v_mfma_f32_16x16x32_bf16 v[100:103], a[212:215], a[232:235], v[100:103]
    buffer_load_dwordx4 a[56:59], v14, s[28:31], s13 offen offset:2048 sc1
    v_mfma_f32_16x16x32_bf16 v[104:107], a[212:215], a[236:239], v[104:107]
    ds_read_b64_tr_b16 v[170:171], v8 offset:7744
    s_add_u32 s13, s92, 1068032
    v_mfma_f32_16x16x32_bf16 v[108:111], a[212:215], a[240:243], v[108:111]
    ds_read_b64_tr_b16 v[172:173], v253 offset:96
    v_mfma_f32_16x16x32_bf16 v[112:115], a[212:215], a[244:247], v[112:115]
    v_rcp_f32 v219, v219
    v_mfma_f32_16x16x32_bf16 v[116:119], a[212:215], a[248:251], v[116:119]
    ds_read_b64_tr_b16 v[174:175], v253 offset:7776
    v_mul_f32 v218, v218, v219
    v_mfma_f32_16x16x32_bf16 v[120:123], a[212:215], a[252:255], v[120:123]
    buffer_load_dwordx4 a[60:63], v14, s[28:31], s13 offen offset:0 sc1
    v_mfma_f32_16x16x32_bf16 v[156:159], a[216:219], a[252:255], v[156:159]
    v_rcp_f32 v221, v221
    v_mfma_f32_16x16x32_bf16 v[152:155], a[216:219], a[248:251], v[152:155]
    v_rcp_f32 v223, v223
    v_mfma_f32_16x16x32_bf16 v[148:151], a[216:219], a[244:247], v[148:151]
    v_rcp_f32 v225, v225
    v_mfma_f32_16x16x32_bf16 v[144:147], a[216:219], a[240:243], v[144:147]
    buffer_load_dwordx4 a[64:67], v14, s[28:31], s13 offen offset:1024 sc1
    v_mfma_f32_16x16x32_bf16 v[140:143], a[216:219], a[236:239], v[140:143]
    v_rcp_f32 v227, v227
    v_mfma_f32_16x16x32_bf16 v[136:139], a[216:219], a[232:235], v[136:139]
    v_rcp_f32 v229, v229
    v_mfma_f32_16x16x32_bf16 v[132:135], a[216:219], a[228:231], v[132:135]
    v_mul_f32 v220, v220, v221
    v_mul_f32 v222, v222, v223
    v_mfma_f32_16x16x32_bf16 v[128:131], a[216:219], a[224:227], v[128:131]
    buffer_load_dwordx4 a[68:71], v14, s[28:31], s13 offen offset:2048 sc1
    v_mfma_f32_16x16x32_bf16 v[124:127], a[216:219], a[220:223], v[124:127]
    s_add_u32 s13, s92, 1105920
    s_waitcnt lgkmcnt(0)
    v_mfma_f32_16x16x32_bf16 v[16:19], v[160:163], v[176:179], v[16:19]
    s_barrier
    v_mfma_f32_16x16x32_bf16 v[20:23], v[160:163], v[180:183], v[20:23]
    ds_read_b64_tr_b16 a[204:205], v8 offset:15360
    v_mul_f32 v224, v224, v225
    v_mfma_f32_16x16x32_bf16 v[24:27], v[160:163], v[184:187], v[24:27]
    ds_read_b64_tr_b16 a[206:207], v8 offset:23040
    v_mul_f32 v226, v226, v227
    v_mfma_f32_16x16x32_bf16 v[28:31], v[160:163], v[188:191], v[28:31]
    buffer_load_dwordx4 a[72:75], v14, s[28:31], s13 offen offset:0 sc1
    v_mfma_f32_16x16x32_bf16 v[32:35], v[160:163], v[192:195], v[32:35]
    s_mov_b64 exec, s[94:95]
    ds_read_b128 a[220:223], v10 offset:16384
    s_mov_b64 exec, -1
    v_mfma_f32_16x16x32_bf16 v[36:39], v[160:163], v[196:199], v[36:39]
    ds_read_b128 a[224:227], v10 offset:0
    v_mul_f32 v228, v228, v229
    v_mfma_f32_16x16x32_bf16 v[40:43], v[160:163], v[200:203], v[40:43]
    v_subrev_u32 v254, 1, v234
    v_ashrrev_i32 v254, 31, v254
    v_mfma_f32_16x16x32_bf16 v[44:47], v[160:163], v[204:207], v[44:47]
    ds_read_b128 a[228:231], v10 offset:2048
    v_subrev_u32 v255, 2, v234
    v_mfma_f32_16x16x32_bf16 v[48:51], v[160:163], v[208:211], v[48:51]
    ds_read_b128 a[232:235], v10 offset:4096
    v_ashrrev_i32 v255, 31, v255
    v_mfma_f32_16x16x32_bf16 v[84:87], v[164:167], v[208:211], v[84:87]
    buffer_load_dwordx4 a[76:79], v14, s[28:31], s13 offen offset:1024 sc1
    v_mfma_f32_16x16x32_bf16 v[80:83], v[164:167], v[204:207], v[80:83]
    ds_read_b128 a[236:239], v10 offset:6144
    v_subrev_u32 v1, 3, v234
    v_mfma_f32_16x16x32_bf16 v[76:79], v[164:167], v[200:203], v[76:79]
    ds_read_b128 a[240:243], v10 offset:8192
    v_ashrrev_i32 v1, 31, v1
    v_mfma_f32_16x16x32_bf16 v[72:75], v[164:167], v[196:199], v[72:75]
    v_mfma_f32_16x16x32_bf16 v[68:71], v[164:167], v[192:195], v[68:71]
    ds_read_b128 a[244:247], v10 offset:10240
    v_mfma_f32_16x16x32_bf16 v[64:67], v[164:167], v[188:191], v[64:67]
    ds_read_b128 a[248:251], v10 offset:12288
    v_mfma_f32_16x16x32_bf16 v[60:63], v[164:167], v[184:187], v[60:63]
    buffer_load_dwordx4 a[80:83], v14, s[28:31], s13 offen offset:2048 sc1
    v_mfma_f32_16x16x32_bf16 v[56:59], v[164:167], v[180:183], v[56:59]
    ds_read_b128 a[252:255], v10 offset:14336
    s_add_u32 s13, s92, 1108992
    v_mfma_f32_16x16x32_bf16 v[52:55], v[164:167], v[176:179], v[52:55]
    ds_read_b64_tr_b16 a[208:209], v8 offset:15392
    v_mfma_f32_16x16x32_bf16 v[88:91], v[168:171], v[176:179], v[88:91]
    v_mfma_f32_16x16x32_bf16 v[92:95], v[168:171], v[180:183], v[92:95]
    ds_read_b64_tr_b16 a[210:211], v8 offset:23072
    v_mfma_f32_16x16x32_bf16 v[96:99], v[168:171], v[184:187], v[96:99]
    ds_read_b64_tr_b16 a[212:213], v8 offset:15424
    v_mfma_f32_16x16x32_bf16 v[100:103], v[168:171], v[188:191], v[100:103]
    buffer_load_dwordx4 a[84:87], v14, s[28:31], s13 offen offset:0 sc1
    v_mfma_f32_16x16x32_bf16 v[104:107], v[168:171], v[192:195], v[104:107]
    ds_read_b64_tr_b16 a[214:215], v8 offset:23104
    v_mfma_f32_16x16x32_bf16 v[108:111], v[168:171], v[196:199], v[108:111]
    ds_read_b64_tr_b16 a[216:217], v253 offset:15456
    v_mfma_f32_16x16x32_bf16 v[112:115], v[168:171], v[200:203], v[112:115]
    v_mfma_f32_16x16x32_bf16 v[116:119], v[168:171], v[204:207], v[116:119]
    ds_read_b64_tr_b16 a[218:219], v253 offset:23136
    v_mfma_f32_16x16x32_bf16 v[120:123], v[168:171], v[208:211], v[120:123]
    buffer_load_dwordx4 a[88:91], v14, s[28:31], s13 offen offset:1024 sc1
    v_mfma_f32_16x16x32_bf16 v[156:159], v[172:175], v[208:211], v[156:159]
    v_mfma_f32_16x16x32_bf16 v[152:155], v[172:175], v[204:207], v[152:155]
    v_mfma_f32_16x16x32_bf16 v[148:151], v[172:175], v[200:203], v[148:151]
    v_mfma_f32_16x16x32_bf16 v[144:147], v[172:175], v[196:199], v[144:147]
    buffer_load_dwordx4 a[92:95], v14, s[28:31], s13 offen offset:2048 sc1
    v_mfma_f32_16x16x32_bf16 v[140:143], v[172:175], v[192:195], v[140:143]
    s_add_u32 s13, s92, 901120
    v_mfma_f32_16x16x32_bf16 v[136:139], v[172:175], v[188:191], v[136:139]
    v_mfma_f32_16x16x32_bf16 v[132:135], v[172:175], v[184:187], v[132:135]
    v_mfma_f32_16x16x32_bf16 v[128:131], v[172:175], v[180:183], v[128:131]
    buffer_load_dwordx4 a[96:99], v14, s[28:31], s13 offen offset:0 sc1
    v_mfma_f32_16x16x32_bf16 v[124:127], v[172:175], v[176:179], v[124:127]
    s_waitcnt lgkmcnt(0)
    v_mfma_f32_16x16x32_bf16 v[16:19], a[204:207], a[220:223], v[16:19]
    s_barrier
    v_mfma_f32_16x16x32_bf16 v[20:23], a[204:207], a[224:227], v[20:23]
    v_mfma_f32_16x16x32_bf16 v[24:27], a[204:207], a[228:231], v[24:27]
    buffer_load_dwordx4 a[100:103], v14, s[28:31], s13 offen offset:1024 sc1
    v_mfma_f32_16x16x32_bf16 v[28:31], a[204:207], a[232:235], v[28:31]
    v_mfma_f32_16x16x32_bf16 v[32:35], a[204:207], a[236:239], v[32:35]
    v_mfma_f32_16x16x32_bf16 v[36:39], a[204:207], a[240:243], v[36:39]
    v_mfma_f32_16x16x32_bf16 v[40:43], a[204:207], a[244:247], v[40:43]
    buffer_load_dwordx4 a[104:107], v14, s[28:31], s13 offen offset:2048 sc1
    v_mfma_f32_16x16x32_bf16 v[44:47], a[204:207], a[248:251], v[44:47]
    s_add_u32 s13, s92, 904192
    v_mfma_f32_16x16x32_bf16 v[48:51], a[204:207], a[252:255], v[48:51]
    v_mfma_f32_16x16x32_bf16 v[52:55], a[208:211], a[220:223], v[52:55]
    v_mov_b32_dpp v248, v16 row_newbcast:0 row_mask:0xf bank_mask:0xf
    v_mov_b32_dpp v249, v17 row_newbcast:0 row_mask:0xf bank_mask:0xf
    v_mfma_f32_16x16x32_bf16 v[56:59], a[208:211], a[224:227], v[56:59]
    v_mov_b32_dpp v250, v18 row_newbcast:0 row_mask:0xf bank_mask:0xf
    v_mov_b32_dpp v251, v19 row_newbcast:0 row_mask:0xf bank_mask:0xf
    v_mfma_f32_16x16x32_bf16 v[60:63], a[208:211], a[228:231], v[60:63]
    v_mul_f32 v16, v16, v213
    v_mul_f32 v17, v17, v213
    v_mfma_f32_16x16x32_bf16 v[64:67], a[208:211], a[232:235], v[64:67]
    v_mfma_f32_16x16x32_bf16 v[68:71], a[208:211], a[236:239], v[68:71]
    v_mul_f32 v18, v18, v213
    v_mul_f32 v19, v19, v213
    v_mfma_f32_16x16x32_bf16 v[72:75], a[208:211], a[240:243], v[72:75]
    v_fmac_f32 v16, v248, v212
    v_fmac_f32 v17, v249, v212
    v_mfma_f32_16x16x32_bf16 v[76:79], a[208:211], a[244:247], v[76:79]
    v_fmac_f32 v18, v250, v212
    v_fmac_f32 v19, v251, v212
    v_mfma_f32_16x16x32_bf16 v[80:83], a[208:211], a[248:251], v[80:83]
    buffer_load_dwordx4 a[108:111], v14, s[28:31], s13 offen offset:0 sc1
    v_mfma_f32_16x16x32_bf16 v[84:87], a[208:211], a[252:255], v[84:87]
    v_cvt_pk_bf16_f32 v16, v16, v17
    v_cvt_pk_bf16_f32 v17, v18, v19
    v_mfma_f32_16x16x32_bf16 v[88:91], a[212:215], a[220:223], v[88:91]
    ds_write_b64 v235, v[16:17] offset:0
    v_mul_f32 v20, v20, v215
    v_mfma_f32_16x16x32_bf16 v[92:95], a[212:215], a[224:227], v[92:95]
    v_mul_f32 v21, v21, v215
    v_mul_f32 v22, v22, v215
    v_mfma_f32_16x16x32_bf16 v[96:99], a[212:215], a[228:231], v[96:99]
    v_mfma_f32_16x16x32_bf16 v[100:103], a[212:215], a[232:235], v[100:103]
    v_mul_f32 v23, v23, v215
    v_fmac_f32 v20, v248, v214
    v_mfma_f32_16x16x32_bf16 v[104:107], a[212:215], a[236:239], v[104:107]
    v_fmac_f32 v21, v249, v214
    v_fmac_f32 v22, v250, v214
    v_mfma_f32_16x16x32_bf16 v[108:111], a[212:215], a[240:243], v[108:111]
    v_fmac_f32 v23, v251, v214
    v_cvt_pk_bf16_f32 v20, v20, v21
    v_mfma_f32_16x16x32_bf16 v[112:115], a[212:215], a[244:247], v[112:115]
    v_mfma_f32_16x16x32_bf16 v[116:119], a[212:215], a[248:251], v[116:119]
    v_cvt_pk_bf16_f32 v21, v22, v23
    ds_write_b64 v235, v[20:21] offset:7936
    v_mfma_f32_16x16x32_bf16 v[120:123], a[212:215], a[252:255], v[120:123]
    v_mul_f32 v24, v24, v217
    v_mul_f32 v25, v25, v217
    v_mfma_f32_16x16x32_bf16 v[124:127], a[216:219], a[220:223], v[124:127]
    v_mul_f32 v26, v26, v217
    v_mul_f32 v27, v27, v217
    v_mfma_f32_16x16x32_bf16 v[128:131], a[216:219], a[224:227], v[128:131]
    v_mfma_f32_16x16x32_bf16 v[132:135], a[216:219], a[228:231], v[132:135]
    v_fmac_f32 v24, v248, v216
    v_fmac_f32 v25, v249, v216
    v_mfma_f32_16x16x32_bf16 v[136:139], a[216:219], a[232:235], v[136:139]
    v_fmac_f32 v26, v250, v216
    v_fmac_f32 v27, v251, v216
    v_mfma_f32_16x16x32_bf16 v[140:143], a[216:219], a[236:239], v[140:143]
    v_cvt_pk_bf16_f32 v24, v24, v25
    v_cvt_pk_bf16_f32 v25, v26, v27
    v_mfma_f32_16x16x32_bf16 v[144:147], a[216:219], a[240:243], v[144:147]
    buffer_load_dwordx4 a[112:115], v14, s[28:31], s13 offen offset:1024 sc1
    v_mfma_f32_16x16x32_bf16 v[148:151], a[216:219], a[244:247], v[148:151]
    ds_write_b64 v235, v[24:25] offset:15872
    v_mul_f32 v28, v28, v219
    v_mfma_f32_16x16x32_bf16 v[152:155], a[216:219], a[248:251], v[152:155]
    v_mul_f32 v29, v29, v219
    v_mul_f32 v30, v30, v219
    v_mfma_f32_16x16x32_bf16 v[156:159], a[216:219], a[252:255], v[156:159]
    v_mul_f32 v31, v31, v219
    v_fmac_f32 v28, v248, v218
    s_mul_i32 s12, s32, 15360
    s_add_u32 s12, s12, 94208
    s_cmp_eq_u32 s32, 3
    s_cselect_b32 s68, 0x30000, 0
    v_add_u32 v13, s68, v235
    v_fmac_f32 v29, v249, v218
    buffer_load_dwordx4 a[116:119], v14, s[28:31], s13 offen offset:2048 sc1
    v_fmac_f32 v30, v250, v218
    v_fmac_f32 v31, v251, v218
    v_cvt_pk_bf16_f32 v28, v28, v29
    v_cvt_pk_bf16_f32 v29, v30, v31
    ds_write_b64 v235, v[28:29] offset:23808
    v_mul_f32 v32, v32, v221
    v_mul_f32 v33, v33, v221
    v_mul_f32 v34, v34, v221
    s_add_u32 s13, s92, 942080
    buffer_load_dwordx4 a[120:123], v14, s[28:31], s13 offen offset:0 sc1
    v_mul_f32 v35, v35, v221
    v_fmac_f32 v32, v248, v220
    v_fmac_f32 v33, v249, v220
    v_fmac_f32 v34, v250, v220
    v_fmac_f32 v35, v251, v220
    v_cvt_pk_bf16_f32 v32, v32, v33
    v_cvt_pk_bf16_f32 v33, v34, v35
    ds_write_b64 v235, v[32:33] offset:31744
    buffer_load_dwordx4 a[124:127], v14, s[28:31], s13 offen offset:1024 sc1
    v_pk_mul_f32 v[36:37], v[36:37], v[222:223] op_sel:[0,1] op_sel_hi:[1,1]
    v_pk_mul_f32 v[38:39], v[38:39], v[222:223] op_sel:[0,1] op_sel_hi:[1,1]
    v_pk_fma_f32 v[36:37], v[248:249], v[222:223], v[36:37] op_sel_hi:[1,0,1]
    v_pk_fma_f32 v[38:39], v[250:251], v[222:223], v[38:39] op_sel_hi:[1,0,1]
    v_cvt_pk_bf16_f32 v36, v36, v37
    v_cvt_pk_bf16_f32 v37, v38, v39
    ds_write_b64 v235, v[36:37] offset:39680
    v_pk_mul_f32 v[40:41], v[40:41], v[224:225] op_sel:[0,1] op_sel_hi:[1,1]
    buffer_load_dwordx4 a[128:131], v14, s[28:31], s13 offen offset:2048 sc1
    v_pk_mul_f32 v[42:43], v[42:43], v[224:225] op_sel:[0,1] op_sel_hi:[1,1]
    v_pk_fma_f32 v[40:41], v[248:249], v[224:225], v[40:41] op_sel_hi:[1,0,1]
    v_pk_fma_f32 v[42:43], v[250:251], v[224:225], v[42:43] op_sel_hi:[1,0,1]
    v_cvt_pk_bf16_f32 v40, v40, v41
    v_cvt_pk_bf16_f32 v41, v42, v43
    ds_write_b64 v235, v[40:41] offset:47616
    v_pk_mul_f32 v[44:45], v[44:45], v[226:227] op_sel:[0,1] op_sel_hi:[1,1]
    v_pk_mul_f32 v[46:47], v[46:47], v[226:227] op_sel:[0,1] op_sel_hi:[1,1]
    s_add_u32 s13, s92, 945152
    buffer_load_dwordx4 a[132:135], v14, s[28:31], s13 offen offset:0 sc1
    v_pk_fma_f32 v[44:45], v[248:249], v[226:227], v[44:45] op_sel_hi:[1,0,1]
    v_pk_fma_f32 v[46:47], v[250:251], v[226:227], v[46:47] op_sel_hi:[1,0,1]
    v_cvt_pk_bf16_f32 v44, v44, v45
    v_cvt_pk_bf16_f32 v45, v46, v47
    ds_write_b64 v235, v[44:45] offset:55552
    v_pk_mul_f32 v[48:49], v[48:49], v[228:229] op_sel:[0,1] op_sel_hi:[1,1]
    v_pk_mul_f32 v[50:51], v[50:51], v[228:229] op_sel:[0,1] op_sel_hi:[1,1]
    v_pk_fma_f32 v[48:49], v[248:249], v[228:229], v[48:49] op_sel_hi:[1,0,1]
    buffer_load_dwordx4 a[136:139], v14, s[28:31], s13 offen offset:1024 sc1
    v_pk_fma_f32 v[50:51], v[250:251], v[228:229], v[50:51] op_sel_hi:[1,0,1]
    v_cvt_pk_bf16_f32 v48, v48, v49
    v_cvt_pk_bf16_f32 v49, v50, v51
    ds_write_b64 v235, v[48:49] offset:63488
    v_mov_b32_dpp v248, v52 row_newbcast:0 row_mask:0xf bank_mask:0xf
    v_mov_b32_dpp v249, v53 row_newbcast:0 row_mask:0xf bank_mask:0xf
    v_mov_b32_dpp v250, v54 row_newbcast:0 row_mask:0xf bank_mask:0xf
    v_mov_b32_dpp v251, v55 row_newbcast:0 row_mask:0xf bank_mask:0xf
    buffer_load_dwordx4 a[140:143], v14, s[28:31], s13 offen offset:2048 sc1
    v_pk_mul_f32 v[52:53], v[52:53], v[212:213] op_sel:[0,1] op_sel_hi:[1,1]
    v_pk_mul_f32 v[54:55], v[54:55], v[212:213] op_sel:[0,1] op_sel_hi:[1,1]
    v_pk_fma_f32 v[52:53], v[248:249], v[212:213], v[52:53] op_sel_hi:[1,0,1]
    v_pk_fma_f32 v[54:55], v[250:251], v[212:213], v[54:55] op_sel_hi:[1,0,1]
    v_cvt_pk_bf16_f32 v52, v52, v53
    v_cvt_pk_bf16_f32 v53, v54, v55
    ds_write_b64 v235, v[52:53] offset:32
    v_pk_mul_f32 v[56:57], v[56:57], v[214:215] op_sel:[0,1] op_sel_hi:[1,1]
    s_add_u32 s13, s92, 1146880
    buffer_load_dwordx4 a[144:147], v14, s[28:31], s13 offen offset:0 sc1
    v_pk_mul_f32 v[58:59], v[58:59], v[214:215] op_sel:[0,1] op_sel_hi:[1,1]
    v_pk_fma_f32 v[56:57], v[248:249], v[214:215], v[56:57] op_sel_hi:[1,0,1]
    v_pk_fma_f32 v[58:59], v[250:251], v[214:215], v[58:59] op_sel_hi:[1,0,1]
    v_cvt_pk_bf16_f32 v56, v56, v57
    v_cvt_pk_bf16_f32 v57, v58, v59
    ds_write_b64 v235, v[56:57] offset:7968
    v_pk_mul_f32 v[60:61], v[60:61], v[216:217] op_sel:[0,1] op_sel_hi:[1,1]
    v_pk_mul_f32 v[62:63], v[62:63], v[216:217] op_sel:[0,1] op_sel_hi:[1,1]
    buffer_load_dwordx4 a[148:151], v14, s[28:31], s13 offen offset:1024 sc1
    v_pk_fma_f32 v[60:61], v[248:249], v[216:217], v[60:61] op_sel_hi:[1,0,1]
    v_pk_fma_f32 v[62:63], v[250:251], v[216:217], v[62:63] op_sel_hi:[1,0,1]
    v_cvt_pk_bf16_f32 v60, v60, v61
    v_cvt_pk_bf16_f32 v61, v62, v63
    ds_write_b64 v235, v[60:61] offset:15904
    v_pk_mul_f32 v[64:65], v[64:65], v[218:219] op_sel:[0,1] op_sel_hi:[1,1]
    v_pk_mul_f32 v[66:67], v[66:67], v[218:219] op_sel:[0,1] op_sel_hi:[1,1]
    v_pk_fma_f32 v[64:65], v[248:249], v[218:219], v[64:65] op_sel_hi:[1,0,1]
    buffer_load_dwordx4 a[152:155], v14, s[28:31], s13 offen offset:2048 sc1
    v_pk_fma_f32 v[66:67], v[250:251], v[218:219], v[66:67] op_sel_hi:[1,0,1]
    v_cvt_pk_bf16_f32 v64, v64, v65
    v_cvt_pk_bf16_f32 v65, v66, v67
    ds_write_b64 v235, v[64:65] offset:23840
    v_pk_mul_f32 v[68:69], v[68:69], v[220:221] op_sel:[0,1] op_sel_hi:[1,1]
    v_pk_mul_f32 v[70:71], v[70:71], v[220:221] op_sel:[0,1] op_sel_hi:[1,1]
    v_pk_fma_f32 v[68:69], v[248:249], v[220:221], v[68:69] op_sel_hi:[1,0,1]
    v_pk_fma_f32 v[70:71], v[250:251], v[220:221], v[70:71] op_sel_hi:[1,0,1]
    s_add_u32 s13, s92, 1149952
    buffer_load_dwordx4 a[156:159], v14, s[28:31], s13 offen offset:0 sc1
    v_cvt_pk_bf16_f32 v68, v68, v69
    v_cvt_pk_bf16_f32 v69, v70, v71
    ds_write_b64 v235, v[68:69] offset:31776
    v_pk_mul_f32 v[72:73], v[72:73], v[222:223] op_sel:[0,1] op_sel_hi:[1,1]
    v_pk_mul_f32 v[74:75], v[74:75], v[222:223] op_sel:[0,1] op_sel_hi:[1,1]
    v_pk_fma_f32 v[72:73], v[248:249], v[222:223], v[72:73] op_sel_hi:[1,0,1]
    v_pk_fma_f32 v[74:75], v[250:251], v[222:223], v[74:75] op_sel_hi:[1,0,1]
    v_cvt_pk_bf16_f32 v72, v72, v73
    buffer_load_dwordx4 a[160:163], v14, s[28:31], s13 offen offset:1024 sc1
    v_cvt_pk_bf16_f32 v73, v74, v75
    ds_write_b64 v235, v[72:73] offset:39712
    v_pk_mul_f32 v[76:77], v[76:77], v[224:225] op_sel:[0,1] op_sel_hi:[1,1]
    v_pk_mul_f32 v[78:79], v[78:79], v[224:225] op_sel:[0,1] op_sel_hi:[1,1]
    v_pk_fma_f32 v[76:77], v[248:249], v[224:225], v[76:77] op_sel_hi:[1,0,1]
    v_pk_fma_f32 v[78:79], v[250:251], v[224:225], v[78:79] op_sel_hi:[1,0,1]
    v_cvt_pk_bf16_f32 v76, v76, v77
    v_cvt_pk_bf16_f32 v77, v78, v79
    buffer_load_dwordx4 a[164:167], v14, s[28:31], s13 offen offset:2048 sc1
    ds_write_b64 v235, v[76:77] offset:47648
    v_pk_mul_f32 v[80:81], v[80:81], v[226:227] op_sel:[0,1] op_sel_hi:[1,1]
    v_pk_mul_f32 v[82:83], v[82:83], v[226:227] op_sel:[0,1] op_sel_hi:[1,1]
    v_pk_fma_f32 v[80:81], v[248:249], v[226:227], v[80:81] op_sel_hi:[1,0,1]
    v_pk_fma_f32 v[82:83], v[250:251], v[226:227], v[82:83] op_sel_hi:[1,0,1]
    v_cvt_pk_bf16_f32 v80, v80, v81
    v_cvt_pk_bf16_f32 v81, v82, v83
    ds_write_b64 v235, v[80:81] offset:55584
    s_add_u32 s13, s92, 1187840
    buffer_load_dwordx4 a[168:171], v14, s[28:31], s13 offen offset:0 sc1
    v_pk_mul_f32 v[84:85], v[84:85], v[228:229] op_sel:[0,1] op_sel_hi:[1,1]
    v_pk_mul_f32 v[86:87], v[86:87], v[228:229] op_sel:[0,1] op_sel_hi:[1,1]
    v_pk_fma_f32 v[84:85], v[248:249], v[228:229], v[84:85] op_sel_hi:[1,0,1]
    v_pk_fma_f32 v[86:87], v[250:251], v[228:229], v[86:87] op_sel_hi:[1,0,1]
    v_cvt_pk_bf16_f32 v84, v84, v85
    v_cvt_pk_bf16_f32 v85, v86, v87
    ds_write_b64 v235, v[84:85] offset:63520
    v_mov_b32_dpp v248, v88 row_newbcast:0 row_mask:0xf bank_mask:0xf
    buffer_load_dwordx4 a[172:175], v14, s[28:31], s13 offen offset:1024 sc1
    v_mov_b32_dpp v249, v89 row_newbcast:0 row_mask:0xf bank_mask:0xf
    v_mov_b32_dpp v250, v90 row_newbcast:0 row_mask:0xf bank_mask:0xf
    v_mov_b32_dpp v251, v91 row_newbcast:0 row_mask:0xf bank_mask:0xf
    v_pk_mul_f32 v[88:89], v[88:89], v[212:213] op_sel:[0,1] op_sel_hi:[1,1]
    v_pk_mul_f32 v[90:91], v[90:91], v[212:213] op_sel:[0,1] op_sel_hi:[1,1]
    v_pk_fma_f32 v[88:89], v[248:249], v[212:213], v[88:89] op_sel_hi:[1,0,1]
    v_pk_fma_f32 v[90:91], v[250:251], v[212:213], v[90:91] op_sel_hi:[1,0,1]
    v_cvt_pk_bf16_f32 v88, v88, v89
    buffer_load_dwordx4 a[176:179], v14, s[28:31], s13 offen offset:2048 sc1
    v_cvt_pk_bf16_f32 v89, v90, v91
    ds_write_b64 v235, v[88:89] offset:64
    v_pk_mul_f32 v[92:93], v[92:93], v[214:215] op_sel:[0,1] op_sel_hi:[1,1]
    v_pk_mul_f32 v[94:95], v[94:95], v[214:215] op_sel:[0,1] op_sel_hi:[1,1]
    v_pk_fma_f32 v[92:93], v[248:249], v[214:215], v[92:93] op_sel_hi:[1,0,1]
    v_pk_fma_f32 v[94:95], v[250:251], v[214:215], v[94:95] op_sel_hi:[1,0,1]
    v_cvt_pk_bf16_f32 v92, v92, v93
    v_cvt_pk_bf16_f32 v93, v94, v95
    s_add_u32 s13, s92, 1190912
    buffer_load_dwordx4 a[180:183], v14, s[28:31], s13 offen offset:0 sc1
    ds_write_b64 v235, v[92:93] offset:8000
    v_pk_mul_f32 v[96:97], v[96:97], v[216:217] op_sel:[0,1] op_sel_hi:[1,1]
    v_pk_mul_f32 v[98:99], v[98:99], v[216:217] op_sel:[0,1] op_sel_hi:[1,1]
    v_pk_fma_f32 v[96:97], v[248:249], v[216:217], v[96:97] op_sel_hi:[1,0,1]
    v_pk_fma_f32 v[98:99], v[250:251], v[216:217], v[98:99] op_sel_hi:[1,0,1]
    v_cvt_pk_bf16_f32 v96, v96, v97
    v_cvt_pk_bf16_f32 v97, v98, v99
    ds_write_b64 v235, v[96:97] offset:15936
    buffer_load_dwordx4 a[184:187], v14, s[28:31], s13 offen offset:1024 sc1
    v_pk_mul_f32 v[100:101], v[100:101], v[218:219] op_sel:[0,1] op_sel_hi:[1,1]
    v_pk_mul_f32 v[102:103], v[102:103], v[218:219] op_sel:[0,1] op_sel_hi:[1,1]
    v_pk_fma_f32 v[100:101], v[248:249], v[218:219], v[100:101] op_sel_hi:[1,0,1]
    v_pk_fma_f32 v[102:103], v[250:251], v[218:219], v[102:103] op_sel_hi:[1,0,1]
    v_cvt_pk_bf16_f32 v100, v100, v101
    v_cvt_pk_bf16_f32 v101, v102, v103
    ds_write_b64 v235, v[100:101] offset:23872
    v_pk_mul_f32 v[104:105], v[104:105], v[220:221] op_sel:[0,1] op_sel_hi:[1,1]
    buffer_load_dwordx4 a[188:191], v14, s[28:31], s13 offen offset:2048 sc1
    v_pk_mul_f32 v[106:107], v[106:107], v[220:221] op_sel:[0,1] op_sel_hi:[1,1]
    v_pk_fma_f32 v[104:105], v[248:249], v[220:221], v[104:105] op_sel_hi:[1,0,1]
    v_pk_fma_f32 v[106:107], v[250:251], v[220:221], v[106:107] op_sel_hi:[1,0,1]
    v_cvt_pk_bf16_f32 v104, v104, v105
    v_cvt_pk_bf16_f32 v105, v106, v107
    ds_write_b64 v235, v[104:105] offset:31808
    v_pk_mul_f32 v[108:109], v[108:109], v[222:223] op_sel:[0,1] op_sel_hi:[1,1]
    v_pk_mul_f32 v[110:111], v[110:111], v[222:223] op_sel:[0,1] op_sel_hi:[1,1]
    s_add_u32 s13, s93, 0
    buffer_load_dwordx4 a[192:195], v14, s[28:31], s13 offen offset:0 sc1
    v_pk_fma_f32 v[108:109], v[248:249], v[222:223], v[108:109] op_sel_hi:[1,0,1]
    v_pk_fma_f32 v[110:111], v[250:251], v[222:223], v[110:111] op_sel_hi:[1,0,1]
    v_cvt_pk_bf16_f32 v108, v108, v109
    v_cvt_pk_bf16_f32 v109, v110, v111
    ds_write_b64 v235, v[108:109] offset:39744
    v_pk_mul_f32 v[112:113], v[112:113], v[224:225] op_sel:[0,1] op_sel_hi:[1,1]
    v_pk_mul_f32 v[114:115], v[114:115], v[224:225] op_sel:[0,1] op_sel_hi:[1,1]
    v_pk_fma_f32 v[112:113], v[248:249], v[224:225], v[112:113] op_sel_hi:[1,0,1]
    buffer_load_dwordx4 a[196:199], v14, s[28:31], s13 offen offset:1024 sc1
    v_pk_fma_f32 v[114:115], v[250:251], v[224:225], v[114:115] op_sel_hi:[1,0,1]
    v_cvt_pk_bf16_f32 v112, v112, v113
    v_cvt_pk_bf16_f32 v113, v114, v115
    ds_write_b64 v235, v[112:113] offset:47680
    v_pk_mul_f32 v[116:117], v[116:117], v[226:227] op_sel:[0,1] op_sel_hi:[1,1]
    v_pk_mul_f32 v[118:119], v[118:119], v[226:227] op_sel:[0,1] op_sel_hi:[1,1]
    v_pk_fma_f32 v[116:117], v[248:249], v[226:227], v[116:117] op_sel_hi:[1,0,1]
    v_pk_fma_f32 v[118:119], v[250:251], v[226:227], v[118:119] op_sel_hi:[1,0,1]
    buffer_load_dwordx4 a[200:203], v14, s[28:31], s13 offen offset:2048 sc1
    v_cvt_pk_bf16_f32 v116, v116, v117
    v_cvt_pk_bf16_f32 v117, v118, v119
    ds_write_b64 v235, v[116:117] offset:55616
    v_pk_mul_f32 v[120:121], v[120:121], v[228:229] op_sel:[0,1] op_sel_hi:[1,1]
    v_pk_mul_f32 v[122:123], v[122:123], v[228:229] op_sel:[0,1] op_sel_hi:[1,1]
    v_pk_fma_f32 v[120:121], v[248:249], v[228:229], v[120:121] op_sel_hi:[1,0,1]
    v_pk_fma_f32 v[122:123], v[250:251], v[228:229], v[122:123] op_sel_hi:[1,0,1]
    v_cvt_pk_bf16_f32 v120, v120, v121
    s_add_u32 s13, s93, 3072
    buffer_load_dwordx4 a[204:207], v14, s[28:31], s13 offen offset:0 sc1
    v_cvt_pk_bf16_f32 v121, v122, v123
    ds_write_b64 v235, v[120:121] offset:63552
    v_mov_b32_dpp v248, v124 row_newbcast:0 row_mask:0xf bank_mask:0xf
    v_mov_b32_dpp v249, v125 row_newbcast:0 row_mask:0xf bank_mask:0xf
    v_mov_b32_dpp v250, v126 row_newbcast:0 row_mask:0xf bank_mask:0xf
    v_mov_b32_dpp v251, v127 row_newbcast:0 row_mask:0xf bank_mask:0xf
    v_pk_mul_f32 v[124:125], v[124:125], v[212:213] op_sel:[0,1] op_sel_hi:[1,1]
    v_pk_mul_f32 v[126:127], v[126:127], v[212:213] op_sel:[0,1] op_sel_hi:[1,1]
    buffer_load_dwordx4 a[208:211], v14, s[28:31], s13 offen offset:1024 sc1
    v_pk_fma_f32 v[124:125], v[248:249], v[212:213], v[124:125] op_sel_hi:[1,0,1]
    v_pk_fma_f32 v[126:127], v[250:251], v[212:213], v[126:127] op_sel_hi:[1,0,1]
    v_cvt_pk_bf16_f32 v124, v124, v125
    v_cvt_pk_bf16_f32 v125, v126, v127
    ds_write_b64 v13, v[124:125] offset:96
    v_pk_mul_f32 v[128:129], v[128:129], v[214:215] op_sel:[0,1] op_sel_hi:[1,1]
    v_pk_mul_f32 v[130:131], v[130:131], v[214:215] op_sel:[0,1] op_sel_hi:[1,1]
    v_pk_fma_f32 v[128:129], v[248:249], v[214:215], v[128:129] op_sel_hi:[1,0,1]
    buffer_load_dwordx4 a[212:215], v14, s[28:31], s13 offen offset:2048 sc1
    v_pk_fma_f32 v[130:131], v[250:251], v[214:215], v[130:131] op_sel_hi:[1,0,1]
    v_cvt_pk_bf16_f32 v128, v128, v129
    v_cvt_pk_bf16_f32 v129, v130, v131
    ds_write_b64 v13, v[128:129] offset:8032
    v_pk_mul_f32 v[132:133], v[132:133], v[216:217] op_sel:[0,1] op_sel_hi:[1,1]
    v_pk_mul_f32 v[134:135], v[134:135], v[216:217] op_sel:[0,1] op_sel_hi:[1,1]
    v_pk_fma_f32 v[132:133], v[248:249], v[216:217], v[132:133] op_sel_hi:[1,0,1]
    v_pk_fma_f32 v[134:135], v[250:251], v[216:217], v[134:135] op_sel_hi:[1,0,1]
    s_add_u32 s13, s93, 40960
    buffer_load_dwordx4 a[216:219], v14, s[28:31], s13 offen offset:0 sc1
    v_cvt_pk_bf16_f32 v132, v132, v133
    v_cvt_pk_bf16_f32 v133, v134, v135
    ds_write_b64 v13, v[132:133] offset:15968
    v_pk_mul_f32 v[136:137], v[136:137], v[218:219] op_sel:[0,1] op_sel_hi:[1,1]
    v_pk_mul_f32 v[138:139], v[138:139], v[218:219] op_sel:[0,1] op_sel_hi:[1,1]
    v_pk_fma_f32 v[136:137], v[248:249], v[218:219], v[136:137] op_sel_hi:[1,0,1]
    v_pk_fma_f32 v[138:139], v[250:251], v[218:219], v[138:139] op_sel_hi:[1,0,1]
    v_cvt_pk_bf16_f32 v136, v136, v137
    buffer_load_dwordx4 a[220:223], v14, s[28:31], s13 offen offset:1024 sc1
    v_cvt_pk_bf16_f32 v137, v138, v139
    ds_write_b64 v13, v[136:137] offset:23904
    v_pk_mul_f32 v[140:141], v[140:141], v[220:221] op_sel:[0,1] op_sel_hi:[1,1]
    v_pk_mul_f32 v[142:143], v[142:143], v[220:221] op_sel:[0,1] op_sel_hi:[1,1]
    v_pk_fma_f32 v[140:141], v[248:249], v[220:221], v[140:141] op_sel_hi:[1,0,1]
    v_pk_fma_f32 v[142:143], v[250:251], v[220:221], v[142:143] op_sel_hi:[1,0,1]
    v_cvt_pk_bf16_f32 v140, v140, v141
    v_cvt_pk_bf16_f32 v141, v142, v143
    buffer_load_dwordx4 a[224:227], v14, s[28:31], s13 offen offset:2048 sc1
    ds_write_b64 v13, v[140:141] offset:31840
    v_pk_mul_f32 v[144:145], v[144:145], v[222:223] op_sel:[0,1] op_sel_hi:[1,1]
    v_pk_mul_f32 v[146:147], v[146:147], v[222:223] op_sel:[0,1] op_sel_hi:[1,1]
    v_pk_fma_f32 v[144:145], v[248:249], v[222:223], v[144:145] op_sel_hi:[1,0,1]
    v_pk_fma_f32 v[146:147], v[250:251], v[222:223], v[146:147] op_sel_hi:[1,0,1]
    v_cvt_pk_bf16_f32 v144, v144, v145
    v_cvt_pk_bf16_f32 v145, v146, v147
    ds_write_b64 v13, v[144:145] offset:39776
    s_add_u32 s13, s93, 44032
    buffer_load_dwordx4 a[228:231], v14, s[28:31], s13 offen offset:0 sc1
    v_pk_mul_f32 v[148:149], v[148:149], v[224:225] op_sel:[0,1] op_sel_hi:[1,1]
    v_pk_mul_f32 v[150:151], v[150:151], v[224:225] op_sel:[0,1] op_sel_hi:[1,1]
    v_pk_fma_f32 v[148:149], v[248:249], v[224:225], v[148:149] op_sel_hi:[1,0,1]
    v_pk_fma_f32 v[150:151], v[250:251], v[224:225], v[150:151] op_sel_hi:[1,0,1]
    v_cvt_pk_bf16_f32 v148, v148, v149
    v_cvt_pk_bf16_f32 v149, v150, v151
    ds_write_b64 v13, v[148:149] offset:47712
    v_pk_mul_f32 v[152:153], v[152:153], v[226:227] op_sel:[0,1] op_sel_hi:[1,1]
    buffer_load_dwordx4 a[232:235], v14, s[28:31], s13 offen offset:1024 sc1
    v_pk_mul_f32 v[154:155], v[154:155], v[226:227] op_sel:[0,1] op_sel_hi:[1,1]
    v_pk_fma_f32 v[152:153], v[248:249], v[226:227], v[152:153] op_sel_hi:[1,0,1]
    v_pk_fma_f32 v[154:155], v[250:251], v[226:227], v[154:155] op_sel_hi:[1,0,1]
    v_cvt_pk_bf16_f32 v152, v152, v153
    v_cvt_pk_bf16_f32 v153, v154, v155
    ds_write_b64 v13, v[152:153] offset:55648
    v_pk_mul_f32 v[156:157], v[156:157], v[228:229] op_sel:[0,1] op_sel_hi:[1,1]
    v_pk_mul_f32 v[158:159], v[158:159], v[228:229] op_sel:[0,1] op_sel_hi:[1,1]
    buffer_load_dwordx4 a[236:239], v14, s[28:31], s13 offen offset:2048 sc1
    v_pk_fma_f32 v[156:157], v[248:249], v[228:229], v[156:157] op_sel_hi:[1,0,1]
    v_pk_fma_f32 v[158:159], v[250:251], v[228:229], v[158:159] op_sel_hi:[1,0,1]
    v_cvt_pk_bf16_f32 v156, v156, v157
    v_cvt_pk_bf16_f32 v157, v158, v159
    ds_write_b64 v13, v[156:157] offset:63584
K_att_s3:
    s_waitcnt lgkmcnt(0)
    s_barrier
    ds_read_b64 v[60:61], v232 offset:7936
    ds_read_b64 v[62:63], v232 offset:7944
    ds_read_b64 v[64:65], v232 offset:7952
    ds_read_b64 v[66:67], v232 offset:7960
    ds_read_b64 v[68:69], v232 offset:7968
    ds_read_b64 v[70:71], v232 offset:160
    ds_read_b64 v[72:73], v232 offset:168
    ds_read_b64 v[74:75], v232 offset:176
    ds_read_b64 v[76:77], v232 offset:184
    ds_read_b64 v[78:79], v232 offset:192
    ds_read_b64 v[80:81], v232 offset:4128
    ds_read_b64 v[82:83], v232 offset:4136
    ds_read_b64 v[84:85], v232 offset:4144
    ds_read_b64 v[86:87], v232 offset:4152
    ds_read_b64 v[88:89], v232 offset:4160
    ds_read_b64 v[90:91], v232 offset:8096
    ds_read_b64 v[92:93], v232 offset:8104
    ds_read_b64 v[94:95], v232 offset:8112
    ds_read_b64 v[96:97], v232 offset:8120
    ds_read_b64 v[98:99], v232 offset:8128
    ds_read_b64 a[240:241], v232 offset:15872
    ds_read_b64 a[242:243], v232 offset:15880
    ds_read_b64 a[244:245], v232 offset:15888
    ds_read_b64 a[246:247], v232 offset:15896
    ds_read_b64 a[248:249], v232 offset:15904
    ds_read_b64 v[100:101], v232 offset:12064
    ds_read_b64 v[102:103], v232 offset:12072
    ds_read_b64 v[104:105], v232 offset:12080
    ds_read_b64 v[106:107], v232 offset:12088
    ds_read_b64 v[108:109], v232 offset:12096
    ds_read_b64 v[110:111], v232 offset:16032
    ds_read_b64 v[112:113], v232 offset:16040
    ds_read_b64 v[114:115], v232 offset:16048
    ds_read_b64 v[116:117], v232 offset:16056
    ds_read_b64 v[118:119], v232 offset:16064
    s_waitcnt lgkmcnt(15)
    v_mfma_f32_4x4x4_16b_bf16 v[16:19], v[70:71], v[60:61], 0
    s_add_u32 m0, s12, 0
    s_add_u32 s69, s92, 983040
    buffer_load_dwordx4 v14, s[28:31], s69 offen offset:0 sc1 lds
    ds_read_b64_tr_b16 v[192:193], v233 offset:320
    v_mfma_f32_4x4x4_16b_bf16 v[20:23], v[80:81], v[60:61], 0
    ds_read_b64_tr_b16 v[202:203], v233 offset:4288
    v_mfma_f32_4x4x4_16b_bf16 v[24:27], v[90:91], v[60:61], 0
    ds_read_b64_tr_b16 v[212:213], v233 offset:8256
    v_mfma_f32_4x4x4_16b_bf16 v[16:19], v[72:73], v[62:63], v[16:19]
    buffer_load_dwordx4 v14, s[28:31], s69 offen offset:1024 sc1 lds
    ds_read_b64_tr_b16 v[194:195], v233 offset:328
    v_mfma_f32_4x4x4_16b_bf16 v[20:23], v[82:83], v[62:63], v[20:23]
    ds_read_b64_tr_b16 v[204:205], v233 offset:4296
    v_mfma_f32_4x4x4_16b_bf16 v[24:27], v[92:93], v[62:63], v[24:27]
    ds_read_b64_tr_b16 v[214:215], v233 offset:8264
    v_mfma_f32_4x4x4_16b_bf16 v[16:19], v[74:75], v[64:65], v[16:19]
    buffer_load_dwordx4 v14, s[28:31], s69 offen offset:2048 sc1 lds
    ds_read_b64_tr_b16 v[196:197], v233 offset:336
    v_mfma_f32_4x4x4_16b_bf16 v[20:23], v[84:85], v[64:65], v[20:23]
    ds_read_b64_tr_b16 v[206:207], v233 offset:4304
    v_mfma_f32_4x4x4_16b_bf16 v[24:27], v[94:95], v[64:65], v[24:27]
    ds_read_b64_tr_b16 v[216:217], v233 offset:8272
    v_mfma_f32_4x4x4_16b_bf16 v[16:19], v[76:77], v[66:67], v[16:19]
    s_add_u32 m0, s12, 3072
    s_add_u32 s69, s92, 986112
    buffer_load_dwordx4 v14, s[28:31], s69 offen offset:0 sc1 lds
    ds_read_b64_tr_b16 v[198:199], v233 offset:344
    v_mfma_f32_4x4x4_16b_bf16 v[20:23], v[86:87], v[66:67], v[20:23]
    ds_read_b64_tr_b16 v[208:209], v233 offset:4312
    v_mfma_f32_4x4x4_16b_bf16 v[24:27], v[96:97], v[66:67], v[24:27]
    ds_read_b64_tr_b16 v[218:219], v233 offset:8280
    v_mfma_f32_4x4x4_16b_bf16 v[16:19], v[78:79], v[68:69], v[16:19]
    buffer_load_dwordx4 v14, s[28:31], s69 offen offset:1024 sc1 lds
    ds_read_b64_tr_b16 v[200:201], v233 offset:352
    v_mfma_f32_4x4x4_16b_bf16 v[20:23], v[88:89], v[68:69], v[20:23]
    ds_read_b64_tr_b16 v[210:211], v233 offset:4320
    v_mfma_f32_4x4x4_16b_bf16 v[24:27], v[98:99], v[68:69], v[24:27]
    ds_read_b64_tr_b16 v[220:221], v233 offset:8288
    s_waitcnt lgkmcnt(15)
    v_mfma_f32_4x4x4_16b_bf16 v[38:41], v[90:91], a[240:241], 0
    buffer_load_dwordx4 v14, s[28:31], s69 offen offset:2048 sc1 lds
    v_mfma_f32_4x4x4_16b_bf16 v[42:45], v[100:101], a[240:241], 0
    ds_read_b64_tr_b16 v[222:223], v233 offset:12224
    v_mfma_f32_4x4x4_16b_bf16 v[46:49], v[110:111], a[240:241], 0
    ds_read_b64_tr_b16 v[4:5], v233 offset:16192
    v_mfma_f32_4x4x4_16b_bf16 v[38:41], v[92:93], a[242:243], v[38:41]
    s_add_u32 m0, s12, 6144
    s_add_u32 s69, s92, 1024000
    buffer_load_dwordx4 v14, s[28:31], s69 offen offset:0 sc1 lds
    v_mfma_f32_4x4x4_16b_bf16 v[42:45], v[102:103], a[242:243], v[42:45]
    ds_read_b64_tr_b16 v[224:225], v233 offset:12232
    v_mfma_f32_4x4x4_16b_bf16 v[46:49], v[112:113], a[242:243], v[46:49]
    ds_read_b64_tr_b16 v[6:7], v233 offset:16200
    v_mfma_f32_4x4x4_16b_bf16 v[38:41], v[94:95], a[244:245], v[38:41]
    buffer_load_dwordx4 v14, s[28:31], s69 offen offset:1024 sc1 lds
    v_mfma_f32_4x4x4_16b_bf16 v[42:45], v[104:105], a[244:245], v[42:45]
    ds_read_b64_tr_b16 v[226:227], v233 offset:12240
    v_mfma_f32_4x4x4_16b_bf16 v[46:49], v[114:115], a[244:245], v[46:49]
    ds_read_b64_tr_b16 v[8:9], v233 offset:16208
    v_mfma_f32_4x4x4_16b_bf16 v[38:41], v[96:97], a[246:247], v[38:41]
    buffer_load_dwordx4 v14, s[28:31], s69 offen offset:2048 sc1 lds
    v_mfma_f32_4x4x4_16b_bf16 v[42:45], v[106:107], a[246:247], v[42:45]
    ds_read_b64_tr_b16 v[228:229], v233 offset:12248
    v_mfma_f32_4x4x4_16b_bf16 v[46:49], v[116:117], a[246:247], v[46:49]
    ds_read_b64_tr_b16 v[10:11], v233 offset:16216
    v_mfma_f32_4x4x4_16b_bf16 v[38:41], v[98:99], a[248:249], v[38:41]
    s_add_u32 m0, s12, 9216
    s_add_u32 s69, s92, 1027072
    buffer_load_dwordx4 v14, s[28:31], s69 offen offset:0 sc1 lds
    v_mfma_f32_4x4x4_16b_bf16 v[42:45], v[108:109], a[248:249], v[42:45]
    ds_read_b64_tr_b16 v[230:231], v233 offset:12256
    v_mfma_f32_4x4x4_16b_bf16 v[46:49], v[118:119], a[248:249], v[46:49]
    ds_read_b64_tr_b16 v[12:13], v233 offset:16224
    s_nop 3
    s_or_b32 s68, s36, s32
    s_cmp_lg_u32 s68, 0
    s_cbranch_scc1 K_att_nomask
    v_lshlrev_b32 v34, 1, v234
    v_sub_u32 v34, v236, v34
    v_mov_b32 v35, 0xff800000
    v_cmp_gt_u32 vcc, 14, v34
    s_nop 1
    v_cndmask_b32 v17, v17, v35, vcc
    v_cmp_gt_u32 vcc, 12, v34
    s_nop 1
    v_cndmask_b32 v18, v18, v35, vcc
    v_cmp_gt_u32 vcc, 10, v34
    s_nop 1
    v_cndmask_b32 v19, v19, v35, vcc
    v_cmp_gt_u32 vcc, 8, v34
    s_nop 1
    v_cndmask_b32 v20, v20, v35, vcc
    v_cmp_gt_u32 vcc, 6, v34
    s_nop 1
    v_cndmask_b32 v21, v21, v35, vcc
    v_cmp_gt_u32 vcc, 4, v34
    s_nop 1
    v_cndmask_b32 v22, v22, v35, vcc
    v_cmp_gt_u32 vcc, 2, v34
    s_nop 1
    v_cndmask_b32 v23, v23, v35, vcc
K_att_nomask:
    s_buffer_load_dwordx4 s[56:59], s[28:31], s35 offset:0 glc
    v_bfi_b32 v17, v254, v17, v25
    v_bfi_b32 v39, v254, v39, v47
    buffer_load_dwordx4 v14, s[28:31], s69 offen offset:1024 sc1 lds
    v_bfi_b32 v18, v255, v18, v26
    v_bfi_b32 v40, v255, v40, v48
    v_bfi_b32 v19, v1, v19, v27
    v_bfi_b32 v41, v1, v41, v49
    v_max3_f32 v35, v20, v21, v22
    v_max3_f32 v57, v42, v43, v44
    v_max3_f32 v34, v17, v18, v19
    v_max3_f32 v56, v39, v40, v41
    buffer_load_dwordx4 v14, s[28:31], s69 offen offset:2048 sc1 lds
    v_max3_f32 v35, v35, v23, v24
    v_max3_f32 v57, v57, v45, v46
    v_max_f32 v34, v34, v35
    v_max_f32 v56, v56, v57
    v_mul_f32 v34, s39, v34
    v_mul_f32 v56, s39, v56
    v_fma_f32 v17, v17, s39, -v34
    v_fma_f32 v39, v39, s39, -v56
    s_add_u32 m0, s12, 12288
    s_add_u32 s69, s92, 1228800
    buffer_load_dwordx4 v14, s[28:31], s69 offen offset:0 sc1 lds
    v_fma_f32 v18, v18, s39, -v34
    v_fma_f32 v40, v40, s39, -v56
    v_fma_f32 v19, v19, s39, -v34
    v_fma_f32 v41, v41, s39, -v56
    v_fma_f32 v20, v20, s39, -v34
    v_fma_f32 v42, v42, s39, -v56
    v_fma_f32 v21, v21, s39, -v34
    v_fma_f32 v43, v43, s39, -v56
    buffer_load_dwordx4 v14, s[28:31], s69 offen offset:1024 sc1 lds
    v_fma_f32 v22, v22, s39, -v34
    v_fma_f32 v44, v44, s39, -v56
    v_fma_f32 v23, v23, s39, -v34
    v_fma_f32 v45, v45, s39, -v56
    v_fma_f32 v24, v24, s39, -v34
    v_fma_f32 v46, v46, s39, -v56
    v_exp_f32 v17, v17
    v_exp_f32 v39, v39
    buffer_load_dwordx4 v14, s[28:31], s69 offen offset:2048 sc1 lds
    v_exp_f32 v18, v18
    v_exp_f32 v40, v40
    v_exp_f32 v19, v19
    v_exp_f32 v41, v41
    v_exp_f32 v20, v20
    v_exp_f32 v42, v42
    v_exp_f32 v21, v21
    v_exp_f32 v43, v43
    s_add_u32 s13, s93, 81920
    buffer_load_dwordx4 v[120:123], v14, s[28:31], s13 offen offset:0 sc1
    v_exp_f32 v22, v22
    v_exp_f32 v44, v44
    v_exp_f32 v23, v23
    v_exp_f32 v45, v45
    v_exp_f32 v24, v24
    v_exp_f32 v46, v46
    v_add_f32 v34, v17, v18
    v_add_f32 v56, v39, v40
    buffer_load_dwordx4 v[124:127], v14, s[28:31], s13 offen offset:1024 sc1
    v_add_f32 v35, v19, v20
    v_add_f32 v57, v41, v42
    v_add_f32 v36, v21, v22
    v_add_f32 v58, v43, v44
    v_add_f32 v37, v23, v24
    v_add_f32 v59, v45, v46
    v_add_f32 v34, v34, v35
    v_add_f32 v56, v56, v57
    buffer_load_dwordx4 v[128:131], v14, s[28:31], s13 offen offset:2048 sc1
    v_add_f32 v36, v36, v37
    v_add_f32 v58, v58, v59
    v_add_f32 v34, v34, v36
    v_add_f32 v56, v56, v58
    v_rcp_f32 v34, v34
    v_rcp_f32 v56, v56
    v_mov_b32 v16, 0
    v_mov_b32 v38, 0
    s_add_u32 s13, s93, 84992
    buffer_load_dwordx4 v[132:135], v14, s[28:31], s13 offen offset:0 sc1
    v_mul_f32 v17, v17, v34
    v_mul_f32 v39, v39, v56
    v_mul_f32 v18, v18, v34
    v_mul_f32 v40, v40, v56
    v_mul_f32 v19, v19, v34
    v_mul_f32 v41, v41, v56
    v_mul_f32 v20, v20, v34
    v_mul_f32 v42, v42, v56
    buffer_load_dwordx4 v[136:139], v14, s[28:31], s13 offen offset:1024 sc1
    v_mul_f32 v21, v21, v34
    v_mul_f32 v43, v43, v56
    v_mul_f32 v22, v22, v34
    v_mul_f32 v44, v44, v56
    v_mul_f32 v23, v23, v34
    v_mul_f32 v45, v45, v56
    v_mul_f32 v24, v24, v34
    v_mul_f32 v46, v46, v56
    buffer_load_dwordx4 v[140:143], v14, s[28:31], s13 offen offset:2048 sc1
    v_bfi_b32 v25, v254, 0, v17
    v_bfi_b32 v47, v254, 0, v39
    v_and_b32 v17, v254, v17
    v_and_b32 v39, v254, v39
    v_bfi_b32 v26, v255, 0, v18
    v_bfi_b32 v48, v255, 0, v40
    v_and_b32 v18, v255, v18
    v_and_b32 v40, v255, v40
    s_add_u32 s13, s93, 122880
    buffer_load_dwordx4 v[144:147], v14, s[28:31], s13 offen offset:0 sc1
    v_bfi_b32 v27, v1, 0, v19
    v_bfi_b32 v49, v1, 0, v41
    v_and_b32 v19, v1, v19
    v_and_b32 v41, v1, v41
    v_cvt_pk_bf16_f32 v28, v16, v17
    v_cvt_pk_bf16_f32 v50, v38, v39
    v_cvt_pk_bf16_f32 v29, v18, v19
    v_cvt_pk_bf16_f32 v51, v40, v41
    buffer_load_dwordx4 v[148:151], v14, s[28:31], s13 offen offset:1024 sc1
    v_cvt_pk_bf16_f32 v30, v20, v21
    v_cvt_pk_bf16_f32 v52, v42, v43
    v_cvt_pk_bf16_f32 v31, v22, v23
    v_cvt_pk_bf16_f32 v53, v44, v45
    v_cvt_pk_bf16_f32 v32, v24, v25
    v_cvt_pk_bf16_f32 v54, v46, v47
    v_cvt_pk_bf16_f32 v33, v26, v27
    v_cvt_pk_bf16_f32 v55, v48, v49
    buffer_load_dwordx4 v[152:155], v14, s[28:31], s13 offen offset:2048 sc1
    s_waitcnt lgkmcnt(0)
    s_nop 0
    s_add_u32 s100, s1, 1
    s_sub_u32 s56, s56, s100
    s_sub_u32 s57, s57, s100
    s_sub_u32 s58, s58, s100
    s_sub_u32 s59, s59, s100
    s_max_u32 s56, s56, s57
    s_max_u32 s58, s58, s59
    s_max_u32 s56, s56, s58
    s_cmp_gt_u32 s56, 2
    s_cbranch_scc1 ATT_fe_spin
ATT_fe_ok:
    v_mfma_f32_4x4x4_16b_bf16 v[60:63], v[192:193], v[28:29], 0
    v_mfma_f32_4x4x4_16b_bf16 v[64:67], v[194:195], v[28:29], 0
    v_mfma_f32_4x4x4_16b_bf16 v[68:71], v[196:197], v[28:29], 0
    v_mfma_f32_4x4x4_16b_bf16 v[72:75], v[198:199], v[28:29], 0
    v_mfma_f32_4x4x4_16b_bf16 v[76:79], v[200:201], v[28:29], 0
    s_add_u32 s14, s32, 0
    s_and_b32 s14, s14, 3
    s_lshl_b32 s14, s14, 10
    s_add_u32 s14, s14, s77
    s_add_u32 s14, s14, 81920
    buffer_load_dwordx4 a[240:243], v14, s[28:31], s14 offen sc1
    v_mfma_f32_4x4x4_16b_bf16 v[60:63], v[202:203], v[30:31], v[60:63]
    v_mfma_f32_4x4x4_16b_bf16 v[64:67], v[204:205], v[30:31], v[64:67]
    v_mfma_f32_4x4x4_16b_bf16 v[68:71], v[206:207], v[30:31], v[68:71]
    v_mfma_f32_4x4x4_16b_bf16 v[72:75], v[208:209], v[30:31], v[72:75]
    v_mfma_f32_4x4x4_16b_bf16 v[76:79], v[210:211], v[30:31], v[76:79]
    s_add_u32 s14, s32, 1
    s_and_b32 s14, s14, 3
    s_lshl_b32 s14, s14, 10
    s_add_u32 s14, s14, s77
    s_add_u32 s14, s14, 81920
    buffer_load_dwordx4 a[244:247], v14, s[28:31], s14 offen sc1
    v_mfma_f32_4x4x4_16b_bf16 v[60:63], v[212:213], v[32:33], v[60:63]
    v_mfma_f32_4x4x4_16b_bf16 v[64:67], v[214:215], v[32:33], v[64:67]
    v_mfma_f32_4x4x4_16b_bf16 v[68:71], v[216:217], v[32:33], v[68:71]
    v_mfma_f32_4x4x4_16b_bf16 v[72:75], v[218:219], v[32:33], v[72:75]
    v_mfma_f32_4x4x4_16b_bf16 v[76:79], v[220:221], v[32:33], v[76:79]
    s_add_u32 s14, s32, 2
    s_and_b32 s14, s14, 3
    s_lshl_b32 s14, s14, 10
    s_add_u32 s14, s14, s77
    s_add_u32 s14, s14, 81920
    buffer_load_dwordx4 a[248:251], v14, s[28:31], s14 offen sc1
    v_mfma_f32_4x4x4_16b_bf16 v[80:83], v[212:213], v[50:51], 0
    v_mfma_f32_4x4x4_16b_bf16 v[84:87], v[214:215], v[50:51], 0
    v_cvt_pk_bf16_f32 v60, v60, v61
    v_mfma_f32_4x4x4_16b_bf16 v[88:91], v[216:217], v[50:51], 0
    v_cvt_pk_bf16_f32 v61, v62, v63
    v_mfma_f32_4x4x4_16b_bf16 v[92:95], v[218:219], v[50:51], 0
    ds_write_b64 v238, v[60:61] offset:0
    v_mfma_f32_4x4x4_16b_bf16 v[96:99], v[220:221], v[50:51], 0
    v_cvt_pk_bf16_f32 v64, v64, v65
    s_add_u32 s14, s32, 3
    s_and_b32 s14, s14, 3
    s_lshl_b32 s14, s14, 10
    s_add_u32 s14, s14, s77
    s_add_u32 s14, s14, 81920
    buffer_load_dwordx4 a[252:255], v14, s[28:31], s14 offen sc1
    v_mfma_f32_4x4x4_16b_bf16 v[80:83], v[222:223], v[52:53], v[80:83]
    v_cvt_pk_bf16_f32 v65, v66, v67
    v_mfma_f32_4x4x4_16b_bf16 v[84:87], v[224:225], v[52:53], v[84:87]
    ds_write_b64 v239, v[64:65] offset:0
    v_mfma_f32_4x4x4_16b_bf16 v[88:91], v[226:227], v[52:53], v[88:91]
    v_cvt_pk_bf16_f32 v68, v68, v69
    v_mfma_f32_4x4x4_16b_bf16 v[92:95], v[228:229], v[52:53], v[92:95]
    v_cvt_pk_bf16_f32 v69, v70, v71
    v_mfma_f32_4x4x4_16b_bf16 v[96:99], v[230:231], v[52:53], v[96:99]
    ds_write_b64 v240, v[68:69] offset:0
    s_add_u32 s13, s93, 125952
    buffer_load_dwordx4 v[156:159], v14, s[28:31], s13 offen offset:0 sc1
    v_mfma_f32_4x4x4_16b_bf16 v[80:83], v[4:5], v[54:55], v[80:83]
    v_cvt_pk_bf16_f32 v72, v72, v73
    v_mfma_f32_4x4x4_16b_bf16 v[84:87], v[6:7], v[54:55], v[84:87]
    v_cvt_pk_bf16_f32 v73, v74, v75
    v_mfma_f32_4x4x4_16b_bf16 v[88:91], v[8:9], v[54:55], v[88:91]
    ds_write_b64 v241, v[72:73] offset:0
    v_mfma_f32_4x4x4_16b_bf16 v[92:95], v[10:11], v[54:55], v[92:95]
    v_cvt_pk_bf16_f32 v76, v76, v77
    v_mfma_f32_4x4x4_16b_bf16 v[96:99], v[12:13], v[54:55], v[96:99]
    v_cvt_pk_bf16_f32 v77, v78, v79
    buffer_load_dwordx4 v[160:163], v14, s[28:31], s13 offen offset:1024 sc1
    ds_write_b64 v242, v[76:77] offset:0
    v_cvt_pk_bf16_f32 v80, v80, v81
    v_cvt_pk_bf16_f32 v81, v82, v83
    ds_write_b64 v238, v[80:81] offset:2560
    buffer_load_dwordx4 v[164:167], v14, s[28:31], s13 offen offset:2048 sc1
    v_cvt_pk_bf16_f32 v84, v84, v85
    v_cvt_pk_bf16_f32 v85, v86, v87
    ds_write_b64 v239, v[84:85] offset:2560
    v_cvt_pk_bf16_f32 v88, v88, v89
    v_cvt_pk_bf16_f32 v89, v90, v91
    ds_write_b64 v240, v[88:89] offset:2560
    s_add_u32 s13, s93, 163840
    buffer_load_dwordx4 v[168:171], v14, s[28:31], s13 offen offset:0 sc1
    v_cvt_pk_bf16_f32 v92, v92, v93
    v_cvt_pk_bf16_f32 v93, v94, v95
    ds_write_b64 v241, v[92:93] offset:2560
    v_cvt_pk_bf16_f32 v96, v96, v97
    v_cvt_pk_bf16_f32 v97, v98, v99
    ds_write_b64 v242, v[96:97] offset:2560
    buffer_load_dwordx4 v[172:175], v14, s[28:31], s13 offen offset:1024 sc1
    s_waitcnt lgkmcnt(0)
    ds_read_b128 v[100:103], v237 offset:0
    ds_read_b128 v[104:107], v237 offset:1024
    ds_read_b128 v[108:111], v237 offset:2048
    ds_read_b128 v[112:115], v237 offset:3072
    ds_read_b128 v[116:119], v237 offset:4096
    s_waitcnt lgkmcnt(4)
    buffer_store_dwordx4 v[100:103], v243, s[28:31], s61 offen sc1
    s_waitcnt lgkmcnt(3)
    buffer_store_dwordx4 v[104:107], v244, s[28:31], s61 offen sc1
    s_waitcnt lgkmcnt(2)
    buffer_store_dwordx4 v[108:111], v245, s[28:31], s61 offen sc1
    s_waitcnt lgkmcnt(1)
    buffer_store_dwordx4 v[112:115], v246, s[28:31], s61 offen sc1
    s_waitcnt lgkmcnt(0)
    buffer_store_dwordx4 v[116:119], v247, s[28:31], s61 offen sc1
    s_add_u32 s14, s32, 0
    s_and_b32 s14, s14, 3
    s_lshl_b32 s14, s14, 10
    v_add_u32 v3, s14, v14
    s_add_u32 s14, s32, 1
    s_and_b32 s14, s14, 3
    s_lshl_b32 s14, s14, 10
    v_add_u32 v4, s14, v14
    s_add_u32 s14, s32, 2
    s_and_b32 s14, s14, 3
    s_lshl_b32 s14, s14, 10
    v_add_u32 v5, s14, v14
    s_add_u32 s14, s32, 3
    s_and_b32 s14, s14, 3
    s_lshl_b32 s14, s14, 10
    v_add_u32 v6, s14, v14
    v_mov_b32 v7, v14
    v_add_u32 v2, s1, v2
    buffer_load_dwordx4 v[176:179], v14, s[28:31], s13 offen offset:2048 sc1
    s_add_u32 s13, s77, 86016
    buffer_load_dwordx4 v[192:195], v3, s[28:31], s13 offen sc1
    buffer_load_dwordx4 v[196:199], v4, s[28:31], s13 offen sc1
    buffer_load_dwordx4 v[200:203], v5, s[28:31], s13 offen sc1
    buffer_load_dwordx4 v[204:207], v6, s[28:31], s13 offen sc1
    s_add_u32 s13, s77, 106496
    buffer_load_dwordx4 v[208:211], v3, s[28:31], s13 offen sc1
    buffer_load_dwordx4 v[212:215], v4, s[28:31], s13 offen sc1
    buffer_load_dwordx4 v[216:219], v5, s[28:31], s13 offen sc1
    buffer_load_dwordx4 v[220:223], v6, s[28:31], s13 offen sc1
    s_waitcnt vmcnt(19)
    v_mfma_f32_16x16x32_bf16 v[24:27], a[0:3], a[240:243], 0
    v_mfma_f32_16x16x32_bf16 v[48:51], a[0:3], a[244:247], 0
    s_waitcnt vmcnt(9)
    v_mfma_f32_16x16x32_bf16 v[72:75], a[0:3], a[248:251], 0
    s_mov_b64 exec, 2
    buffer_store_dword v2, off, s[28:31], s34 sc1
    s_mov_b64 exec, -1
    v_mfma_f32_16x16x32_bf16 v[96:99], a[0:3], a[252:255], 0
    v_mfma_f32_16x16x32_bf16 v[100:103], a[4:7], a[252:255], 0
    v_mfma_f32_16x16x32_bf16 v[76:79], a[4:7], a[248:251], 0
    s_buffer_load_dwordx4 s[56:59], s[28:31], s35 offset:0 glc
    s_add_u32 s13, s77, 110592
    v_mfma_f32_16x16x32_bf16 v[52:55], a[4:7], a[244:247], 0
    v_mfma_f32_16x16x32_bf16 v[28:31], a[4:7], a[240:243], 0
    v_mfma_f32_16x16x32_bf16 v[32:35], a[8:11], a[240:243], 0
    buffer_load_dwordx4 v[224:227], v3, s[28:31], s13 offen sc1
    v_mfma_f32_16x16x32_bf16 v[56:59], a[8:11], a[244:247], 0
    v_mfma_f32_16x16x32_bf16 v[80:83], a[8:11], a[248:251], 0
    v_mfma_f32_16x16x32_bf16 v[104:107], a[8:11], a[252:255], 0
    buffer_load_dwordx4 v[228:231], v4, s[28:31], s13 offen sc1
    v_mfma_f32_16x16x32_bf16 v[108:111], a[12:15], a[252:255], 0
    v_mfma_f32_16x16x32_bf16 v[84:87], a[12:15], a[248:251], 0
    v_mfma_f32_16x16x32_bf16 v[60:63], a[12:15], a[244:247], 0
    buffer_load_dwordx4 v[232:235], v5, s[28:31], s13 offen sc1
    v_mfma_f32_16x16x32_bf16 v[36:39], a[12:15], a[240:243], 0
    v_mfma_f32_16x16x32_bf16 v[40:43], a[16:19], a[240:243], 0
    v_mfma_f32_16x16x32_bf16 v[64:67], a[16:19], a[244:247], 0
    buffer_load_dwordx4 v[236:239], v6, s[28:31], s13 offen sc1
    v_mfma_f32_16x16x32_bf16 v[88:91], a[16:19], a[248:251], 0
    v_mfma_f32_16x16x32_bf16 v[112:115], a[16:19], a[252:255], 0
    v_mfma_f32_16x16x32_bf16 v[116:119], a[20:23], a[252:255], 0
    v_mfma_f32_16x16x32_bf16 v[92:95], a[20:23], a[248:251], 0
    v_mfma_f32_16x16x32_bf16 v[68:71], a[20:23], a[244:247], 0
    v_mfma_f32_16x16x32_bf16 v[44:47], a[20:23], a[240:243], 0
    s_waitcnt vmcnt(9)
    v_mfma_f32_16x16x32_bf16 v[24:27], a[24:27], v[192:195], v[24:27]
    s_add_u32 s13, s93, 166912
    v_mfma_f32_16x16x32_bf16 v[48:51], a[24:27], v[196:199], v[48:51]
    buffer_load_dwordx4 v[180:183], v7, s[28:31], s13 offen offset:0 sc1
    v_mfma_f32_16x16x32_bf16 v[72:75], a[24:27], v[200:203], v[72:75]
    v_mfma_f32_16x16x32_bf16 v[96:99], a[24:27], v[204:207], v[96:99]
    v_mfma_f32_16x16x32_bf16 v[100:103], a[28:31], v[204:207], v[100:103]
    buffer_load_dwordx4 v[184:187], v7, s[28:31], s13 offen offset:1024 sc1
    v_mfma_f32_16x16x32_bf16 v[76:79], a[28:31], v[200:203], v[76:79]
    v_mfma_f32_16x16x32_bf16 v[52:55], a[28:31], v[196:199], v[52:55]
    v_mfma_f32_16x16x32_bf16 v[28:31], a[28:31], v[192:195], v[28:31]
    buffer_load_dwordx4 v[188:191], v7, s[28:31], s13 offen offset:2048 sc1
    v_mfma_f32_16x16x32_bf16 v[32:35], a[32:35], v[192:195], v[32:35]
    v_mfma_f32_16x16x32_bf16 v[56:59], a[32:35], v[196:199], v[56:59]
    v_mfma_f32_16x16x32_bf16 v[80:83], a[32:35], v[200:203], v[80:83]
    v_mfma_f32_16x16x32_bf16 v[104:107], a[32:35], v[204:207], v[104:107]
    v_mfma_f32_16x16x32_bf16 v[108:111], a[36:39], v[204:207], v[108:111]
    v_mfma_f32_16x16x32_bf16 v[84:87], a[36:39], v[200:203], v[84:87]
    v_mfma_f32_16x16x32_bf16 v[60:63], a[36:39], v[196:199], v[60:63]
    v_mfma_f32_16x16x32_bf16 v[36:39], a[36:39], v[192:195], v[36:39]
    v_mfma_f32_16x16x32_bf16 v[40:43], a[40:43], v[192:195], v[40:43]
    v_mfma_f32_16x16x32_bf16 v[64:67], a[40:43], v[196:199], v[64:67]
    v_mfma_f32_16x16x32_bf16 v[88:91], a[40:43], v[200:203], v[88:91]
    v_mfma_f32_16x16x32_bf16 v[112:115], a[40:43], v[204:207], v[112:115]
    v_mfma_f32_16x16x32_bf16 v[116:119], a[44:47], v[204:207], v[116:119]
    v_mfma_f32_16x16x32_bf16 v[92:95], a[44:47], v[200:203], v[92:95]
    v_mfma_f32_16x16x32_bf16 v[68:71], a[44:47], v[196:199], v[68:71]
    v_mfma_f32_16x16x32_bf16 v[44:47], a[44:47], v[192:195], v[44:47]
    s_waitcnt vmcnt(8)
    v_mfma_f32_16x16x32_bf16 v[24:27], a[48:51], v[208:211], v[24:27]
    s_waitcnt lgkmcnt(0)
    s_add_u32 s100, s1, 2
    v_mfma_f32_16x16x32_bf16 v[48:51], a[48:51], v[212:215], v[48:51]
    s_sub_u32 s56, s56, s100
    s_sub_u32 s57, s57, s100
    v_mfma_f32_16x16x32_bf16 v[72:75], a[48:51], v[216:219], v[72:75]
    s_sub_u32 s58, s58, s100
    s_sub_u32 s59, s59, s100
    v_mfma_f32_16x16x32_bf16 v[96:99], a[48:51], v[220:223], v[96:99]
    s_max_u32 s56, s56, s57
    s_max_u32 s58, s58, s59
    v_mfma_f32_16x16x32_bf16 v[100:103], a[52:55], v[220:223], v[100:103]
    s_max_u32 s56, s56, s58
    v_mfma_f32_16x16x32_bf16 v[76:79], a[52:55], v[216:219], v[76:79]
    s_cmp_gt_u32 s56, 1
    s_cbranch_scc1 P2att_f4_spin
P2att_f4_ok:
    v_mfma_f32_16x16x32_bf16 v[52:55], a[52:55], v[212:215], v[52:55]
    s_add_u32 s13, s77, 90112
    v_mfma_f32_16x16x32_bf16 v[28:31], a[52:55], v[208:211], v[28:31]
    buffer_load_dwordx4 v[240:243], v3, s[28:31], s13 offen sc1
    v_mfma_f32_16x16x32_bf16 v[32:35], a[56:59], v[208:211], v[32:35]
    v_mfma_f32_16x16x32_bf16 v[56:59], a[56:59], v[212:215], v[56:59]
    v_mfma_f32_16x16x32_bf16 v[80:83], a[56:59], v[216:219], v[80:83]
    buffer_load_dwordx4 v[244:247], v4, s[28:31], s13 offen sc1
    v_mfma_f32_16x16x32_bf16 v[104:107], a[56:59], v[220:223], v[104:107]
    v_mfma_f32_16x16x32_bf16 v[108:111], a[60:63], v[220:223], v[108:111]
    v_mfma_f32_16x16x32_bf16 v[84:87], a[60:63], v[216:219], v[84:87]
    buffer_load_dwordx4 v[248:251], v5, s[28:31], s13 offen sc1
    v_mfma_f32_16x16x32_bf16 v[60:63], a[60:63], v[212:215], v[60:63]
    v_mfma_f32_16x16x32_bf16 v[36:39], a[60:63], v[208:211], v[36:39]
    v_mfma_f32_16x16x32_bf16 v[40:43], a[64:67], v[208:211], v[40:43]
    buffer_load_dwordx4 v[252:255], v6, s[28:31], s13 offen sc1
    v_mfma_f32_16x16x32_bf16 v[64:67], a[64:67], v[212:215], v[64:67]
    s_add_u32 s13, s77, 94208
    v_mfma_f32_16x16x32_bf16 v[88:91], a[64:67], v[216:219], v[88:91]
    v_mfma_f32_16x16x32_bf16 v[112:115], a[64:67], v[220:223], v[112:115]
    buffer_load_dwordx4 a[240:243], v3, s[28:31], s13 offen sc1
    v_mfma_f32_16x16x32_bf16 v[116:119], a[68:71], v[220:223], v[116:119]
    v_mfma_f32_16x16x32_bf16 v[92:95], a[68:71], v[216:219], v[92:95]
    v_mfma_f32_16x16x32_bf16 v[68:71], a[68:71], v[212:215], v[68:71]
    buffer_load_dwordx4 a[244:247], v4, s[28:31], s13 offen sc1
    v_mfma_f32_16x16x32_bf16 v[44:47], a[68:71], v[208:211], v[44:47]
    buffer_load_dwordx4 a[248:251], v5, s[28:31], s13 offen sc1
    buffer_load_dwordx4 a[252:255], v6, s[28:31], s13 offen sc1
    s_waitcnt vmcnt(11)
    v_mfma_f32_16x16x32_bf16 v[24:27], a[72:75], v[224:227], v[24:27]
    v_mfma_f32_16x16x32_bf16 v[48:51], a[72:75], v[228:231], v[48:51]
    s_buffer_load_dwordx4 s[56:59], s[28:31], s35 offset:16 glc
    s_add_u32 s13, s77, 114688
    v_mfma_f32_16x16x32_bf16 v[72:75], a[72:75], v[232:235], v[72:75]
    v_mfma_f32_16x16x32_bf16 v[96:99], a[72:75], v[236:239], v[96:99]
    v_mfma_f32_16x16x32_bf16 v[100:103], a[76:79], v[236:239], v[100:103]
    buffer_load_dwordx4 v[192:195], v3, s[28:31], s13 offen sc1
    v_mfma_f32_16x16x32_bf16 v[76:79], a[76:79], v[232:235], v[76:79]
    v_mfma_f32_16x16x32_bf16 v[52:55], a[76:79], v[228:231], v[52:55]
    v_mfma_f32_16x16x32_bf16 v[28:31], a[76:79], v[224:227], v[28:31]
    buffer_load_dwordx4 v[196:199], v4, s[28:31], s13 offen sc1
    v_mfma_f32_16x16x32_bf16 v[32:35], a[80:83], v[224:227], v[32:35]
    v_mfma_f32_16x16x32_bf16 v[56:59], a[80:83], v[228:231], v[56:59]
    v_mfma_f32_16x16x32_bf16 v[80:83], a[80:83], v[232:235], v[80:83]
    buffer_load_dwordx4 v[200:203], v5, s[28:31], s13 offen sc1
    v_mfma_f32_16x16x32_bf16 v[104:107], a[80:83], v[236:239], v[104:107]
    v_mfma_f32_16x16x32_bf16 v[108:111], a[84:87], v[236:239], v[108:111]
    v_mfma_f32_16x16x32_bf16 v[84:87], a[84:87], v[232:235], v[84:87]
    buffer_load_dwordx4 v[204:207], v6, s[28:31], s13 offen sc1
    v_mfma_f32_16x16x32_bf16 v[60:63], a[84:87], v[228:231], v[60:63]
    v_mfma_f32_16x16x32_bf16 v[36:39], a[84:87], v[224:227], v[36:39]
    v_mfma_f32_16x16x32_bf16 v[40:43], a[88:91], v[224:227], v[40:43]
    v_mfma_f32_16x16x32_bf16 v[64:67], a[88:91], v[228:231], v[64:67]
    v_mfma_f32_16x16x32_bf16 v[88:91], a[88:91], v[232:235], v[88:91]
    v_mfma_f32_16x16x32_bf16 v[112:115], a[88:91], v[236:239], v[112:115]
    v_mfma_f32_16x16x32_bf16 v[116:119], a[92:95], v[236:239], v[116:119]
    v_mfma_f32_16x16x32_bf16 v[92:95], a[92:95], v[232:235], v[92:95]
    v_mfma_f32_16x16x32_bf16 v[68:71], a[92:95], v[228:231], v[68:71]
    v_mfma_f32_16x16x32_bf16 v[44:47], a[92:95], v[224:227], v[44:47]
    s_waitcnt vmcnt(8)
    v_mfma_f32_16x16x32_bf16 v[24:27], a[96:99], v[240:243], v[24:27]
    s_add_u32 s13, s77, 118784
    v_mfma_f32_16x16x32_bf16 v[48:51], a[96:99], v[244:247], v[48:51]
    buffer_load_dwordx4 v[208:211], v3, s[28:31], s13 offen sc1
    v_mfma_f32_16x16x32_bf16 v[72:75], a[96:99], v[248:251], v[72:75]
    v_mfma_f32_16x16x32_bf16 v[96:99], a[96:99], v[252:255], v[96:99]
    v_mfma_f32_16x16x32_bf16 v[100:103], a[100:103], v[252:255], v[100:103]
    buffer_load_dwordx4 v[212:215], v4, s[28:31], s13 offen sc1
    v_mfma_f32_16x16x32_bf16 v[76:79], a[100:103], v[248:251], v[76:79]
    v_mfma_f32_16x16x32_bf16 v[52:55], a[100:103], v[244:247], v[52:55]
    v_mfma_f32_16x16x32_bf16 v[28:31], a[100:103], v[240:243], v[28:31]
    buffer_load_dwordx4 v[216:219], v5, s[28:31], s13 offen sc1
    v_mfma_f32_16x16x32_bf16 v[32:35], a[104:107], v[240:243], v[32:35]
    v_mfma_f32_16x16x32_bf16 v[56:59], a[104:107], v[244:247], v[56:59]
    v_mfma_f32_16x16x32_bf16 v[80:83], a[104:107], v[248:251], v[80:83]
    buffer_load_dwordx4 v[220:223], v6, s[28:31], s13 offen sc1
    v_mfma_f32_16x16x32_bf16 v[104:107], a[104:107], v[252:255], v[104:107]
    s_add_u32 s13, s92, 1231872
    v_mfma_f32_16x16x32_bf16 v[108:111], a[108:111], v[252:255], v[108:111]
    v_mfma_f32_16x16x32_bf16 v[84:87], a[108:111], v[248:251], v[84:87]
    buffer_load_dwordx4 a[60:63], v7, s[28:31], s13 offen offset:0 sc1
    v_mfma_f32_16x16x32_bf16 v[60:63], a[108:111], v[244:247], v[60:63]
    v_mfma_f32_16x16x32_bf16 v[36:39], a[108:111], v[240:243], v[36:39]
    v_mfma_f32_16x16x32_bf16 v[40:43], a[112:115], v[240:243], v[40:43]
    buffer_load_dwordx4 a[64:67], v7, s[28:31], s13 offen offset:1024 sc1
    v_mfma_f32_16x16x32_bf16 v[64:67], a[112:115], v[244:247], v[64:67]
    v_mfma_f32_16x16x32_bf16 v[88:91], a[112:115], v[248:251], v[88:91]
    v_mfma_f32_16x16x32_bf16 v[112:115], a[112:115], v[252:255], v[112:115]
    buffer_load_dwordx4 a[68:71], v7, s[28:31], s13 offen offset:2048 sc1
    v_mfma_f32_16x16x32_bf16 v[116:119], a[116:119], v[252:255], v[116:119]
    v_mfma_f32_16x16x32_bf16 v[92:95], a[116:119], v[248:251], v[92:95]
    v_mfma_f32_16x16x32_bf16 v[68:71], a[116:119], v[244:247], v[68:71]
    v_mfma_f32_16x16x32_bf16 v[44:47], a[116:119], v[240:243], v[44:47]
    s_waitcnt vmcnt(11)
    v_mfma_f32_16x16x32_bf16 v[24:27], a[120:123], a[240:243], v[24:27]
    s_waitcnt lgkmcnt(0)
    s_add_u32 s100, s1, 1
    v_mfma_f32_16x16x32_bf16 v[48:51], a[120:123], a[244:247], v[48:51]
    s_sub_u32 s56, s56, s100
    s_sub_u32 s57, s57, s100
    v_mfma_f32_16x16x32_bf16 v[72:75], a[120:123], a[248:251], v[72:75]
    s_sub_u32 s58, s58, s100
    s_sub_u32 s59, s59, s100
    v_mfma_f32_16x16x32_bf16 v[96:99], a[120:123], a[252:255], v[96:99]
    s_max_u32 s56, s56, s57
    s_max_u32 s58, s58, s59
    v_mfma_f32_16x16x32_bf16 v[100:103], a[124:127], a[252:255], v[100:103]
    s_max_u32 s56, s56, s58
    v_mfma_f32_16x16x32_bf16 v[76:79], a[124:127], a[248:251], v[76:79]
    s_cmp_gt_u32 s56, 2
    s_cbranch_scc1 P2att_f8_spin
P2att_f8_ok:
    v_mfma_f32_16x16x32_bf16 v[52:55], a[124:127], a[244:247], v[52:55]
    s_add_u32 s13, s78, 0
    v_mfma_f32_16x16x32_bf16 v[28:31], a[124:127], a[240:243], v[28:31]
    buffer_load_dwordx4 v[224:227], v3, s[28:31], s13 offen sc1
    v_mfma_f32_16x16x32_bf16 v[32:35], a[128:131], a[240:243], v[32:35]
    v_mfma_f32_16x16x32_bf16 v[56:59], a[128:131], a[244:247], v[56:59]
    v_mfma_f32_16x16x32_bf16 v[80:83], a[128:131], a[248:251], v[80:83]
    buffer_load_dwordx4 v[228:231], v4, s[28:31], s13 offen sc1
    v_mfma_f32_16x16x32_bf16 v[104:107], a[128:131], a[252:255], v[104:107]
    v_mfma_f32_16x16x32_bf16 v[108:111], a[132:135], a[252:255], v[108:111]
    v_mfma_f32_16x16x32_bf16 v[84:87], a[132:135], a[248:251], v[84:87]
    buffer_load_dwordx4 v[232:235], v5, s[28:31], s13 offen sc1
    v_mfma_f32_16x16x32_bf16 v[60:63], a[132:135], a[244:247], v[60:63]
    v_mfma_f32_16x16x32_bf16 v[36:39], a[132:135], a[240:243], v[36:39]
    v_mfma_f32_16x16x32_bf16 v[40:43], a[136:139], a[240:243], v[40:43]
    buffer_load_dwordx4 v[236:239], v6, s[28:31], s13 offen sc1
    v_mfma_f32_16x16x32_bf16 v[64:67], a[136:139], a[244:247], v[64:67]
    v_mfma_f32_16x16x32_bf16 v[88:91], a[136:139], a[248:251], v[88:91]
    v_mfma_f32_16x16x32_bf16 v[112:115], a[136:139], a[252:255], v[112:115]
    v_mfma_f32_16x16x32_bf16 v[116:119], a[140:143], a[252:255], v[116:119]
    v_mfma_f32_16x16x32_bf16 v[92:95], a[140:143], a[248:251], v[92:95]
    v_mfma_f32_16x16x32_bf16 v[68:71], a[140:143], a[244:247], v[68:71]
    v_mfma_f32_16x16x32_bf16 v[44:47], a[140:143], a[240:243], v[44:47]
    s_waitcnt vmcnt(11)
    v_mfma_f32_16x16x32_bf16 v[24:27], a[144:147], v[192:195], v[24:27]
    s_add_u32 s13, s78, 4096
    v_mfma_f32_16x16x32_bf16 v[48:51], a[144:147], v[196:199], v[48:51]
    buffer_load_dwordx4 v[240:243], v3, s[28:31], s13 offen sc1
    v_mfma_f32_16x16x32_bf16 v[72:75], a[144:147], v[200:203], v[72:75]
    v_mfma_f32_16x16x32_bf16 v[96:99], a[144:147], v[204:207], v[96:99]
    v_mfma_f32_16x16x32_bf16 v[100:103], a[148:151], v[204:207], v[100:103]
    buffer_load_dwordx4 v[244:247], v4, s[28:31], s13 offen sc1
    v_mfma_f32_16x16x32_bf16 v[76:79], a[148:151], v[200:203], v[76:79]
    v_mfma_f32_16x16x32_bf16 v[52:55], a[148:151], v[196:199], v[52:55]
    v_mfma_f32_16x16x32_bf16 v[28:31], a[148:151], v[192:195], v[28:31]
    buffer_load_dwordx4 v[248:251], v5, s[28:31], s13 offen sc1
    v_mfma_f32_16x16x32_bf16 v[32:35], a[152:155], v[192:195], v[32:35]
    v_mfma_f32_16x16x32_bf16 v[56:59], a[152:155], v[196:199], v[56:59]
    v_mfma_f32_16x16x32_bf16 v[80:83], a[152:155], v[200:203], v[80:83]
    buffer_load_dwordx4 v[252:255], v6, s[28:31], s13 offen sc1
    v_mfma_f32_16x16x32_bf16 v[104:107], a[152:155], v[204:207], v[104:107]
    v_mfma_f32_16x16x32_bf16 v[108:111], a[156:159], v[204:207], v[108:111]
    v_mfma_f32_16x16x32_bf16 v[84:87], a[156:159], v[200:203], v[84:87]
    v_mfma_f32_16x16x32_bf16 v[60:63], a[156:159], v[196:199], v[60:63]
    v_mfma_f32_16x16x32_bf16 v[36:39], a[156:159], v[192:195], v[36:39]
    v_mfma_f32_16x16x32_bf16 v[40:43], a[160:163], v[192:195], v[40:43]
    v_mfma_f32_16x16x32_bf16 v[64:67], a[160:163], v[196:199], v[64:67]
    v_mfma_f32_16x16x32_bf16 v[88:91], a[160:163], v[200:203], v[88:91]
    v_mfma_f32_16x16x32_bf16 v[112:115], a[160:163], v[204:207], v[112:115]
    v_mfma_f32_16x16x32_bf16 v[116:119], a[164:167], v[204:207], v[116:119]
    v_mfma_f32_16x16x32_bf16 v[92:95], a[164:167], v[200:203], v[92:95]
    v_mfma_f32_16x16x32_bf16 v[68:71], a[164:167], v[196:199], v[68:71]
    v_mfma_f32_16x16x32_bf16 v[44:47], a[164:167], v[192:195], v[44:47]
    s_waitcnt vmcnt(11)
    v_mfma_f32_16x16x32_bf16 v[24:27], a[168:171], v[208:211], v[24:27]
    s_add_u32 s13, s78, 8192
    v_mfma_f32_16x16x32_bf16 v[48:51], a[168:171], v[212:215], v[48:51]
    buffer_load_dwordx4 a[96:99], v3, s[28:31], s13 offen sc1
    v_mfma_f32_16x16x32_bf16 v[72:75], a[168:171], v[216:219], v[72:75]
    v_add_u32 v22, s12, v7
    v_mfma_f32_16x16x32_bf16 v[96:99], a[168:171], v[220:223], v[96:99]
    ds_read_b128 a[0:3], v22 offset:0
    v_mfma_f32_16x16x32_bf16 v[100:103], a[172:175], v[220:223], v[100:103]
    buffer_load_dwordx4 a[100:103], v4, s[28:31], s13 offen sc1
    v_mfma_f32_16x16x32_bf16 v[76:79], a[172:175], v[216:219], v[76:79]
    ds_read_b128 a[4:7], v22 offset:1024
    v_mfma_f32_16x16x32_bf16 v[52:55], a[172:175], v[212:215], v[52:55]
    ds_read_b128 a[8:11], v22 offset:2048
    v_mfma_f32_16x16x32_bf16 v[28:31], a[172:175], v[208:211], v[28:31]
    buffer_load_dwordx4 a[104:107], v5, s[28:31], s13 offen sc1
    v_mfma_f32_16x16x32_bf16 v[32:35], a[176:179], v[208:211], v[32:35]
    ds_read_b128 a[12:15], v22 offset:3072
    v_mfma_f32_16x16x32_bf16 v[56:59], a[176:179], v[212:215], v[56:59]
    ds_read_b128 a[16:19], v22 offset:4096
    v_mfma_f32_16x16x32_bf16 v[80:83], a[176:179], v[216:219], v[80:83]
    buffer_load_dwordx4 a[108:111], v6, s[28:31], s13 offen sc1
    v_mfma_f32_16x16x32_bf16 v[104:107], a[176:179], v[220:223], v[104:107]
    s_add_u32 s13, s78, 12288
    v_mfma_f32_16x16x32_bf16 v[108:111], a[180:183], v[220:223], v[108:111]
    ds_read_b128 a[20:23], v22 offset:5120
    v_mfma_f32_16x16x32_bf16 v[84:87], a[180:183], v[216:219], v[84:87]
    buffer_load_dwordx4 a[240:243], v3, s[28:31], s13 offen sc1
    v_mfma_f32_16x16x32_bf16 v[60:63], a[180:183], v[212:215], v[60:63]
    ds_read_b128 a[24:27], v22 offset:6144
    v_mfma_f32_16x16x32_bf16 v[36:39], a[180:183], v[208:211], v[36:39]
    ds_read_b128 a[28:31], v22 offset:7168
    v_mfma_f32_16x16x32_bf16 v[40:43], a[184:187], v[208:211], v[40:43]
    buffer_load_dwordx4 a[244:247], v4, s[28:31], s13 offen sc1
    v_mfma_f32_16x16x32_bf16 v[64:67], a[184:187], v[212:215], v[64:67]
    v_mfma_f32_16x16x32_bf16 v[88:91], a[184:187], v[216:219], v[88:91]
    v_mfma_f32_16x16x32_bf16 v[112:115], a[184:187], v[220:223], v[112:115]
    buffer_load_dwordx4 a[248:251], v5, s[28:31], s13 offen sc1
    v_mfma_f32_16x16x32_bf16 v[116:119], a[188:191], v[220:223], v[116:119]
    v_mfma_f32_16x16x32_bf16 v[92:95], a[188:191], v[216:219], v[92:95]
    v_mfma_f32_16x16x32_bf16 v[68:71], a[188:191], v[212:215], v[68:71]
    buffer_load_dwordx4 a[252:255], v6, s[28:31], s13 offen sc1
    v_mfma_f32_16x16x32_bf16 v[44:47], a[188:191], v[208:211], v[44:47]
    s_waitcnt vmcnt(12)
    v_mfma_f32_16x16x32_bf16 v[24:27], a[192:195], v[224:227], v[24:27]
    ds_read_b128 a[32:35], v22 offset:8192
    v_mfma_f32_16x16x32_bf16 v[48:51], a[192:195], v[228:231], v[48:51]
    s_buffer_load_dwordx4 s[56:59], s[28:31], s35 offset:0 glc
    s_add_u32 s13, s78, 16384
    v_mfma_f32_16x16x32_bf16 v[72:75], a[192:195], v[232:235], v[72:75]
    ds_read_b128 a[36:39], v22 offset:9216
    v_mfma_f32_16x16x32_bf16 v[96:99], a[192:195], v[236:239], v[96:99]
    ds_read_b128 a[40:43], v22 offset:10240
    v_mfma_f32_16x16x32_bf16 v[100:103], a[196:199], v[236:239], v[100:103]
    buffer_load_dwordx4 a[120:123], v3, s[28:31], s13 offen sc1
    v_mfma_f32_16x16x32_bf16 v[76:79], a[196:199], v[232:235], v[76:79]
    ds_read_b128 a[44:47], v22 offset:11264
    v_mfma_f32_16x16x32_bf16 v[52:55], a[196:199], v[228:231], v[52:55]
    ds_read_b128 a[48:51], v22 offset:12288
    v_mfma_f32_16x16x32_bf16 v[28:31], a[196:199], v[224:227], v[28:31]
    buffer_load_dwordx4 a[124:127], v4, s[28:31], s13 offen sc1
    v_mfma_f32_16x16x32_bf16 v[32:35], a[200:203], v[224:227], v[32:35]
    ds_read_b128 a[52:55], v22 offset:13312
    v_mfma_f32_16x16x32_bf16 v[56:59], a[200:203], v[228:231], v[56:59]
    ds_read_b128 a[56:59], v22 offset:14336
    v_mfma_f32_16x16x32_bf16 v[80:83], a[200:203], v[232:235], v[80:83]
    buffer_load_dwordx4 a[128:131], v5, s[28:31], s13 offen sc1
    v_mfma_f32_16x16x32_bf16 v[104:107], a[200:203], v[236:239], v[104:107]
    v_mfma_f32_16x16x32_bf16 v[108:111], a[204:207], v[236:239], v[108:111]
    v_mfma_f32_16x16x32_bf16 v[84:87], a[204:207], v[232:235], v[84:87]
    buffer_load_dwordx4 a[132:135], v6, s[28:31], s13 offen sc1
    v_mfma_f32_16x16x32_bf16 v[60:63], a[204:207], v[228:231], v[60:63]
    v_mfma_f32_16x16x32_bf16 v[36:39], a[204:207], v[224:227], v[36:39]
    v_mfma_f32_16x16x32_bf16 v[40:43], a[208:211], v[224:227], v[40:43]
    v_mfma_f32_16x16x32_bf16 v[64:67], a[208:211], v[228:231], v[64:67]
    v_mfma_f32_16x16x32_bf16 v[88:91], a[208:211], v[232:235], v[88:91]
    v_mfma_f32_16x16x32_bf16 v[112:115], a[208:211], v[236:239], v[112:115]
    v_mfma_f32_16x16x32_bf16 v[116:119], a[212:215], v[236:239], v[116:119]
    v_mfma_f32_16x16x32_bf16 v[92:95], a[212:215], v[232:235], v[92:95]
    v_mfma_f32_16x16x32_bf16 v[68:71], a[212:215], v[228:231], v[68:71]
    v_mfma_f32_16x16x32_bf16 v[44:47], a[212:215], v[224:227], v[44:47]
    s_waitcnt vmcnt(12)
    v_mfma_f32_16x16x32_bf16 v[24:27], a[216:219], v[240:243], v[24:27]
    s_add_u32 s13, s92, 1269760
    v_mfma_f32_16x16x32_bf16 v[48:51], a[216:219], v[244:247], v[48:51]
    buffer_load_dwordx4 a[72:75], v7, s[28:31], s13 offen offset:0 sc1
    v_mfma_f32_16x16x32_bf16 v[72:75], a[216:219], v[248:251], v[72:75]
    v_mfma_f32_16x16x32_bf16 v[96:99], a[216:219], v[252:255], v[96:99]
    v_mfma_f32_16x16x32_bf16 v[100:103], a[220:223], v[252:255], v[100:103]
    buffer_load_dwordx4 a[76:79], v7, s[28:31], s13 offen offset:1024 sc1
    v_mfma_f32_16x16x32_bf16 v[76:79], a[220:223], v[248:251], v[76:79]
    v_mfma_f32_16x16x32_bf16 v[52:55], a[220:223], v[244:247], v[52:55]
    v_mfma_f32_16x16x32_bf16 v[28:31], a[220:223], v[240:243], v[28:31]
    buffer_load_dwordx4 a[80:83], v7, s[28:31], s13 offen offset:2048 sc1
    v_mfma_f32_16x16x32_bf16 v[32:35], a[224:227], v[240:243], v[32:35]
    s_add_u32 s13, s92, 1272832
    v_mfma_f32_16x16x32_bf16 v[56:59], a[224:227], v[244:247], v[56:59]
    v_mfma_f32_16x16x32_bf16 v[80:83], a[224:227], v[248:251], v[80:83]
    buffer_load_dwordx4 a[84:87], v7, s[28:31], s13 offen offset:0 sc1
    v_mfma_f32_16x16x32_bf16 v[104:107], a[224:227], v[252:255], v[104:107]
    v_mfma_f32_16x16x32_bf16 v[108:111], a[228:231], v[252:255], v[108:111]
    v_mfma_f32_16x16x32_bf16 v[84:87], a[228:231], v[248:251], v[84:87]
    buffer_load_dwordx4 a[88:91], v7, s[28:31], s13 offen offset:1024 sc1
    v_mfma_f32_16x16x32_bf16 v[60:63], a[228:231], v[244:247], v[60:63]
    v_mfma_f32_16x16x32_bf16 v[36:39], a[228:231], v[240:243], v[36:39]
    v_mfma_f32_16x16x32_bf16 v[40:43], a[232:235], v[240:243], v[40:43]
    buffer_load_dwordx4 a[92:95], v7, s[28:31], s13 offen offset:2048 sc1
    v_mfma_f32_16x16x32_bf16 v[64:67], a[232:235], v[244:247], v[64:67]
    v_mfma_f32_16x16x32_bf16 v[88:91], a[232:235], v[248:251], v[88:91]
    v_mfma_f32_16x16x32_bf16 v[112:115], a[232:235], v[252:255], v[112:115]
    v_mfma_f32_16x16x32_bf16 v[116:119], a[236:239], v[252:255], v[116:119]
    v_mfma_f32_16x16x32_bf16 v[92:95], a[236:239], v[248:251], v[92:95]
    v_mfma_f32_16x16x32_bf16 v[68:71], a[236:239], v[244:247], v[68:71]
    v_mfma_f32_16x16x32_bf16 v[44:47], a[236:239], v[240:243], v[44:47]
    s_waitcnt vmcnt(14)
    s_waitcnt lgkmcnt(0)
    v_mfma_f32_16x16x32_bf16 v[24:27], v[120:123], a[96:99], v[24:27]
    s_waitcnt lgkmcnt(0)
    s_add_u32 s100, s1, 3
    v_mfma_f32_16x16x32_bf16 v[48:51], v[120:123], a[100:103], v[48:51]
    s_sub_u32 s56, s56, s100
    s_sub_u32 s57, s57, s100
    v_mfma_f32_16x16x32_bf16 v[72:75], v[120:123], a[104:107], v[72:75]
    s_sub_u32 s58, s58, s100
    s_sub_u32 s59, s59, s100
    v_mfma_f32_16x16x32_bf16 v[96:99], v[120:123], a[108:111], v[96:99]
    s_max_u32 s56, s56, s57
    s_max_u32 s58, s58, s59
    v_mfma_f32_16x16x32_bf16 v[100:103], v[124:127], a[108:111], v[100:103]
    s_max_u32 s56, s56, s58
    v_mfma_f32_16x16x32_bf16 v[76:79], v[124:127], a[104:107], v[76:79]
    s_cmp_gt_u32 s56, 0
    s_cbranch_scc1 P2att_f13_spin
P2att_f13_ok:
    v_mfma_f32_16x16x32_bf16 v[52:55], v[124:127], a[100:103], v[52:55]
    s_add_u32 s13, s77, 98304
    v_mfma_f32_16x16x32_bf16 v[28:31], v[124:127], a[96:99], v[28:31]
    buffer_load_dwordx4 v[196:199], v4, s[28:31], s13 offen sc1
    v_mfma_f32_16x16x32_bf16 v[32:35], v[128:131], a[96:99], v[32:35]
    s_add_u32 s13, s77, 102400
    v_mfma_f32_16x16x32_bf16 v[56:59], v[128:131], a[100:103], v[56:59]
    v_mfma_f32_16x16x32_bf16 v[80:83], v[128:131], a[104:107], v[80:83]
    buffer_load_dwordx4 a[148:151], v4, s[28:31], s13 offen sc1
    v_mfma_f32_16x16x32_bf16 v[104:107], v[128:131], a[108:111], v[104:107]
    s_add_u32 s13, s77, 122880
    v_mfma_f32_16x16x32_bf16 v[108:111], v[132:135], a[108:111], v[108:111]
    v_mfma_f32_16x16x32_bf16 v[84:87], v[132:135], a[104:107], v[84:87]
    buffer_load_dwordx4 v[212:215], v4, s[28:31], s13 offen sc1
    v_mfma_f32_16x16x32_bf16 v[60:63], v[132:135], a[100:103], v[60:63]
    s_add_u32 s13, s77, 126976
    v_mfma_f32_16x16x32_bf16 v[36:39], v[132:135], a[96:99], v[36:39]
    v_mfma_f32_16x16x32_bf16 v[40:43], v[136:139], a[96:99], v[40:43]
    buffer_load_dwordx4 a[172:175], v4, s[28:31], s13 offen sc1
    v_mfma_f32_16x16x32_bf16 v[64:67], v[136:139], a[100:103], v[64:67]
    v_mfma_f32_16x16x32_bf16 v[88:91], v[136:139], a[104:107], v[88:91]
    v_mfma_f32_16x16x32_bf16 v[112:115], v[136:139], a[108:111], v[112:115]
    v_mfma_f32_16x16x32_bf16 v[116:119], v[140:143], a[108:111], v[116:119]
    v_mfma_f32_16x16x32_bf16 v[92:95], v[140:143], a[104:107], v[92:95]
    v_mfma_f32_16x16x32_bf16 v[68:71], v[140:143], a[100:103], v[68:71]
    v_mfma_f32_16x16x32_bf16 v[44:47], v[140:143], a[96:99], v[44:47]
    s_waitcnt vmcnt(14)
    v_mfma_f32_16x16x32_bf16 v[24:27], v[144:147], a[240:243], v[24:27]
    s_add_u32 s13, s77, 98304
    v_mfma_f32_16x16x32_bf16 v[48:51], v[144:147], a[244:247], v[48:51]
    buffer_load_dwordx4 v[200:203], v5, s[28:31], s13 offen sc1
    v_mfma_f32_16x16x32_bf16 v[72:75], v[144:147], a[248:251], v[72:75]
    s_add_u32 s13, s77, 102400
    v_mfma_f32_16x16x32_bf16 v[96:99], v[144:147], a[252:255], v[96:99]
    v_mfma_f32_16x16x32_bf16 v[100:103], v[148:151], a[252:255], v[100:103]
    buffer_load_dwordx4 a[152:155], v5, s[28:31], s13 offen sc1
    v_mfma_f32_16x16x32_bf16 v[76:79], v[148:151], a[248:251], v[76:79]
    s_add_u32 s13, s77, 122880
    v_mfma_f32_16x16x32_bf16 v[52:55], v[148:151], a[244:247], v[52:55]
    v_mfma_f32_16x16x32_bf16 v[28:31], v[148:151], a[240:243], v[28:31]
    buffer_load_dwordx4 v[216:219], v5, s[28:31], s13 offen sc1
    v_mfma_f32_16x16x32_bf16 v[32:35], v[152:155], a[240:243], v[32:35]
    s_add_u32 s13, s77, 126976
    v_mfma_f32_16x16x32_bf16 v[56:59], v[152:155], a[244:247], v[56:59]
    v_mfma_f32_16x16x32_bf16 v[80:83], v[152:155], a[248:251], v[80:83]
    buffer_load_dwordx4 a[176:179], v5, s[28:31], s13 offen sc1
    v_mfma_f32_16x16x32_bf16 v[104:107], v[152:155], a[252:255], v[104:107]
    v_mfma_f32_16x16x32_bf16 v[108:111], v[156:159], a[252:255], v[108:111]
    v_mfma_f32_16x16x32_bf16 v[84:87], v[156:159], a[248:251], v[84:87]
    v_mfma_f32_16x16x32_bf16 v[60:63], v[156:159], a[244:247], v[60:63]
    v_mfma_f32_16x16x32_bf16 v[36:39], v[156:159], a[240:243], v[36:39]
    v_mfma_f32_16x16x32_bf16 v[40:43], v[160:163], a[240:243], v[40:43]
    v_mfma_f32_16x16x32_bf16 v[64:67], v[160:163], a[244:247], v[64:67]
    v_mfma_f32_16x16x32_bf16 v[88:91], v[160:163], a[248:251], v[88:91]
    v_mfma_f32_16x16x32_bf16 v[112:115], v[160:163], a[252:255], v[112:115]
    v_mfma_f32_16x16x32_bf16 v[116:119], v[164:167], a[252:255], v[116:119]
    v_mfma_f32_16x16x32_bf16 v[92:95], v[164:167], a[248:251], v[92:95]
    v_mfma_f32_16x16x32_bf16 v[68:71], v[164:167], a[244:247], v[68:71]
    v_mfma_f32_16x16x32_bf16 v[44:47], v[164:167], a[240:243], v[44:47]
    s_waitcnt vmcnt(14)
    v_mfma_f32_16x16x32_bf16 v[24:27], v[168:171], a[120:123], v[24:27]
    s_add_u32 s13, s77, 98304
    s_mov_b32 s20, s98
    v_mfma_f32_16x16x32_bf16 v[48:51], v[168:171], a[124:127], v[48:51]
    buffer_load_dwordx4 v[204:207], v6, s[28:31], s13 offen sc1
    v_mfma_f32_16x16x32_bf16 v[72:75], v[168:171], a[128:131], v[72:75]
    s_add_u32 s13, s77, 102400
    s_and_b32 s21, s99, 0xffff
    v_mfma_f32_16x16x32_bf16 v[96:99], v[168:171], a[132:135], v[96:99]
    s_mov_b32 s22, 0x280000
    s_mov_b32 s23, 0x00020000
    v_mfma_f32_16x16x32_bf16 v[100:103], v[172:175], a[132:135], v[100:103]
    buffer_load_dwordx4 a[156:159], v6, s[28:31], s13 offen sc1
    v_mfma_f32_16x16x32_bf16 v[76:79], v[172:175], a[128:131], v[76:79]
    s_add_u32 s13, s77, 122880
    s_add_u32 s14, s32, 1
    v_mfma_f32_16x16x32_bf16 v[52:55], v[172:175], a[124:127], v[52:55]
    s_and_b32 s14, s14, 3
    s_mul_i32 s14, s14, 18432
    v_mfma_f32_16x16x32_bf16 v[28:31], v[172:175], a[120:123], v[28:31]
    buffer_load_dwordx4 v[220:223], v6, s[28:31], s13 offen sc1
    v_mfma_f32_16x16x32_bf16 v[32:35], v[176:179], a[120:123], v[32:35]
    s_add_u32 s13, s77, 126976
    v_add_u32 v10, s14, v7
    v_mfma_f32_16x16x32_bf16 v[56:59], v[176:179], a[124:127], v[56:59]
    s_add_u32 s14, s32, 2
    s_and_b32 s14, s14, 3
    v_mfma_f32_16x16x32_bf16 v[80:83], v[176:179], a[128:131], v[80:83]
    buffer_load_dwordx4 a[180:183], v6, s[28:31], s13 offen sc1
    v_mfma_f32_16x16x32_bf16 v[104:107], v[176:179], a[132:135], v[104:107]
    s_add_u32 s13, s77, 98304
    s_mul_i32 s14, s14, 18432
    v_mfma_f32_16x16x32_bf16 v[108:111], v[180:183], a[132:135], v[108:111]
    v_add_u32 v11, s14, v7
    s_add_u32 s14, s32, 3
    v_mfma_f32_16x16x32_bf16 v[84:87], v[180:183], a[128:131], v[84:87]
    buffer_load_dwordx4 v[192:195], v3, s[28:31], s13 offen sc1
    v_mfma_f32_16x16x32_bf16 v[60:63], v[180:183], a[124:127], v[60:63]
    s_add_u32 s13, s77, 102400
    s_and_b32 s14, s14, 3
    v_mfma_f32_16x16x32_bf16 v[36:39], v[180:183], a[120:123], v[36:39]
    s_mul_i32 s14, s14, 18432
    v_add_u32 v12, s14, v7
    v_mfma_f32_16x16x32_bf16 v[40:43], v[184:187], a[120:123], v[40:43]
    buffer_load_dwordx4 a[144:147], v3, s[28:31], s13 offen sc1
    v_mfma_f32_16x16x32_bf16 v[64:67], v[184:187], a[124:127], v[64:67]
    s_add_u32 s13, s77, 122880
    v_mfma_f32_16x16x32_bf16 v[88:91], v[184:187], a[128:131], v[88:91]
    v_mfma_f32_16x16x32_bf16 v[112:115], v[184:187], a[132:135], v[112:115]
    buffer_load_dwordx4 v[208:211], v3, s[28:31], s13 offen sc1
    v_mfma_f32_16x16x32_bf16 v[116:119], v[188:191], a[132:135], v[116:119]
    s_add_u32 s13, s77, 126976
    v_mfma_f32_16x16x32_bf16 v[92:95], v[188:191], a[128:131], v[92:95]
    v_mfma_f32_16x16x32_bf16 v[68:71], v[188:191], a[124:127], v[68:71]
    buffer_load_dwordx4 a[168:171], v3, s[28:31], s13 offen sc1
    v_mfma_f32_16x16x32_bf16 v[44:47], v[188:191], a[120:123], v[44:47]
    v_and_b32 v9, 0xf0, v7
    v_mul_u32_u24 v9, 80, v9
    v_lshrrev_b32 v8, 8, v7
    v_lshl_add_u32 v8, v8, 4, v9
    buffer_load_dwordx4 v[144:147], v8, s[16:19], s3 offen offset:0
    buffer_load_dwordx4 v[148:151], v8, s[16:19], s3 offen offset:64
    buffer_load_dwordx4 v[152:155], v8, s[16:19], s3 offen offset:128
    s_waitcnt vmcnt(15)
    v_mfma_f32_16x16x32_bf16 v[48:51], a[0:3], v[196:199], v[48:51]
    s_barrier
    v_mfma_f32_16x16x32_bf16 v[52:55], a[4:7], v[196:199], v[52:55]
    v_mfma_f32_16x16x32_bf16 v[56:59], a[8:11], v[196:199], v[56:59]
    v_mfma_f32_16x16x32_bf16 v[60:63], a[12:15], v[196:199], v[60:63]
    v_mfma_f32_16x16x32_bf16 v[64:67], a[16:19], v[196:199], v[64:67]
    v_mfma_f32_16x16x32_bf16 v[68:71], a[20:23], v[196:199], v[68:71]
    v_mfma_f32_16x16x32_bf16 v[48:51], a[24:27], a[148:151], v[48:51]
    v_mfma_f32_16x16x32_bf16 v[52:55], a[28:31], a[148:151], v[52:55]
    v_mfma_f32_16x16x32_bf16 v[56:59], a[32:35], a[148:151], v[56:59]
    v_mfma_f32_16x16x32_bf16 v[60:63], a[36:39], a[148:151], v[60:63]
    v_mfma_f32_16x16x32_bf16 v[64:67], a[40:43], a[148:151], v[64:67]
    v_mfma_f32_16x16x32_bf16 v[68:71], a[44:47], a[148:151], v[68:71]
    v_mfma_f32_16x16x32_bf16 v[48:51], a[48:51], v[212:215], v[48:51]
    v_mfma_f32_16x16x32_bf16 v[52:55], a[52:55], v[212:215], v[52:55]
    v_mfma_f32_16x16x32_bf16 v[56:59], a[56:59], v[212:215], v[56:59]
    v_mfma_f32_16x16x32_bf16 v[60:63], a[60:63], v[212:215], v[60:63]
    v_mfma_f32_16x16x32_bf16 v[64:67], a[64:67], v[212:215], v[64:67]
    v_mfma_f32_16x16x32_bf16 v[68:71], a[68:71], v[212:215], v[68:71]
    v_mfma_f32_16x16x32_bf16 v[48:51], a[72:75], a[172:175], v[48:51]
    v_mfma_f32_16x16x32_bf16 v[52:55], a[76:79], a[172:175], v[52:55]
    v_mfma_f32_16x16x32_bf16 v[56:59], a[80:83], a[172:175], v[56:59]
    v_mfma_f32_16x16x32_bf16 v[60:63], a[84:87], a[172:175], v[60:63]
    v_mfma_f32_16x16x32_bf16 v[64:67], a[88:91], a[172:175], v[64:67]
    v_mfma_f32_16x16x32_bf16 v[68:71], a[92:95], a[172:175], v[68:71]
    s_waitcnt vmcnt(11)
    v_mfma_f32_16x16x32_bf16 v[72:75], a[0:3], v[200:203], v[72:75]
    v_mfma_f32_16x16x32_bf16 v[76:79], a[4:7], v[200:203], v[76:79]
    v_mfma_f32_16x16x32_bf16 v[80:83], a[8:11], v[200:203], v[80:83]
    v_mfma_f32_16x16x32_bf16 v[84:87], a[12:15], v[200:203], v[84:87]
    v_mfma_f32_16x16x32_bf16 v[88:91], a[16:19], v[200:203], v[88:91]
    ds_write_b128 v10, v[48:51] offset:0
    v_mfma_f32_16x16x32_bf16 v[92:95], a[20:23], v[200:203], v[92:95]
    v_mfma_f32_16x16x32_bf16 v[72:75], a[24:27], a[152:155], v[72:75]
    v_mfma_f32_16x16x32_bf16 v[76:79], a[28:31], a[152:155], v[76:79]
    ds_write_b128 v10, v[52:55] offset:1024
    v_mfma_f32_16x16x32_bf16 v[80:83], a[32:35], a[152:155], v[80:83]
    v_mfma_f32_16x16x32_bf16 v[84:87], a[36:39], a[152:155], v[84:87]
    v_mfma_f32_16x16x32_bf16 v[88:91], a[40:43], a[152:155], v[88:91]
    ds_write_b128 v10, v[56:59] offset:2048
    v_mfma_f32_16x16x32_bf16 v[92:95], a[44:47], a[152:155], v[92:95]
    v_mfma_f32_16x16x32_bf16 v[72:75], a[48:51], v[216:219], v[72:75]
    v_mfma_f32_16x16x32_bf16 v[76:79], a[52:55], v[216:219], v[76:79]
    ds_write_b128 v10, v[60:63] offset:3072
    v_mfma_f32_16x16x32_bf16 v[80:83], a[56:59], v[216:219], v[80:83]
    v_mfma_f32_16x16x32_bf16 v[84:87], a[60:63], v[216:219], v[84:87]
    v_mfma_f32_16x16x32_bf16 v[88:91], a[64:67], v[216:219], v[88:91]
    ds_write_b128 v10, v[64:67] offset:4096
    v_mfma_f32_16x16x32_bf16 v[92:95], a[68:71], v[216:219], v[92:95]
    v_mfma_f32_16x16x32_bf16 v[72:75], a[72:75], a[176:179], v[72:75]
    v_mfma_f32_16x16x32_bf16 v[76:79], a[76:79], a[176:179], v[76:79]
    ds_write_b128 v10, v[68:71] offset:5120
    v_mfma_f32_16x16x32_bf16 v[80:83], a[80:83], a[176:179], v[80:83]
    v_mfma_f32_16x16x32_bf16 v[84:87], a[84:87], a[176:179], v[84:87]
    v_mfma_f32_16x16x32_bf16 v[88:91], a[88:91], a[176:179], v[88:91]
    v_mfma_f32_16x16x32_bf16 v[92:95], a[92:95], a[176:179], v[92:95]
    s_waitcnt vmcnt(7)
    v_mfma_f32_16x16x32_bf16 v[96:99], a[0:3], v[204:207], v[96:99]
    s_mul_i32 s14, s32, 18432
    v_add_u32 v9, s14, v7
    v_mfma_f32_16x16x32_bf16 v[100:103], a[4:7], v[204:207], v[100:103]
    v_mfma_f32_16x16x32_bf16 v[104:107], a[8:11], v[204:207], v[104:107]
    v_mfma_f32_16x16x32_bf16 v[108:111], a[12:15], v[204:207], v[108:111]
    v_mfma_f32_16x16x32_bf16 v[112:115], a[16:19], v[204:207], v[112:115]
    ds_write_b128 v11, v[72:75] offset:6144
    v_mfma_f32_16x16x32_bf16 v[116:119], a[20:23], v[204:207], v[116:119]
    v_mfma_f32_16x16x32_bf16 v[96:99], a[24:27], a[156:159], v[96:99]
    v_mfma_f32_16x16x32_bf16 v[100:103], a[28:31], a[156:159], v[100:103]
    ds_write_b128 v11, v[76:79] offset:7168
    v_mfma_f32_16x16x32_bf16 v[104:107], a[32:35], a[156:159], v[104:107]
    v_mfma_f32_16x16x32_bf16 v[108:111], a[36:39], a[156:159], v[108:111]
    v_mfma_f32_16x16x32_bf16 v[112:115], a[40:43], a[156:159], v[112:115]
    ds_write_b128 v11, v[80:83] offset:8192
    v_mfma_f32_16x16x32_bf16 v[116:119], a[44:47], a[156:159], v[116:119]
    v_mfma_f32_16x16x32_bf16 v[96:99], a[48:51], v[220:223], v[96:99]
    v_mfma_f32_16x16x32_bf16 v[100:103], a[52:55], v[220:223], v[100:103]
    ds_write_b128 v11, v[84:87] offset:9216
    v_mfma_f32_16x16x32_bf16 v[104:107], a[56:59], v[220:223], v[104:107]
    v_mfma_f32_16x16x32_bf16 v[108:111], a[60:63], v[220:223], v[108:111]
    v_mfma_f32_16x16x32_bf16 v[112:115], a[64:67], v[220:223], v[112:115]
    ds_write_b128 v11, v[88:91] offset:10240
    v_mfma_f32_16x16x32_bf16 v[116:119], a[68:71], v[220:223], v[116:119]
    v_mfma_f32_16x16x32_bf16 v[96:99], a[72:75], a[180:183], v[96:99]
    v_mfma_f32_16x16x32_bf16 v[100:103], a[76:79], a[180:183], v[100:103]
    ds_write_b128 v11, v[92:95] offset:11264
    v_mfma_f32_16x16x32_bf16 v[104:107], a[80:83], a[180:183], v[104:107]
    v_mfma_f32_16x16x32_bf16 v[108:111], a[84:87], a[180:183], v[108:111]
    v_mfma_f32_16x16x32_bf16 v[112:115], a[88:91], a[180:183], v[112:115]
    v_mfma_f32_16x16x32_bf16 v[116:119], a[92:95], a[180:183], v[116:119]
    s_waitcnt vmcnt(3)
    v_mfma_f32_16x16x32_bf16 v[24:27], a[0:3], v[192:195], v[24:27]
    s_waitcnt vmcnt(0)
    v_and_b32 v121, 0xffff0000, v144
    v_mfma_f32_16x16x32_bf16 v[28:31], a[4:7], v[192:195], v[28:31]
    v_lshlrev_b32 v120, 16, v144
    v_and_b32 v123, 0xffff0000, v145
    v_mfma_f32_16x16x32_bf16 v[32:35], a[8:11], v[192:195], v[32:35]
    v_lshlrev_b32 v122, 16, v145
    v_and_b32 v125, 0xffff0000, v146
    v_mfma_f32_16x16x32_bf16 v[36:39], a[12:15], v[192:195], v[36:39]
    v_lshlrev_b32 v124, 16, v146
    v_and_b32 v127, 0xffff0000, v147
    v_mfma_f32_16x16x32_bf16 v[40:43], a[16:19], v[192:195], v[40:43]
    ds_write_b128 v12, v[96:99] offset:12288
    v_mfma_f32_16x16x32_bf16 v[44:47], a[20:23], v[192:195], v[44:47]
    v_lshlrev_b32 v126, 16, v147
    v_and_b32 v129, 0xffff0000, v148
    v_mfma_f32_16x16x32_bf16 v[24:27], a[24:27], a[144:147], v[24:27]
    v_lshlrev_b32 v128, 16, v148
    v_and_b32 v131, 0xffff0000, v149
    v_mfma_f32_16x16x32_bf16 v[28:31], a[28:31], a[144:147], v[28:31]
    ds_write_b128 v12, v[100:103] offset:13312
    v_mfma_f32_16x16x32_bf16 v[32:35], a[32:35], a[144:147], v[32:35]
    v_lshlrev_b32 v130, 16, v149
    v_and_b32 v133, 0xffff0000, v150
    v_mfma_f32_16x16x32_bf16 v[36:39], a[36:39], a[144:147], v[36:39]
    v_lshlrev_b32 v132, 16, v150
    v_and_b32 v135, 0xffff0000, v151
    v_mfma_f32_16x16x32_bf16 v[40:43], a[40:43], a[144:147], v[40:43]
    ds_write_b128 v12, v[104:107] offset:14336
    v_mfma_f32_16x16x32_bf16 v[44:47], a[44:47], a[144:147], v[44:47]
    v_lshlrev_b32 v134, 16, v151
    v_and_b32 v137, 0xffff0000, v152
    v_mfma_f32_16x16x32_bf16 v[24:27], a[48:51], v[208:211], v[24:27]
    v_lshlrev_b32 v136, 16, v152
    v_and_b32 v139, 0xffff0000, v153
    v_mfma_f32_16x16x32_bf16 v[28:31], a[52:55], v[208:211], v[28:31]
    ds_write_b128 v12, v[108:111] offset:15360
    v_mfma_f32_16x16x32_bf16 v[32:35], a[56:59], v[208:211], v[32:35]
    v_lshlrev_b32 v138, 16, v153
    v_and_b32 v141, 0xffff0000, v154
    v_mfma_f32_16x16x32_bf16 v[36:39], a[60:63], v[208:211], v[36:39]
    v_lshlrev_b32 v140, 16, v154
    v_and_b32 v143, 0xffff0000, v155
    v_mfma_f32_16x16x32_bf16 v[40:43], a[64:67], v[208:211], v[40:43]
    ds_write_b128 v12, v[112:115] offset:16384
    v_mfma_f32_16x16x32_bf16 v[44:47], a[68:71], v[208:211], v[44:47]
    v_lshlrev_b32 v142, 16, v155
    v_mfma_f32_16x16x32_bf16 v[24:27], a[72:75], a[168:171], v[24:27]
    v_mfma_f32_16x16x32_bf16 v[28:31], a[76:79], a[168:171], v[28:31]
    ds_write_b128 v12, v[116:119] offset:17408
    v_mfma_f32_16x16x32_bf16 v[32:35], a[80:83], a[168:171], v[32:35]
    v_mfma_f32_16x16x32_bf16 v[36:39], a[84:87], a[168:171], v[36:39]
    v_mfma_f32_16x16x32_bf16 v[40:43], a[88:91], a[168:171], v[40:43]
    v_mfma_f32_16x16x32_bf16 v[44:47], a[92:95], a[168:171], v[44:47]
    s_waitcnt lgkmcnt(0)
    s_barrier
    ds_read_b128 v[144:147], v9 offset:0
    ds_read_b128 v[148:151], v9 offset:6144
    ds_read_b128 v[152:155], v9 offset:12288
    ds_read_b128 v[156:159], v9 offset:1024
    ds_read_b128 v[160:163], v9 offset:7168
    ds_read_b128 v[164:167], v9 offset:13312
    ds_read_b128 v[168:171], v9 offset:2048
    ds_read_b128 v[172:175], v9 offset:8192
    ds_read_b128 v[176:179], v9 offset:14336
    ds_read_b128 v[180:183], v9 offset:3072
    ds_read_b128 v[184:187], v9 offset:9216
    ds_read_b128 v[188:191], v9 offset:15360
    ds_read_b128 v[192:195], v9 offset:4096
    ds_read_b128 v[196:199], v9 offset:10240
    ds_read_b128 v[200:203], v9 offset:16384
    ds_read_b128 v[204:207], v9 offset:5120
    ds_read_b128 v[208:211], v9 offset:11264
    ds_read_b128 v[212:215], v9 offset:17408
    v_pk_add_f32 v[24:25], v[24:25], v[120:121]
    v_pk_add_f32 v[26:27], v[26:27], v[122:123]
    v_pk_add_f32 v[28:29], v[28:29], v[124:125]
    v_pk_add_f32 v[30:31], v[30:31], v[126:127]
    v_pk_add_f32 v[32:33], v[32:33], v[128:129]
    v_pk_add_f32 v[34:35], v[34:35], v[130:131]
    v_pk_add_f32 v[36:37], v[36:37], v[132:133]
    v_pk_add_f32 v[38:39], v[38:39], v[134:135]
    v_pk_add_f32 v[40:41], v[40:41], v[136:137]
    v_pk_add_f32 v[42:43], v[42:43], v[138:139]
    v_pk_add_f32 v[44:45], v[44:45], v[140:141]
    v_pk_add_f32 v[46:47], v[46:47], v[142:143]
    s_waitcnt lgkmcnt(15)
    v_pk_add_f32 v[24:25], v[24:25], v[144:145]
    v_pk_add_f32 v[26:27], v[26:27], v[146:147]
    v_pk_add_f32 v[24:25], v[24:25], v[148:149]
    v_pk_add_f32 v[26:27], v[26:27], v[150:151]
    v_pk_add_f32 v[24:25], v[24:25], v[152:153]
    v_pk_add_f32 v[26:27], v[26:27], v[154:155]
    v_cvt_pk_bf16_f32 v120, v24, v25
    v_cvt_pk_bf16_f32 v121, v26, v27
    s_waitcnt lgkmcnt(12)
    v_pk_add_f32 v[28:29], v[28:29], v[156:157]
    v_pk_add_f32 v[30:31], v[30:31], v[158:159]
    v_pk_add_f32 v[28:29], v[28:29], v[160:161]
    v_pk_add_f32 v[30:31], v[30:31], v[162:163]
    v_pk_add_f32 v[28:29], v[28:29], v[164:165]
    v_pk_add_f32 v[30:31], v[30:31], v[166:167]
    v_cvt_pk_bf16_f32 v122, v28, v29
    v_cvt_pk_bf16_f32 v123, v30, v31
    buffer_store_dwordx4 v[120:123], v8, s[20:23], s3 offen offset:0
    s_waitcnt lgkmcnt(9)
    v_pk_add_f32 v[32:33], v[32:33], v[168:169]
    v_pk_add_f32 v[34:35], v[34:35], v[170:171]
    v_pk_add_f32 v[32:33], v[32:33], v[172:173]
    v_pk_add_f32 v[34:35], v[34:35], v[174:175]
    v_pk_add_f32 v[32:33], v[32:33], v[176:177]
    v_pk_add_f32 v[34:35], v[34:35], v[178:179]
    v_cvt_pk_bf16_f32 v124, v32, v33
    v_cvt_pk_bf16_f32 v125, v34, v35
    s_waitcnt lgkmcnt(6)
    v_pk_add_f32 v[36:37], v[36:37], v[180:181]
    v_pk_add_f32 v[38:39], v[38:39], v[182:183]
    v_pk_add_f32 v[36:37], v[36:37], v[184:185]
    v_pk_add_f32 v[38:39], v[38:39], v[186:187]
    v_pk_add_f32 v[36:37], v[36:37], v[188:189]
    v_pk_add_f32 v[38:39], v[38:39], v[190:191]
    v_cvt_pk_bf16_f32 v126, v36, v37
    v_cvt_pk_bf16_f32 v127, v38, v39
    buffer_store_dwordx4 v[124:127], v8, s[20:23], s3 offen offset:64
    s_waitcnt lgkmcnt(3)
    v_pk_add_f32 v[40:41], v[40:41], v[192:193]
    v_pk_add_f32 v[42:43], v[42:43], v[194:195]
    v_pk_add_f32 v[40:41], v[40:41], v[196:197]
    v_pk_add_f32 v[42:43], v[42:43], v[198:199]
    v_pk_add_f32 v[40:41], v[40:41], v[200:201]
    v_pk_add_f32 v[42:43], v[42:43], v[202:203]
    v_cvt_pk_bf16_f32 v128, v40, v41
    v_cvt_pk_bf16_f32 v129, v42, v43
    s_waitcnt lgkmcnt(0)
    v_pk_add_f32 v[44:45], v[44:45], v[204:205]
    v_pk_add_f32 v[46:47], v[46:47], v[206:207]
    v_pk_add_f32 v[44:45], v[44:45], v[208:209]
    v_pk_add_f32 v[46:47], v[46:47], v[210:211]
    v_pk_add_f32 v[44:45], v[44:45], v[212:213]
    v_pk_add_f32 v[46:47], v[46:47], v[214:215]
    v_cvt_pk_bf16_f32 v130, v44, v45
    v_cvt_pk_bf16_f32 v131, v46, v47
    buffer_store_dwordx4 v[128:131], v8, s[20:23], s3 offen offset:128
K_fin:
K_end:
    s_endpgm
ATT_pf_spin:
    s_mov_b32 s101, 0
ATT_pf_lp:
    s_sleep 2
    buffer_load_dword v1, off, s[28:31], s35 offset:64 sc1
    s_add_u32 s101, s101, 1
    s_waitcnt vmcnt(0)
    s_add_u32 s100, s1, 0
    v_subrev_u32 v1, s100, v1
    v_cmp_lt_u32 vcc, 3, v1
    s_nop 1
    s_cmp_eq_u64 vcc, 0
    s_cbranch_scc1 ATT_pf_ok
    s_cmp_lt_u32 s101, 0x8000
    s_cbranch_scc1 ATT_pf_lp
    s_branch ATT_pf_ok
NON_ffn_spin:
    s_mov_b32 s101, 0
NON_ffn_lp:
    s_sleep 2
    s_sleep 6
    buffer_load_dword v125, off, s[24:27], 0 sc1
    s_add_u32 s101, s101, 1
    s_waitcnt vmcnt(0)
    v_readfirstlane_b32 s1, v125
    v_cmp_eq_u32 vcc, 0, v125
    s_nop 1
    s_cmp_eq_u64 vcc, 0
    s_cbranch_scc1 NON_ffn_ok
    s_cmp_lt_u32 s101, 0x8000
    s_cbranch_scc1 NON_ffn_lp
    s_branch NON_ffn_ok
STF_spin:
    s_mov_b32 s101, 0
STF_lp:
    s_sleep 2
    buffer_load_dwordx2 v[128:129], v110, s[28:31], s75 offen offset:0 sc1
    buffer_load_dwordx2 v[130:131], v110, s[28:31], s75 offen offset:128 sc1
    buffer_load_dwordx2 v[132:133], v110, s[28:31], s75 offen offset:256 sc1
    buffer_load_dwordx2 v[134:135], v110, s[28:31], s75 offen offset:384 sc1
    s_add_u32 s101, s101, 1
    s_waitcnt vmcnt(0)
    v_xor_b32 v136, s1, v129
    v_bitop3_b32 v136, v131, s1, v136 bitop3:0xbe
    v_bitop3_b32 v136, v133, s1, v136 bitop3:0xbe
    v_bitop3_b32 v136, v135, s1, v136 bitop3:0xbe
    v_cmp_ne_u32 vcc, 0, v136
    s_nop 1
    s_cmp_eq_u64 vcc, 0
    s_cbranch_scc1 STF_ok
    s_cmp_lt_u32 s101, 0x8000
    s_cbranch_scc1 STF_lp
    s_branch STF_ok
AE0_spin:
    s_mov_b32 s101, 0
AE0_lp:
    s_sleep 2
    buffer_load_dwordx4 v[240:243], v11, s[28:31], s15 offen offset:0 sc1
    buffer_load_dwordx4 v[244:247], v11, s[28:31], s15 offen offset:1024 sc1
    buffer_load_dwordx4 v[248:251], v11, s[28:31], s15 offen offset:2048 sc1
    buffer_load_dwordx4 v[252:255], v11, s[28:31], s15 offen offset:3072 sc1
    s_add_u32 s101, s101, 1
    s_waitcnt vmcnt(0)
    v_xor_b32 v247, s1, v242
    v_bitop3_b32 v247, v246, s1, v247 bitop3:0xbe
    v_bitop3_b32 v247, v250, s1, v247 bitop3:0xbe
    v_bitop3_b32 v247, v254, s1, v247 bitop3:0xbe
    v_cmp_ne_u32 vcc, 0, v247
    s_nop 1
    s_cmp_eq_u64 vcc, 0
    s_cbranch_scc1 AE0_ok
    s_cmp_lt_u32 s101, 0x8000
    s_cbranch_scc1 AE0_lp
    s_branch AE0_ok
AE1_spin:
    s_mov_b32 s101, 0
AE1_lp:
    s_sleep 2
    buffer_load_dwordx4 v[240:243], v11, s[28:31], s15 offen offset:0 sc1
    buffer_load_dwordx4 v[244:247], v11, s[28:31], s15 offen offset:1024 sc1
    buffer_load_dwordx4 v[248:251], v11, s[28:31], s15 offen offset:2048 sc1
    buffer_load_dwordx4 v[252:255], v11, s[28:31], s15 offen offset:3072 sc1
    s_add_u32 s101, s101, 1
    s_waitcnt vmcnt(0)
    v_xor_b32 v247, s1, v242
    v_bitop3_b32 v247, v246, s1, v247 bitop3:0xbe
    v_bitop3_b32 v247, v250, s1, v247 bitop3:0xbe
    v_bitop3_b32 v247, v254, s1, v247 bitop3:0xbe
    v_cmp_ne_u32 vcc, 0, v247
    s_nop 1
    s_cmp_eq_u64 vcc, 0
    s_cbranch_scc1 AE1_ok
    s_cmp_lt_u32 s101, 0x8000
    s_cbranch_scc1 AE1_lp
    s_branch AE1_ok
AE2_spin:
    s_mov_b32 s101, 0
AE2_lp:
    s_sleep 2
    buffer_load_dwordx4 v[240:243], v11, s[28:31], s15 offen offset:0 sc1
    buffer_load_dwordx4 v[244:247], v11, s[28:31], s15 offen offset:1024 sc1
    buffer_load_dwordx4 v[248:251], v11, s[28:31], s15 offen offset:2048 sc1
    buffer_load_dwordx4 v[252:255], v11, s[28:31], s15 offen offset:3072 sc1
    s_add_u32 s101, s101, 1
    s_waitcnt vmcnt(0)
    v_xor_b32 v247, s1, v242
    v_bitop3_b32 v247, v246, s1, v247 bitop3:0xbe
    v_bitop3_b32 v247, v250, s1, v247 bitop3:0xbe
    v_bitop3_b32 v247, v254, s1, v247 bitop3:0xbe
    v_cmp_ne_u32 vcc, 0, v247
    s_nop 1
    s_cmp_eq_u64 vcc, 0
    s_cbranch_scc1 AE2_ok
    s_cmp_lt_u32 s101, 0x8000
    s_cbranch_scc1 AE2_lp
    s_branch AE2_ok
NON_att_spin:
    s_mov_b32 s101, 0
NON_att_lp:
    s_sleep 2
    s_sleep 6
    buffer_load_dword v253, off, s[24:27], 0 sc1
    s_add_u32 s101, s101, 1
    s_waitcnt vmcnt(0)
    v_readfirstlane_b32 s1, v253
    v_cmp_eq_u32 vcc, 0, v253
    s_nop 1
    s_cmp_eq_u64 vcc, 0
    s_cbranch_scc1 NON_att_ok
    s_cmp_lt_u32 s101, 0x8000
    s_cbranch_scc1 NON_att_lp
    s_branch NON_att_ok
STA_spin:
    s_mov_b32 s101, 0
STA_lp:
    s_sleep 2
    buffer_load_dwordx2 v[212:213], v15, s[28:31], s38 offen offset:0 sc1
    buffer_load_dwordx2 v[214:215], v15, s[28:31], s79 offen offset:0 sc1
    buffer_load_dwordx2 v[216:217], v15, s[28:31], s79 offen offset:128 sc1
    buffer_load_dwordx2 v[218:219], v15, s[28:31], s79 offen offset:256 sc1
    buffer_load_dwordx2 v[220:221], v15, s[28:31], s79 offen offset:384 sc1
    buffer_load_dwordx2 v[222:223], v15, s[28:31], s79 offen offset:512 sc1
    buffer_load_dwordx2 v[224:225], v15, s[28:31], s79 offen offset:640 sc1
    buffer_load_dwordx2 v[226:227], v15, s[28:31], s79 offen offset:768 sc1
    buffer_load_dwordx2 v[228:229], v15, s[28:31], s79 offen offset:896 sc1
    s_add_u32 s101, s101, 1
    s_waitcnt vmcnt(0)
    v_xor_b32 v230, s1, v213
    v_bitop3_b32 v230, v215, s1, v230 bitop3:0xbe
    v_bitop3_b32 v230, v217, s1, v230 bitop3:0xbe
    v_bitop3_b32 v230, v219, s1, v230 bitop3:0xbe
    v_bitop3_b32 v230, v221, s1, v230 bitop3:0xbe
    v_bitop3_b32 v230, v223, s1, v230 bitop3:0xbe
    v_bitop3_b32 v230, v225, s1, v230 bitop3:0xbe
    v_bitop3_b32 v230, v227, s1, v230 bitop3:0xbe
    v_bitop3_b32 v230, v229, s1, v230 bitop3:0xbe
    v_cmp_ne_u32 vcc, 0, v230
    s_nop 1
    s_cmp_eq_u64 vcc, 0
    s_cbranch_scc1 STA_ok
    s_cmp_lt_u32 s101, 0x8000
    s_cbranch_scc1 STA_lp
    s_branch STA_ok
FFN_pf_spin:
    s_mov_b32 s101, 0
FFN_pf_sl:
    s_sleep 1
    s_buffer_load_dword s56, s[28:31], s35 offset:64 glc
    s_add_u32 s101, s101, 1
    s_waitcnt lgkmcnt(0)
    s_add_u32 s100, s1, 0
    s_sub_u32 s56, s56, s100
    s_cmp_le_u32 s56, 3
    s_cbranch_scc1 FFN_pf_ok
    s_cmp_lt_u32 s101, 24
    s_cbranch_scc1 FFN_pf_sl
FFN_pfv_spin:
    s_mov_b32 s101, 0
FFN_pfv_lp:
    s_sleep 2
    buffer_load_dword v2, off, s[28:31], s35 offset:64 sc1
    s_add_u32 s101, s101, 1
    s_waitcnt vmcnt(0)
    s_add_u32 s100, s1, 0
    v_subrev_u32 v2, s100, v2
    v_cmp_lt_u32 vcc, 3, v2
    v_lshrrev_b32 v2, 4, v11
    v_add_u32 v2, s1, v2
    s_nop 1
    s_cmp_eq_u64 vcc, 0
    s_cbranch_scc1 FFN_pfv_ok
    s_cmp_lt_u32 s101, 0x8000
    s_cbranch_scc1 FFN_pfv_lp
    s_branch FFN_pfv_ok
FFN_pfv_ok:
    s_branch FFN_pf_ok
FFN_fe_spin:
    s_mov_b32 s101, 0
FFN_fe_sl:
    s_sleep 1
    s_buffer_load_dwordx4 s[56:59], s[28:31], s35 offset:0 glc
    s_add_u32 s101, s101, 1
    s_waitcnt lgkmcnt(0)
    s_add_u32 s100, s1, 1
    s_sub_u32 s56, s56, s100
    s_sub_u32 s57, s57, s100
    s_sub_u32 s58, s58, s100
    s_sub_u32 s59, s59, s100
    s_max_u32 s56, s56, s57
    s_max_u32 s58, s58, s59
    s_max_u32 s56, s56, s58
    s_cmp_le_u32 s56, 2
    s_cbranch_scc1 FFN_fe_ok
    s_cmp_lt_u32 s101, 24
    s_cbranch_scc1 FFN_fe_sl
FFN_fev_spin:
    s_mov_b32 s101, 0
FFN_fev_lp:
    s_sleep 2
    buffer_load_dwordx4 v[104:107], off, s[28:31], s35 offset:0 sc1
    s_add_u32 s101, s101, 1
    s_waitcnt vmcnt(0)
    s_add_u32 s100, s1, 1
    v_subrev_u32 v104, s100, v104
    v_subrev_u32 v105, s100, v105
    v_subrev_u32 v106, s100, v106
    v_subrev_u32 v107, s100, v107
    v_max3_u32 v104, v104, v105, v106
    v_max_u32 v104, v104, v107
    v_cmp_lt_u32 vcc, 2, v104
    s_nop 1
    s_cmp_eq_u64 vcc, 0
    s_cbranch_scc1 FFN_fev_ok
    s_cmp_lt_u32 s101, 0x8000
    s_cbranch_scc1 FFN_fev_lp
    s_branch FFN_fev_ok
FFN_fev_ok:
    s_branch FFN_fe_ok
P2ffn_f4_spin:
    s_mov_b32 s101, 0
P2ffn_f4_sl:
    s_sleep 1
    s_buffer_load_dwordx4 s[56:59], s[28:31], s35 offset:0 glc
    s_add_u32 s101, s101, 1
    s_waitcnt lgkmcnt(0)
    s_add_u32 s100, s1, 2
    s_sub_u32 s56, s56, s100
    s_sub_u32 s57, s57, s100
    s_sub_u32 s58, s58, s100
    s_sub_u32 s59, s59, s100
    s_max_u32 s56, s56, s57
    s_max_u32 s58, s58, s59
    s_max_u32 s56, s56, s58
    s_cmp_le_u32 s56, 1
    s_cbranch_scc1 P2ffn_f4_ok
    s_cmp_lt_u32 s101, 24
    s_cbranch_scc1 P2ffn_f4_sl
P2ffn_f4v_spin:
    s_mov_b32 s101, 0
P2ffn_f4v_lp:
    s_sleep 2
    buffer_load_dwordx4 v[20:23], off, s[28:31], s35 offset:0 sc1
    s_add_u32 s101, s101, 1
    s_waitcnt vmcnt(0)
    s_add_u32 s100, s1, 2
    v_subrev_u32 v20, s100, v20
    v_subrev_u32 v21, s100, v21
    v_subrev_u32 v22, s100, v22
    v_subrev_u32 v23, s100, v23
    v_max3_u32 v20, v20, v21, v22
    v_max_u32 v20, v20, v23
    v_cmp_lt_u32 vcc, 1, v20
    s_nop 1
    s_cmp_eq_u64 vcc, 0
    s_cbranch_scc1 P2ffn_f4v_ok
    s_cmp_lt_u32 s101, 0x8000
    s_cbranch_scc1 P2ffn_f4v_lp
    s_branch P2ffn_f4v_ok
P2ffn_f4v_ok:
    s_branch P2ffn_f4_ok
P2ffn_f8_spin:
    s_mov_b32 s101, 0
P2ffn_f8_sl:
    s_sleep 1
    s_buffer_load_dwordx4 s[56:59], s[28:31], s35 offset:16 glc
    s_add_u32 s101, s101, 1
    s_waitcnt lgkmcnt(0)
    s_add_u32 s100, s1, 1
    s_sub_u32 s56, s56, s100
    s_sub_u32 s57, s57, s100
    s_sub_u32 s58, s58, s100
    s_sub_u32 s59, s59, s100
    s_max_u32 s56, s56, s57
    s_max_u32 s58, s58, s59
    s_max_u32 s56, s56, s58
    s_cmp_le_u32 s56, 2
    s_cbranch_scc1 P2ffn_f8_ok
    s_cmp_lt_u32 s101, 24
    s_cbranch_scc1 P2ffn_f8_sl
P2ffn_f8v_spin:
    s_mov_b32 s101, 0
P2ffn_f8v_lp:
    s_sleep 2
    buffer_load_dwordx4 v[20:23], off, s[28:31], s35 offset:16 sc1
    s_add_u32 s101, s101, 1
    s_waitcnt vmcnt(0)
    s_add_u32 s100, s1, 1
    v_subrev_u32 v20, s100, v20
    v_subrev_u32 v21, s100, v21
    v_subrev_u32 v22, s100, v22
    v_subrev_u32 v23, s100, v23
    v_max3_u32 v20, v20, v21, v22
    v_max_u32 v20, v20, v23
    v_cmp_lt_u32 vcc, 2, v20
    s_nop 1
    s_cmp_eq_u64 vcc, 0
    s_cbranch_scc1 P2ffn_f8v_ok
    s_cmp_lt_u32 s101, 0x8000
    s_cbranch_scc1 P2ffn_f8v_lp
    s_branch P2ffn_f8v_ok
P2ffn_f8v_ok:
    s_branch P2ffn_f8_ok
P2ffn_f13_spin:
    s_mov_b32 s101, 0
P2ffn_f13_sl:
    s_sleep 1
    s_buffer_load_dwordx4 s[56:59], s[28:31], s35 offset:0 glc
    s_add_u32 s101, s101, 1
    s_waitcnt lgkmcnt(0)
    s_add_u32 s100, s1, 3
    s_sub_u32 s56, s56, s100
    s_sub_u32 s57, s57, s100
    s_sub_u32 s58, s58, s100
    s_sub_u32 s59, s59, s100
    s_max_u32 s56, s56, s57
    s_max_u32 s58, s58, s59
    s_max_u32 s56, s56, s58
    s_cmp_le_u32 s56, 0
    s_cbranch_scc1 P2ffn_f13_ok
    s_cmp_lt_u32 s101, 24
    s_cbranch_scc1 P2ffn_f13_sl
P2ffn_f13v_spin:
    s_mov_b32 s101, 0
P2ffn_f13v_lp:
    s_sleep 2
    buffer_load_dwordx4 v[20:23], off, s[28:31], s35 offset:0 sc1
    s_add_u32 s101, s101, 1
    s_waitcnt vmcnt(0)
    s_add_u32 s100, s1, 3
    v_subrev_u32 v20, s100, v20
    v_subrev_u32 v21, s100, v21
    v_subrev_u32 v22, s100, v22
    v_subrev_u32 v23, s100, v23
    v_max3_u32 v20, v20, v21, v22
    v_max_u32 v20, v20, v23
    v_cmp_lt_u32 vcc, 0, v20
    s_nop 1
    s_cmp_eq_u64 vcc, 0
    s_cbranch_scc1 P2ffn_f13v_ok
    s_cmp_lt_u32 s101, 0x8000
    s_cbranch_scc1 P2ffn_f13v_lp
    s_branch P2ffn_f13v_ok
P2ffn_f13v_ok:
    s_branch P2ffn_f13_ok
ATT_fe_spin:
    s_mov_b32 s101, 0
ATT_fe_sl:
    s_sleep 1
    s_buffer_load_dwordx4 s[56:59], s[28:31], s35 offset:0 glc
    s_add_u32 s101, s101, 1
    s_waitcnt lgkmcnt(0)
    s_add_u32 s100, s1, 1
    s_sub_u32 s56, s56, s100
    s_sub_u32 s57, s57, s100
    s_sub_u32 s58, s58, s100
    s_sub_u32 s59, s59, s100
    s_max_u32 s56, s56, s57
    s_max_u32 s58, s58, s59
    s_max_u32 s56, s56, s58
    s_cmp_le_u32 s56, 2
    s_cbranch_scc1 ATT_fe_ok
    s_cmp_lt_u32 s101, 24
    s_cbranch_scc1 ATT_fe_sl
ATT_fev_spin:
    s_mov_b32 s101, 0
ATT_fev_lp:
    s_sleep 2
    buffer_load_dwordx4 v[100:103], off, s[28:31], s35 offset:0 sc1
    s_add_u32 s101, s101, 1
    s_waitcnt vmcnt(0)
    s_add_u32 s100, s1, 1
    v_subrev_u32 v100, s100, v100
    v_subrev_u32 v101, s100, v101
    v_subrev_u32 v102, s100, v102
    v_subrev_u32 v103, s100, v103
    v_max3_u32 v100, v100, v101, v102
    v_max_u32 v100, v100, v103
    v_cmp_lt_u32 vcc, 2, v100
    s_nop 1
    s_cmp_eq_u64 vcc, 0
    s_cbranch_scc1 ATT_fev_ok
    s_cmp_lt_u32 s101, 0x8000
    s_cbranch_scc1 ATT_fev_lp
    s_branch ATT_fev_ok
ATT_fev_ok:
    s_branch ATT_fe_ok
P2att_f4_spin:
    s_mov_b32 s101, 0
P2att_f4_sl:
    s_sleep 1
    s_buffer_load_dwordx4 s[56:59], s[28:31], s35 offset:0 glc
    s_add_u32 s101, s101, 1
    s_waitcnt lgkmcnt(0)
    s_add_u32 s100, s1, 2
    s_sub_u32 s56, s56, s100
    s_sub_u32 s57, s57, s100
    s_sub_u32 s58, s58, s100
    s_sub_u32 s59, s59, s100
    s_max_u32 s56, s56, s57
    s_max_u32 s58, s58, s59
    s_max_u32 s56, s56, s58
    s_cmp_le_u32 s56, 1
    s_cbranch_scc1 P2att_f4_ok
    s_cmp_lt_u32 s101, 24
    s_cbranch_scc1 P2att_f4_sl
P2att_f4v_spin:
    s_mov_b32 s101, 0
P2att_f4v_lp:
    s_sleep 2
    buffer_load_dwordx4 v[20:23], off, s[28:31], s35 offset:0 sc1
    s_add_u32 s101, s101, 1
    s_waitcnt vmcnt(0)
    s_add_u32 s100, s1, 2
    v_subrev_u32 v20, s100, v20
    v_subrev_u32 v21, s100, v21
    v_subrev_u32 v22, s100, v22
    v_subrev_u32 v23, s100, v23
    v_max3_u32 v20, v20, v21, v22
    v_max_u32 v20, v20, v23
    v_cmp_lt_u32 vcc, 1, v20
    s_nop 1
    s_cmp_eq_u64 vcc, 0
    s_cbranch_scc1 P2att_f4v_ok
    s_cmp_lt_u32 s101, 0x8000
    s_cbranch_scc1 P2att_f4v_lp
    s_branch P2att_f4v_ok
P2att_f4v_ok:
    s_branch P2att_f4_ok
P2att_f8_spin:
    s_mov_b32 s101, 0
P2att_f8_sl:
    s_sleep 1
    s_buffer_load_dwordx4 s[56:59], s[28:31], s35 offset:16 glc
    s_add_u32 s101, s101, 1
    s_waitcnt lgkmcnt(0)
    s_add_u32 s100, s1, 1
    s_sub_u32 s56, s56, s100
    s_sub_u32 s57, s57, s100
    s_sub_u32 s58, s58, s100
    s_sub_u32 s59, s59, s100
    s_max_u32 s56, s56, s57
    s_max_u32 s58, s58, s59
    s_max_u32 s56, s56, s58
    s_cmp_le_u32 s56, 2
    s_cbranch_scc1 P2att_f8_ok
    s_cmp_lt_u32 s101, 24
    s_cbranch_scc1 P2att_f8_sl
P2att_f8v_spin:
    s_mov_b32 s101, 0
P2att_f8v_lp:
    s_sleep 2
    buffer_load_dwordx4 v[20:23], off, s[28:31], s35 offset:16 sc1
    s_add_u32 s101, s101, 1
    s_waitcnt vmcnt(0)
    s_add_u32 s100, s1, 1
    v_subrev_u32 v20, s100, v20
    v_subrev_u32 v21, s100, v21
    v_subrev_u32 v22, s100, v22
    v_subrev_u32 v23, s100, v23
    v_max3_u32 v20, v20, v21, v22
    v_max_u32 v20, v20, v23
    v_cmp_lt_u32 vcc, 2, v20
    s_nop 1
    s_cmp_eq_u64 vcc, 0
    s_cbranch_scc1 P2att_f8v_ok
    s_cmp_lt_u32 s101, 0x8000
    s_cbranch_scc1 P2att_f8v_lp
    s_branch P2att_f8v_ok
P2att_f8v_ok:
    s_branch P2att_f8_ok
P2att_f13_spin:
    s_mov_b32 s101, 0
P2att_f13_sl:
    s_sleep 1
    s_buffer_load_dwordx4 s[56:59], s[28:31], s35 offset:0 glc
    s_add_u32 s101, s101, 1
    s_waitcnt lgkmcnt(0)
    s_add_u32 s100, s1, 3
    s_sub_u32 s56, s56, s100
    s_sub_u32 s57, s57, s100
    s_sub_u32 s58, s58, s100
    s_sub_u32 s59, s59, s100
    s_max_u32 s56, s56, s57
    s_max_u32 s58, s58, s59
    s_max_u32 s56, s56, s58
    s_cmp_le_u32 s56, 0
    s_cbranch_scc1 P2att_f13_ok
    s_cmp_lt_u32 s101, 24
    s_cbranch_scc1 P2att_f13_sl
P2att_f13v_spin:
    s_mov_b32 s101, 0
P2att_f13v_lp:
    s_sleep 2
    buffer_load_dwordx4 v[20:23], off, s[28:31], s35 offset:0 sc1
    s_add_u32 s101, s101, 1
    s_waitcnt vmcnt(0)
    s_add_u32 s100, s1, 3
    v_subrev_u32 v20, s100, v20
    v_subrev_u32 v21, s100, v21
    v_subrev_u32 v22, s100, v22
    v_subrev_u32 v23, s100, v23
    v_max3_u32 v20, v20, v21, v22
    v_max_u32 v20, v20, v23
    v_cmp_lt_u32 vcc, 0, v20
    s_nop 1
    s_cmp_eq_u64 vcc, 0
    s_cbranch_scc1 P2att_f13v_ok
    s_cmp_lt_u32 s101, 0x8000
    s_cbranch_scc1 P2att_f13v_lp
    s_branch P2att_f13v_ok
P2att_f13v_ok:
    s_branch P2att_f13_ok
ATT_bcast:
    v_lshrrev_b32 v212, 2, v2
    v_lshlrev_b32 v212, 14, v212
    v_and_b32 v213, 3, v2
    v_lshl_add_u32 v212, v213, 7, v212
    v_mov_b32 v213, s1
    s_mov_b32 s100, 29361216
    buffer_store_dword v213, v212, s[28:31], s100 offen sc1
    buffer_store_dword v213, v212, s[28:31], s100 offen offset:32 sc1
    s_branch ATT_bcast_ok
K_last:
    s_endpgm
.section .rodata,"a"
.p2align 6
.amdhsa_kernel parallel_sum__sliding_local_dilated__glu_gated_geglu__prompt_kernel
  .amdhsa_next_free_vgpr 512
  .amdhsa_next_free_sgpr 102
  .amdhsa_accum_offset 256
  .amdhsa_group_segment_fixed_size 0
  .amdhsa_kernarg_size 80
  .amdhsa_user_sgpr_count 2
  .amdhsa_user_sgpr_kernarg_segment_ptr 1
  .amdhsa_system_sgpr_workgroup_id_x 1
.end_amdhsa_kernel
```
